```python
import torch

def _softmax(x, axis=-1):
    return torch.softmax(x, dim=axis)
def _gelu(x):
    return torch.nn.functional.gelu(x, approximate="tanh")
def _silu(x):
    return torch.nn.functional.silu(x)
def _sigmoid(x):
    return torch.sigmoid(x)
def _layernorm(x, axis=-1, eps=1e-5):
    m = x.mean(dim=axis, keepdim=True)
    v = x.var(dim=axis, keepdim=True, unbiased=False)
    return (x - m) / torch.sqrt(v + eps)
def _scatter_add(tgt, idx, src, axis=0):
    return tgt.clone().index_add_(axis, idx, src)
def _segment_sum(src, seg, n):
    out = torch.zeros((n,) + src.shape[1:], dtype=src.dtype)
    return out.index_add_(0, seg, src)
def _pad(x, pw):
    flat = tuple(v for pair in reversed(pw) for v in pair)
    return torch.nn.functional.pad(x, flat)

kernel_name = 'interleave_layers__spectral_gfnet__softmax_full_mha__prompt'

def setup_inputs():

    _w = (lambda a: (lambda t: t.to(torch.bfloat16) if t.is_floating_point() else t)(torch.as_tensor(a)))
    def _A_setup():
        B, S, D = 1, 2048, 576
        Df = D // 2 + 1
        return {
            "x": _w((lambda *s: torch.randn(*s, dtype=torch.bfloat16) * 0.05)(B, S, D)),
            "w_r": _w((lambda *s: torch.randn(*s, dtype=torch.bfloat16) * 1.6)(S, Df) * 0.02),
            "w_i": _w((lambda *s: torch.randn(*s, dtype=torch.bfloat16) * 1.6)(S, Df) * 0.02),
        }
    _A_in = _A_setup()

    def _B_setup():
        B, S, D = 1, 2048, 576
        return {
            "x": _w((lambda *s: torch.randn(*s, dtype=torch.bfloat16) * 0.05)(B, S, D)),
            "wqkv": _w((lambda *s: torch.randn(*s, dtype=torch.bfloat16) * 0.05)(D, 3 * D)),
            "wo": _w((lambda *s: torch.randn(*s, dtype=torch.bfloat16) * 0.05)(D, D)),
        }
    _B_in = _B_setup()

    return {
        "A_x": _A_in["x"],
        "A_w_r": _A_in["w_r"],
        "A_w_i": _A_in["w_i"],
        "B_x": _B_in["x"],
        "B_wqkv": _B_in["wqkv"],
        "B_wo": _B_in["wo"],
    }

def reference(A_x, A_w_r, A_w_i, B_x, B_wqkv, B_wo):
    def _A_ref(x, w_r, w_i):
        B, S, D = x.shape
        X = (lambda x, axes=(-2,-1): torch.fft.rfft2(x.float(), dim=axes))(x, axes=(-2, -1))
        W = w_r + 1j * w_i
        X = X * W
        y = (lambda x, s, axes=(-2,-1): torch.fft.irfft2(x, s=s, dim=axes).to(torch.bfloat16))(X, (S, D), axes=(-2, -1))
        return y

    def _B_ref(x, wqkv, wo):
        B, S, D = x.shape
        H = 32; Dh = D // H
        qkv = (lambda x, *d: x.permute(*d))((x @ wqkv).reshape(B, S, 3, H, Dh), 2, 0, 3, 1, 4)
        q, k, v = qkv[0], qkv[1], qkv[2]
        scale = Dh ** -0.5
        scores = torch.einsum("bhqd,bhkd->bhqk", q, k) * scale
        p = _softmax(scores, axis=-1)
        o = torch.einsum("bhqk,bhkd->bhqd", p, v)
        return (lambda x, *d: x.permute(*d))(o, 0, 2, 1, 3).reshape(B, S, D) @ wo

    x = A_x
    x = x + _A_ref(_layernorm(x, axis=-1), A_w_r, A_w_i)
    x = x + _B_ref(_layernorm(x, axis=-1), B_wqkv, B_wo)
    x = x + _A_ref(_layernorm(x, axis=-1), A_w_r, A_w_i)
    x = x + _B_ref(_layernorm(x, axis=-1), B_wqkv, B_wo)
    return x
```

```asm
; @launch kernel=f_kernel grid=(256,1,1) block=(512,1,1) lds=153920
.amdgcn_target "amdgcn-amd-amdhsa--gfx950"
.text
.globl f_kernel
.p2align 8
.type f_kernel,@function
f_kernel:
  s_load_dwordx16 s[4:19], s[0:1], 0
  s_load_dwordx2 s[20:21], s[0:1], 64
  s_getpc_b64 s[90:91]
f_pc:
  v_lshlrev_b32 v5, 7, v0
  v_min_u32 v5, f_end-f_pc, v5
  s_cmp_lt_u32 s2, 256
  s_cbranch_scc1 f_kernel_go1
  s_endpgm
f_kernel_go1:
  global_load_dword v253, v5, s[90:91]
  v_lshrrev_b32 v1, 6, v0
  v_and_b32 v2, 15, v0
  v_readfirstlane_b32 s3, v1
  v_and_b32 v1, 63, v0
  v_lshrrev_b32 v3, 4, v1
  v_lshlrev_b32 v4, 4, v1
  s_mov_b32 s61, 0
  s_mov_b32 s43, 0
  s_and_b32 s40, s2, 7
  s_lshr_b32 s41, s2, 3
  s_lshl_b32 s44, s40, 3
  s_lshr_b32 s62, s41, 2
  s_add_u32 s44, s44, s62
  s_and_b32 s45, s41, 3
  s_mov_b32 s58, 0xc4100000
  s_mov_b32 s59, 0x3ae38e39
  s_and_b32 s62, s44, 3
  s_lshl_b32 s62, s62, 9
  s_lshr_b32 s63, s44, 2
  s_lshl_b32 s63, s63, 1
  s_add_u32 s62, s62, s63
  s_mul_i32 s67, s62, 1152
  s_cmp_lt_u32 s3, 4
  s_cbranch_scc1 f_kernel_fg2
  v_lshrrev_b32 v5, 2, v1
  v_mul_u32_u24 v5, 0x9000, v5
  v_and_b32 v6, 2, v3
  v_xor_b32 v6, v6, v1
  v_and_b32 v6, 3, v6
  v_lshl_add_u32 v5, v6, 4, v5
  s_bitcmp1_b32 s3, 0
  s_cselect_b32 s62, 1152, 0
  s_cselect_b32 s63, 1024, 0
  s_add_u32 s70, s67, s62
  s_bitcmp1_b32 s3, 1
  s_cselect_b32 s62, 576, 0
  s_add_u32 s70, s70, s62
  s_lshl_b32 s62, s62, 5
  s_add_u32 m0, s62, s63
  s_mov_b32 s30, 2359296
  s_mov_b32 s31, 0x00020000
  s_waitcnt lgkmcnt(0)
  s_mov_b64 s[28:29], s[4:5]
  buffer_load_dwordx4 v5, s[28:31], s70 offen offset:0 lds
  s_add_u32 m0, m0, 1984
  s_nop 0
  buffer_load_dwordx4 v5, s[28:31], s70 offen offset:64 lds
  s_add_u32 m0, m0, 1984
  s_nop 0
  buffer_load_dwordx4 v5, s[28:31], s70 offen offset:128 lds
  s_add_u32 m0, m0, 1984
  s_nop 0
  buffer_load_dwordx4 v5, s[28:31], s70 offen offset:192 lds
  s_add_u32 m0, m0, 1984
  s_nop 0
  buffer_load_dwordx4 v5, s[28:31], s70 offen offset:256 lds
  s_add_u32 m0, m0, 1984
  s_nop 0
  buffer_load_dwordx4 v5, s[28:31], s70 offen offset:320 lds
  s_add_u32 m0, m0, 1984
  s_nop 0
  buffer_load_dwordx4 v5, s[28:31], s70 offen offset:384 lds
  s_add_u32 m0, m0, 1984
  s_nop 0
  buffer_load_dwordx4 v5, s[28:31], s70 offen offset:448 lds
  s_add_u32 m0, m0, 1984
  s_nop 0
  buffer_load_dwordx4 v5, s[28:31], s70 offen offset:512 lds
f_kernel_fg2:
  s_mul_i32 s62, s45, 144
  s_lshl_b32 s63, s3, 4
  s_add_u32 s63, s63, s62
  v_add_u32 v16, s63, v2
  v_lshrrev_b32 v17, 1, v16
  v_add_u32 v17, 1, v17
  v_and_b32 v18, 1, v16
  v_cvt_f32_u32 v18, v18
  v_mul_f32 v18, 0x3e800000, v18
  v_cmp_eq_u32 vcc, 0x23f, v16
  s_nop 1
  v_cndmask_b32 v17, v17, 0, vcc
  v_cndmask_b32 v18, v18, 0, vcc
  v_mov_b32 v20, 0x3d715bef
  v_mov_b32 v21, 0x3d2aaaab
  v_cmp_lt_u32 vcc, 0x23d, v16
  s_nop 1
  v_cndmask_b32 v20, v20, v21, vcc
  v_cvt_f32_u32 v19, v17
  v_mul_f32 v19, s59, v19
  v_lshlrev_b32 v22, 3, v3
  v_lshlrev_b32 v24, 5, v17
  v_cvt_f32_u32 v26, v24
  v_mul_f32 v25, s59, v26
  v_floor_f32 v25, v25
  v_fma_f32 v26, v25, s58, v26
  v_mul_f32 v26, s59, v26
  v_cos_f32 v26, v26
  v_mul_u32_u24 v24, v22, v17
  v_cvt_f32_u32 v32, v24
  v_mul_f32 v25, s59, v32
  v_floor_f32 v25, v25
  v_fma_f32 v32, v25, s58, v32
  v_fma_f32 v32, v32, s59, v18
  v_fmamk_f32 v33, v19, 0x3f800000, v32
  v_fmamk_f32 v34, v19, 0x40000000, v32
  v_fmamk_f32 v35, v19, 0x40400000, v32
  v_fmamk_f32 v36, v19, 0x40800000, v32
  v_fmamk_f32 v37, v19, 0x40a00000, v32
  v_fmamk_f32 v38, v19, 0x40c00000, v32
  v_fmamk_f32 v39, v19, 0x40e00000, v32
  v_cos_f32 v32, v32
  v_cos_f32 v33, v33
  v_cos_f32 v34, v34
  v_cos_f32 v35, v35
  v_cos_f32 v36, v36
  v_cos_f32 v37, v37
  v_cos_f32 v38, v38
  v_cos_f32 v39, v39
  v_pk_mul_f32 v[32:33], v[32:33], v[20:21] op_sel_hi:[1,0]
  v_pk_mul_f32 v[34:35], v[34:35], v[20:21] op_sel_hi:[1,0]
  v_pk_mul_f32 v[36:37], v[36:37], v[20:21] op_sel_hi:[1,0]
  v_pk_mul_f32 v[38:39], v[38:39], v[20:21] op_sel_hi:[1,0]
  v_add_f32 v26, v26, v26
  v_add_u32 v22, 32, v22
  v_mul_u32_u24 v24, v22, v17
  v_cvt_f32_u32 v40, v24
  v_mul_f32 v25, s59, v40
  v_floor_f32 v25, v25
  v_fma_f32 v40, v25, s58, v40
  v_fma_f32 v40, v40, s59, v18
  v_fmamk_f32 v41, v19, 0x3f800000, v40
  v_fmamk_f32 v42, v19, 0x40000000, v40
  v_fmamk_f32 v43, v19, 0x40400000, v40
  v_fmamk_f32 v44, v19, 0x40800000, v40
  v_fmamk_f32 v45, v19, 0x40a00000, v40
  v_fmamk_f32 v46, v19, 0x40c00000, v40
  v_fmamk_f32 v47, v19, 0x40e00000, v40
  v_cos_f32 v40, v40
  v_cos_f32 v41, v41
  v_cos_f32 v42, v42
  v_cos_f32 v43, v43
  v_cos_f32 v44, v44
  v_cos_f32 v45, v45
  v_cos_f32 v46, v46
  v_cos_f32 v47, v47
  v_pk_mul_f32 v[40:41], v[40:41], v[20:21] op_sel_hi:[1,0]
  v_pk_mul_f32 v[42:43], v[42:43], v[20:21] op_sel_hi:[1,0]
  v_pk_mul_f32 v[44:45], v[44:45], v[20:21] op_sel_hi:[1,0]
  v_pk_mul_f32 v[46:47], v[46:47], v[20:21] op_sel_hi:[1,0]
  v_cvt_pk_bf16_f32 v160, v32, v33
  v_cvt_pk_bf16_f32 v161, v34, v35
  v_cvt_pk_bf16_f32 v162, v36, v37
  v_cvt_pk_bf16_f32 v163, v38, v39
  v_cvt_pk_bf16_f32 v164, v40, v41
  v_cvt_pk_bf16_f32 v165, v42, v43
  v_cvt_pk_bf16_f32 v166, v44, v45
  v_cvt_pk_bf16_f32 v167, v46, v47
  v_pk_fma_f32 v[32:33], v[40:41], v[26:27], v[32:33] op_sel_hi:[1,0,1] neg_lo:[0,0,1] neg_hi:[0,0,1]
  v_pk_fma_f32 v[34:35], v[42:43], v[26:27], v[34:35] op_sel_hi:[1,0,1] neg_lo:[0,0,1] neg_hi:[0,0,1]
  v_pk_fma_f32 v[36:37], v[44:45], v[26:27], v[36:37] op_sel_hi:[1,0,1] neg_lo:[0,0,1] neg_hi:[0,0,1]
  v_pk_fma_f32 v[38:39], v[46:47], v[26:27], v[38:39] op_sel_hi:[1,0,1] neg_lo:[0,0,1] neg_hi:[0,0,1]
  v_cvt_pk_bf16_f32 v168, v32, v33
  v_cvt_pk_bf16_f32 v169, v34, v35
  v_cvt_pk_bf16_f32 v170, v36, v37
  v_cvt_pk_bf16_f32 v171, v38, v39
  v_pk_fma_f32 v[40:41], v[32:33], v[26:27], v[40:41] op_sel_hi:[1,0,1] neg_lo:[0,0,1] neg_hi:[0,0,1]
  v_pk_fma_f32 v[42:43], v[34:35], v[26:27], v[42:43] op_sel_hi:[1,0,1] neg_lo:[0,0,1] neg_hi:[0,0,1]
  v_pk_fma_f32 v[44:45], v[36:37], v[26:27], v[44:45] op_sel_hi:[1,0,1] neg_lo:[0,0,1] neg_hi:[0,0,1]
  v_pk_fma_f32 v[46:47], v[38:39], v[26:27], v[46:47] op_sel_hi:[1,0,1] neg_lo:[0,0,1] neg_hi:[0,0,1]
  v_cvt_pk_bf16_f32 v172, v40, v41
  v_cvt_pk_bf16_f32 v173, v42, v43
  v_cvt_pk_bf16_f32 v174, v44, v45
  v_cvt_pk_bf16_f32 v175, v46, v47
  v_pk_fma_f32 v[32:33], v[40:41], v[26:27], v[32:33] op_sel_hi:[1,0,1] neg_lo:[0,0,1] neg_hi:[0,0,1]
  v_pk_fma_f32 v[34:35], v[42:43], v[26:27], v[34:35] op_sel_hi:[1,0,1] neg_lo:[0,0,1] neg_hi:[0,0,1]
  v_pk_fma_f32 v[36:37], v[44:45], v[26:27], v[36:37] op_sel_hi:[1,0,1] neg_lo:[0,0,1] neg_hi:[0,0,1]
  v_pk_fma_f32 v[38:39], v[46:47], v[26:27], v[38:39] op_sel_hi:[1,0,1] neg_lo:[0,0,1] neg_hi:[0,0,1]
  v_cvt_pk_bf16_f32 v176, v32, v33
  v_cvt_pk_bf16_f32 v177, v34, v35
  v_cvt_pk_bf16_f32 v178, v36, v37
  v_cvt_pk_bf16_f32 v179, v38, v39
  v_pk_fma_f32 v[40:41], v[32:33], v[26:27], v[40:41] op_sel_hi:[1,0,1] neg_lo:[0,0,1] neg_hi:[0,0,1]
  v_pk_fma_f32 v[42:43], v[34:35], v[26:27], v[42:43] op_sel_hi:[1,0,1] neg_lo:[0,0,1] neg_hi:[0,0,1]
  v_pk_fma_f32 v[44:45], v[36:37], v[26:27], v[44:45] op_sel_hi:[1,0,1] neg_lo:[0,0,1] neg_hi:[0,0,1]
  v_pk_fma_f32 v[46:47], v[38:39], v[26:27], v[46:47] op_sel_hi:[1,0,1] neg_lo:[0,0,1] neg_hi:[0,0,1]
  v_cvt_pk_bf16_f32 v180, v40, v41
  v_cvt_pk_bf16_f32 v181, v42, v43
  v_cvt_pk_bf16_f32 v182, v44, v45
  v_cvt_pk_bf16_f32 v183, v46, v47
  v_pk_fma_f32 v[32:33], v[40:41], v[26:27], v[32:33] op_sel_hi:[1,0,1] neg_lo:[0,0,1] neg_hi:[0,0,1]
  v_pk_fma_f32 v[34:35], v[42:43], v[26:27], v[34:35] op_sel_hi:[1,0,1] neg_lo:[0,0,1] neg_hi:[0,0,1]
  v_pk_fma_f32 v[36:37], v[44:45], v[26:27], v[36:37] op_sel_hi:[1,0,1] neg_lo:[0,0,1] neg_hi:[0,0,1]
  v_pk_fma_f32 v[38:39], v[46:47], v[26:27], v[38:39] op_sel_hi:[1,0,1] neg_lo:[0,0,1] neg_hi:[0,0,1]
  v_cvt_pk_bf16_f32 v184, v32, v33
  v_cvt_pk_bf16_f32 v185, v34, v35
  v_cvt_pk_bf16_f32 v186, v36, v37
  v_cvt_pk_bf16_f32 v187, v38, v39
  v_pk_fma_f32 v[40:41], v[32:33], v[26:27], v[40:41] op_sel_hi:[1,0,1] neg_lo:[0,0,1] neg_hi:[0,0,1]
  v_pk_fma_f32 v[42:43], v[34:35], v[26:27], v[42:43] op_sel_hi:[1,0,1] neg_lo:[0,0,1] neg_hi:[0,0,1]
  v_pk_fma_f32 v[44:45], v[36:37], v[26:27], v[44:45] op_sel_hi:[1,0,1] neg_lo:[0,0,1] neg_hi:[0,0,1]
  v_pk_fma_f32 v[46:47], v[38:39], v[26:27], v[46:47] op_sel_hi:[1,0,1] neg_lo:[0,0,1] neg_hi:[0,0,1]
  v_cvt_pk_bf16_f32 v188, v40, v41
  v_cvt_pk_bf16_f32 v189, v42, v43
  v_cvt_pk_bf16_f32 v190, v44, v45
  v_cvt_pk_bf16_f32 v191, v46, v47
  v_pk_fma_f32 v[32:33], v[40:41], v[26:27], v[32:33] op_sel_hi:[1,0,1] neg_lo:[0,0,1] neg_hi:[0,0,1]
  v_pk_fma_f32 v[34:35], v[42:43], v[26:27], v[34:35] op_sel_hi:[1,0,1] neg_lo:[0,0,1] neg_hi:[0,0,1]
  v_pk_fma_f32 v[36:37], v[44:45], v[26:27], v[36:37] op_sel_hi:[1,0,1] neg_lo:[0,0,1] neg_hi:[0,0,1]
  v_pk_fma_f32 v[38:39], v[46:47], v[26:27], v[38:39] op_sel_hi:[1,0,1] neg_lo:[0,0,1] neg_hi:[0,0,1]
  v_cvt_pk_bf16_f32 v192, v32, v33
  v_cvt_pk_bf16_f32 v193, v34, v35
  v_cvt_pk_bf16_f32 v194, v36, v37
  v_cvt_pk_bf16_f32 v195, v38, v39
  v_pk_fma_f32 v[40:41], v[32:33], v[26:27], v[40:41] op_sel_hi:[1,0,1] neg_lo:[0,0,1] neg_hi:[0,0,1]
  v_pk_fma_f32 v[42:43], v[34:35], v[26:27], v[42:43] op_sel_hi:[1,0,1] neg_lo:[0,0,1] neg_hi:[0,0,1]
  v_pk_fma_f32 v[44:45], v[36:37], v[26:27], v[44:45] op_sel_hi:[1,0,1] neg_lo:[0,0,1] neg_hi:[0,0,1]
  v_pk_fma_f32 v[46:47], v[38:39], v[26:27], v[46:47] op_sel_hi:[1,0,1] neg_lo:[0,0,1] neg_hi:[0,0,1]
  v_cvt_pk_bf16_f32 v196, v40, v41
  v_cvt_pk_bf16_f32 v197, v42, v43
  v_cvt_pk_bf16_f32 v198, v44, v45
  v_cvt_pk_bf16_f32 v199, v46, v47
  v_pk_fma_f32 v[32:33], v[40:41], v[26:27], v[32:33] op_sel_hi:[1,0,1] neg_lo:[0,0,1] neg_hi:[0,0,1]
  v_pk_fma_f32 v[34:35], v[42:43], v[26:27], v[34:35] op_sel_hi:[1,0,1] neg_lo:[0,0,1] neg_hi:[0,0,1]
  v_pk_fma_f32 v[36:37], v[44:45], v[26:27], v[36:37] op_sel_hi:[1,0,1] neg_lo:[0,0,1] neg_hi:[0,0,1]
  v_pk_fma_f32 v[38:39], v[46:47], v[26:27], v[38:39] op_sel_hi:[1,0,1] neg_lo:[0,0,1] neg_hi:[0,0,1]
  v_cvt_pk_bf16_f32 v200, v32, v33
  v_cvt_pk_bf16_f32 v201, v34, v35
  v_cvt_pk_bf16_f32 v202, v36, v37
  v_cvt_pk_bf16_f32 v203, v38, v39
  v_pk_fma_f32 v[40:41], v[32:33], v[26:27], v[40:41] op_sel_hi:[1,0,1] neg_lo:[0,0,1] neg_hi:[0,0,1]
  v_pk_fma_f32 v[42:43], v[34:35], v[26:27], v[42:43] op_sel_hi:[1,0,1] neg_lo:[0,0,1] neg_hi:[0,0,1]
  v_pk_fma_f32 v[44:45], v[36:37], v[26:27], v[44:45] op_sel_hi:[1,0,1] neg_lo:[0,0,1] neg_hi:[0,0,1]
  v_pk_fma_f32 v[46:47], v[38:39], v[26:27], v[46:47] op_sel_hi:[1,0,1] neg_lo:[0,0,1] neg_hi:[0,0,1]
  v_cvt_pk_bf16_f32 v204, v40, v41
  v_cvt_pk_bf16_f32 v205, v42, v43
  v_cvt_pk_bf16_f32 v206, v44, v45
  v_cvt_pk_bf16_f32 v207, v46, v47
  v_pk_fma_f32 v[32:33], v[40:41], v[26:27], v[32:33] op_sel_hi:[1,0,1] neg_lo:[0,0,1] neg_hi:[0,0,1]
  v_pk_fma_f32 v[34:35], v[42:43], v[26:27], v[34:35] op_sel_hi:[1,0,1] neg_lo:[0,0,1] neg_hi:[0,0,1]
  v_pk_fma_f32 v[36:37], v[44:45], v[26:27], v[36:37] op_sel_hi:[1,0,1] neg_lo:[0,0,1] neg_hi:[0,0,1]
  v_pk_fma_f32 v[38:39], v[46:47], v[26:27], v[38:39] op_sel_hi:[1,0,1] neg_lo:[0,0,1] neg_hi:[0,0,1]
  v_cvt_pk_bf16_f32 v208, v32, v33
  v_cvt_pk_bf16_f32 v209, v34, v35
  v_cvt_pk_bf16_f32 v210, v36, v37
  v_cvt_pk_bf16_f32 v211, v38, v39
  v_pk_fma_f32 v[40:41], v[32:33], v[26:27], v[40:41] op_sel_hi:[1,0,1] neg_lo:[0,0,1] neg_hi:[0,0,1]
  v_pk_fma_f32 v[42:43], v[34:35], v[26:27], v[42:43] op_sel_hi:[1,0,1] neg_lo:[0,0,1] neg_hi:[0,0,1]
  v_pk_fma_f32 v[44:45], v[36:37], v[26:27], v[44:45] op_sel_hi:[1,0,1] neg_lo:[0,0,1] neg_hi:[0,0,1]
  v_pk_fma_f32 v[46:47], v[38:39], v[26:27], v[46:47] op_sel_hi:[1,0,1] neg_lo:[0,0,1] neg_hi:[0,0,1]
  v_cvt_pk_bf16_f32 v212, v40, v41
  v_cvt_pk_bf16_f32 v213, v42, v43
  v_cvt_pk_bf16_f32 v214, v44, v45
  v_cvt_pk_bf16_f32 v215, v46, v47
  v_pk_fma_f32 v[32:33], v[40:41], v[26:27], v[32:33] op_sel_hi:[1,0,1] neg_lo:[0,0,1] neg_hi:[0,0,1]
  v_pk_fma_f32 v[34:35], v[42:43], v[26:27], v[34:35] op_sel_hi:[1,0,1] neg_lo:[0,0,1] neg_hi:[0,0,1]
  v_pk_fma_f32 v[36:37], v[44:45], v[26:27], v[36:37] op_sel_hi:[1,0,1] neg_lo:[0,0,1] neg_hi:[0,0,1]
  v_pk_fma_f32 v[38:39], v[46:47], v[26:27], v[38:39] op_sel_hi:[1,0,1] neg_lo:[0,0,1] neg_hi:[0,0,1]
  v_cvt_pk_bf16_f32 v216, v32, v33
  v_cvt_pk_bf16_f32 v217, v34, v35
  v_cvt_pk_bf16_f32 v218, v36, v37
  v_cvt_pk_bf16_f32 v219, v38, v39
  v_pk_fma_f32 v[40:41], v[32:33], v[26:27], v[40:41] op_sel_hi:[1,0,1] neg_lo:[0,0,1] neg_hi:[0,0,1]
  v_pk_fma_f32 v[42:43], v[34:35], v[26:27], v[42:43] op_sel_hi:[1,0,1] neg_lo:[0,0,1] neg_hi:[0,0,1]
  v_pk_fma_f32 v[44:45], v[36:37], v[26:27], v[44:45] op_sel_hi:[1,0,1] neg_lo:[0,0,1] neg_hi:[0,0,1]
  v_pk_fma_f32 v[46:47], v[38:39], v[26:27], v[46:47] op_sel_hi:[1,0,1] neg_lo:[0,0,1] neg_hi:[0,0,1]
  v_cvt_pk_bf16_f32 v220, v40, v41
  v_cvt_pk_bf16_f32 v221, v42, v43
  v_cvt_pk_bf16_f32 v222, v44, v45
  v_cvt_pk_bf16_f32 v223, v46, v47
  v_pk_fma_f32 v[32:33], v[40:41], v[26:27], v[32:33] op_sel_hi:[1,0,1] neg_lo:[0,0,1] neg_hi:[0,0,1]
  v_pk_fma_f32 v[34:35], v[42:43], v[26:27], v[34:35] op_sel_hi:[1,0,1] neg_lo:[0,0,1] neg_hi:[0,0,1]
  v_pk_fma_f32 v[36:37], v[44:45], v[26:27], v[36:37] op_sel_hi:[1,0,1] neg_lo:[0,0,1] neg_hi:[0,0,1]
  v_pk_fma_f32 v[38:39], v[46:47], v[26:27], v[38:39] op_sel_hi:[1,0,1] neg_lo:[0,0,1] neg_hi:[0,0,1]
  v_cvt_pk_bf16_f32 v224, v32, v33
  v_cvt_pk_bf16_f32 v225, v34, v35
  v_cvt_pk_bf16_f32 v226, v36, v37
  v_cvt_pk_bf16_f32 v227, v38, v39
  v_pk_fma_f32 v[40:41], v[32:33], v[26:27], v[40:41] op_sel_hi:[1,0,1] neg_lo:[0,0,1] neg_hi:[0,0,1]
  v_pk_fma_f32 v[42:43], v[34:35], v[26:27], v[42:43] op_sel_hi:[1,0,1] neg_lo:[0,0,1] neg_hi:[0,0,1]
  v_pk_fma_f32 v[44:45], v[36:37], v[26:27], v[44:45] op_sel_hi:[1,0,1] neg_lo:[0,0,1] neg_hi:[0,0,1]
  v_pk_fma_f32 v[46:47], v[38:39], v[26:27], v[46:47] op_sel_hi:[1,0,1] neg_lo:[0,0,1] neg_hi:[0,0,1]
  v_cvt_pk_bf16_f32 v228, v40, v41
  v_cvt_pk_bf16_f32 v229, v42, v43
  v_cvt_pk_bf16_f32 v230, v44, v45
  v_cvt_pk_bf16_f32 v231, v46, v47
  s_add_u32 s62, s62, 128
  v_add_u32 v16, s62, v2
  v_lshrrev_b32 v17, 1, v16
  v_add_u32 v17, 1, v17
  v_and_b32 v18, 1, v16
  v_cvt_f32_u32 v18, v18
  v_mul_f32 v18, 0x3e800000, v18
  v_cmp_eq_u32 vcc, 0x23f, v16
  s_nop 1
  v_cndmask_b32 v17, v17, 0, vcc
  v_cndmask_b32 v18, v18, 0, vcc
  v_mov_b32 v20, 0x3d715bef
  v_mov_b32 v21, 0x3d2aaaab
  v_cmp_lt_u32 vcc, 0x23d, v16
  s_nop 1
  v_cndmask_b32 v20, v20, v21, vcc
  v_cvt_f32_u32 v19, v17
  v_mul_f32 v19, s59, v19
  s_lshl_b32 s62, s3, 6
  v_lshl_add_u32 v22, v3, 3, s62
  v_mul_u32_u24 v24, v22, v17
  v_cvt_f32_u32 v32, v24
  v_mul_f32 v25, s59, v32
  v_floor_f32 v25, v25
  v_fma_f32 v32, v25, s58, v32
  v_fma_f32 v32, v32, s59, v18
  v_fmamk_f32 v33, v19, 0x3f800000, v32
  v_fmamk_f32 v34, v19, 0x40000000, v32
  v_fmamk_f32 v35, v19, 0x40400000, v32
  v_fmamk_f32 v36, v19, 0x40800000, v32
  v_fmamk_f32 v37, v19, 0x40a00000, v32
  v_fmamk_f32 v38, v19, 0x40c00000, v32
  v_fmamk_f32 v39, v19, 0x40e00000, v32
  v_cos_f32 v32, v32
  v_cos_f32 v33, v33
  v_cos_f32 v34, v34
  v_cos_f32 v35, v35
  v_cos_f32 v36, v36
  v_cos_f32 v37, v37
  v_cos_f32 v38, v38
  v_cos_f32 v39, v39
  v_pk_mul_f32 v[32:33], v[32:33], v[20:21] op_sel_hi:[1,0]
  v_pk_mul_f32 v[34:35], v[34:35], v[20:21] op_sel_hi:[1,0]
  v_pk_mul_f32 v[36:37], v[36:37], v[20:21] op_sel_hi:[1,0]
  v_pk_mul_f32 v[38:39], v[38:39], v[20:21] op_sel_hi:[1,0]
  v_add_u32 v22, 32, v22
  v_mul_u32_u24 v24, v22, v17
  v_cvt_f32_u32 v40, v24
  v_mul_f32 v25, s59, v40
  v_floor_f32 v25, v25
  v_fma_f32 v40, v25, s58, v40
  v_fma_f32 v40, v40, s59, v18
  v_fmamk_f32 v41, v19, 0x3f800000, v40
  v_fmamk_f32 v42, v19, 0x40000000, v40
  v_fmamk_f32 v43, v19, 0x40400000, v40
  v_fmamk_f32 v44, v19, 0x40800000, v40
  v_fmamk_f32 v45, v19, 0x40a00000, v40
  v_fmamk_f32 v46, v19, 0x40c00000, v40
  v_fmamk_f32 v47, v19, 0x40e00000, v40
  v_cos_f32 v40, v40
  v_cos_f32 v41, v41
  v_cos_f32 v42, v42
  v_cos_f32 v43, v43
  v_cos_f32 v44, v44
  v_cos_f32 v45, v45
  v_cos_f32 v46, v46
  v_cos_f32 v47, v47
  v_pk_mul_f32 v[40:41], v[40:41], v[20:21] op_sel_hi:[1,0]
  v_pk_mul_f32 v[42:43], v[42:43], v[20:21] op_sel_hi:[1,0]
  v_pk_mul_f32 v[44:45], v[44:45], v[20:21] op_sel_hi:[1,0]
  v_pk_mul_f32 v[46:47], v[46:47], v[20:21] op_sel_hi:[1,0]
  v_cvt_pk_bf16_f32 v232, v32, v33
  v_cvt_pk_bf16_f32 v233, v34, v35
  v_cvt_pk_bf16_f32 v234, v36, v37
  v_cvt_pk_bf16_f32 v235, v38, v39
  v_cvt_pk_bf16_f32 v236, v40, v41
  v_cvt_pk_bf16_f32 v237, v42, v43
  v_cvt_pk_bf16_f32 v238, v44, v45
  v_cvt_pk_bf16_f32 v239, v46, v47
  s_and_b32 s62, s3, 1
  s_lshl_b32 s62, s62, 5
  s_add_u32 s62, s62, 512
  v_lshl_add_u32 v22, v3, 3, s62
  s_cmp_lt_u32 s3, 2
  s_cselect_b32 s62, 1.0, 0
  v_mul_f32 v20, s62, v20
  v_mul_u32_u24 v24, v22, v17
  v_cvt_f32_u32 v32, v24
  v_mul_f32 v25, s59, v32
  v_floor_f32 v25, v25
  v_fma_f32 v32, v25, s58, v32
  v_fma_f32 v32, v32, s59, v18
  v_fmamk_f32 v33, v19, 0x3f800000, v32
  v_fmamk_f32 v34, v19, 0x40000000, v32
  v_fmamk_f32 v35, v19, 0x40400000, v32
  v_fmamk_f32 v36, v19, 0x40800000, v32
  v_fmamk_f32 v37, v19, 0x40a00000, v32
  v_fmamk_f32 v38, v19, 0x40c00000, v32
  v_fmamk_f32 v39, v19, 0x40e00000, v32
  v_cos_f32 v32, v32
  v_cos_f32 v33, v33
  v_cos_f32 v34, v34
  v_cos_f32 v35, v35
  v_cos_f32 v36, v36
  v_cos_f32 v37, v37
  v_cos_f32 v38, v38
  v_cos_f32 v39, v39
  v_pk_mul_f32 v[32:33], v[32:33], v[20:21] op_sel_hi:[1,0]
  v_pk_mul_f32 v[34:35], v[34:35], v[20:21] op_sel_hi:[1,0]
  v_pk_mul_f32 v[36:37], v[36:37], v[20:21] op_sel_hi:[1,0]
  v_pk_mul_f32 v[38:39], v[38:39], v[20:21] op_sel_hi:[1,0]
  v_cvt_pk_bf16_f32 v240, v32, v33
  v_cvt_pk_bf16_f32 v241, v34, v35
  v_cvt_pk_bf16_f32 v242, v36, v37
  v_cvt_pk_bf16_f32 v243, v38, v39
  s_and_b32 s62, s40, 1
  s_lshl_b32 s62, s62, 1
  s_sub_u32 s62, s41, s62
  s_sub_u32 s63, s62, 16
  s_cmp_lt_u32 s63, 2
  s_cselect_b32 s62, s62, 0x1000
  s_cmp_lt_u32 s41, 16
  s_cselect_b32 s62, s41, s62
  s_mul_i32 s46, s40, 18
  s_add_u32 s46, s46, s62
  s_sub_u32 s62, s41, 20
  s_lshr_b32 s62, s62, 2
  s_lshl_b32 s62, s62, 3
  s_add_u32 s62, s62, s40
  s_lshr_b32 s63, s40, 1
  s_add_u32 s63, s63, 24
  s_cmp_ge_u32 s41, 20
  s_cselect_b32 s47, s62, s63
  s_cmp_lt_u32 s46, 144
  s_cselect_b32 s47, 28, s47
  s_waitcnt lgkmcnt(0)
  s_load_dword s42, s[20:21], 256
  s_cmp_ge_u32 s3, 2
  s_cbranch_scc1 f_kernel_pj4
  s_mov_b32 s35, 0x00020000
  v_mul_u32_u24 v6, 0x242, v2
  v_lshl_add_u32 v6, v3, 4, v6
  s_lshr_b32 s62, s41, 2
  s_lshl_b32 s62, s62, 4
  s_add_u32 s62, s62, s45
  s_mul_i32 s74, s62, 9248
  s_mul_i32 s62, s40, 72
  s_lshl_b32 s63, s3, 6
  s_add_u32 s62, s62, s63
  s_add_u32 s74, s74, s62
  s_add_u32 s74, s74, 2
  s_mov_b64 s[32:33], s[6:7]
  s_mov_b32 s34, 1183744
  s_mov_b64 s[36:37], s[8:9]
  s_mov_b32 s38, 1183744
  s_mov_b32 s39, 0x00020000
  s_cmp_eq_u32 s3, 0
  s_cselect_b64 exec, -1, 0xffff
  buffer_load_dwordx4 v[104:107], v6, s[32:35], s74 offen
  buffer_load_dwordx4 v[108:111], v6, s[36:39], s74 offen
  s_add_u32 s74, s74, 36992
  buffer_load_dwordx4 v[112:115], v6, s[32:35], s74 offen
  buffer_load_dwordx4 v[116:119], v6, s[36:39], s74 offen
  s_add_u32 s74, s74, 36992
  buffer_load_dwordx4 v[120:123], v6, s[32:35], s74 offen
  buffer_load_dwordx4 v[124:127], v6, s[36:39], s74 offen
  s_add_u32 s74, s74, 36992
  buffer_load_dwordx4 v[128:131], v6, s[32:35], s74 offen
  buffer_load_dwordx4 v[132:135], v6, s[36:39], s74 offen
  s_mov_b64 exec, -1
f_kernel_pj4:
  s_mov_b64 s[24:25], s[20:21]
  s_mov_b32 s26, 67108864
  s_mov_b32 s27, 0x00020000
  s_mov_b64 s[28:29], s[4:5]
  s_mov_b32 s30, 2359296
  s_mov_b32 s31, 0x00020000
  s_mov_b32 s48, 65536
  s_mov_b32 s49, 0
  s_mov_b32 s50, 50331648
  s_mov_b32 s51, 9568256
  s_lshr_b32 s62, s2, 2
  s_lshl_b32 s62, s62, 6
  s_and_b32 s63, s2, 3
  s_lshl_b32 s63, s63, 2
  s_add_u32 s52, s62, s63
  s_lshl_b32 s62, s47, 6
  s_lshl_b32 s63, s45, 2
  s_add_u32 s53, s62, s63
  s_add_u32 s55, s53, 50724864
  s_cmp_lt_u32 s47, 18
  s_cselect_b32 s55, s55, 1073741824
  s_and_b32 s62, s41, 7
  s_mul_i32 s62, s62, 4608
  s_lshl_b32 s63, s40, 6
  s_add_u32 s62, s62, s63
  s_lshr_b32 s63, s41, 3
  s_lshl_b32 s63, s63, 2
  s_add_u32 s54, s62, s63
  s_lshl_b32 s56, s40, 12
  s_mul_i32 s57, s40, 4608
  s_mov_b32 s60, 0xffff0000
  v_mov_b32 v144, 0
  v_mov_b32 v145, 0
  v_mov_b32 v146, 0
  v_mov_b32 v147, 0
  v_mov_b32 v148, 0
  v_mov_b32 v149, 0
  v_mov_b32 v150, 0
  v_mov_b32 v151, 0
  v_mov_b32 v152, 0
  v_mov_b32 v153, 0
  v_mov_b32 v154, 0
  v_mov_b32 v155, 0
  v_mov_b32 v156, 0
  v_mov_b32 v157, 0
  v_mov_b32 v158, 0
  v_mov_b32 v159, 0
  v_lshrrev_b32 v5, 2, v2
  v_and_b32 v5, 2, v5
  v_xor_b32 v5, v5, v3
  v_lshlrev_b32 v5, 4, v5
  v_lshl_add_u32 v252, v2, 6, v5
  s_lshl_b32 s62, s3, 12
  v_add_u32 v5, s62, v252
  s_and_b32 s62, s3, 1
  s_lshl_b32 s62, s62, 11
  s_add_u32 s62, s62, 32768
  v_add_u32 v6, s62, v252
  s_mul_i32 s62, s3, 4112
  s_add_u32 s62, s62, 36864
  v_add_u32 v7, s62, v4
  v_lshlrev_b32 v8, 4, v2
  v_lshl_add_u32 v8, v3, 14, v8
  v_lshl_add_u32 v9, v2, 2, v3
  s_lshl_b32 s62, s3, 3
  s_add_u32 s62, s62, 69760
  v_lshl_add_u32 v9, v9, 6, s62
  s_mul_i32 s64, s45, 589824
  s_lshl_b32 s65, s44, 8
  s_add_u32 s64, s64, s65
  s_add_u32 s64, s64, s48
  s_lshl_b32 s65, s3, 5
  s_add_u32 s65, s65, s64
  s_add_u32 s65, s65, 524288
  s_lshl_b32 s62, s3, 16
  s_add_u32 s64, s64, s62
  s_lshl_b32 s66, s45, 13
  s_lshl_b32 s62, s44, 7
  s_add_u32 s66, s66, s62
  s_lshl_b32 s62, s3, 4
  s_add_u32 s66, s66, s62
  s_add_u32 s66, s66, s51
  s_waitcnt lgkmcnt(0)
  s_mul_i32 s42, s42, 1664525
  s_add_u32 s42, s42, 1013904223
  s_cmp_lt_u32 s3, 4
  s_cbranch_scc1 f_kernel_px5
  s_lshl_b32 s62, s45, 2
  s_and_b32 s63, s3, 3
  s_add_u32 s62, s62, s63
  s_mul_i32 s71, s62, 124416
  s_lshl_b32 s63, s47, 7
  s_add_u32 s71, s71, s63
  s_cmp_lt_u32 s47, 27
  s_cselect_b32 s71, s71, 1073741824
  v_min_u32 v40, 35, v1
  v_mul_u32_u24 v40, 0xd80, v40
  s_mov_b32 s32, s12
  s_mov_b32 s33, s13
  s_mov_b32 s34, 1990656
  s_mov_b32 s35, 0x00020000
  buffer_load_dword v254, v40, s[32:35], s71 offen
  s_mul_i32 s71, s62, 2688
  s_mul_i32 s63, s47, 41472
  s_add_u32 s71, s71, s63
  s_cmp_lt_u32 s47, 16
  s_cselect_b32 s71, s71, 1073741824
  v_min_u32 v40, 20, v1
  v_lshlrev_b32 v40, 7, v40
  s_mov_b32 s32, s14
  s_mov_b32 s33, s15
  s_mov_b32 s34, 663552
  s_mov_b32 s35, 0x00020000
  buffer_load_dword v254, v40, s[32:35], s71 offen
  s_waitcnt vmcnt(2)
f_kernel_px5:
f_kernel_core6:
  s_barrier
  ds_read_b128 v[80:83], v5 offset:0
  ds_read_b128 v[84:87], v5 offset:1024
  ds_read_b128 v[88:91], v5 offset:2048
  ds_read_b128 v[92:95], v5 offset:3072
  ds_read_b128 v[96:99], v6 offset:0
  ds_read_b128 v[100:103], v6 offset:1024
  ds_read_b128 v[16:19], v252 offset:0
  ds_read_b128 v[20:23], v252 offset:1024
  ds_read_b128 v[24:27], v252 offset:2048
  ds_read_b128 v[28:31], v252 offset:3072
  ds_read_b128 v[32:35], v252 offset:4096
  ds_read_b128 v[36:39], v252 offset:5120
  ds_read_b128 v[40:43], v252 offset:6144
  ds_read_b128 v[44:47], v252 offset:7168
  s_waitcnt lgkmcnt(13)
  v_mfma_f32_16x16x32_bf16 v[152:155], v[232:235], v[80:83], v[152:155]
  ds_read_b128 v[48:51], v252 offset:8192
  s_waitcnt lgkmcnt(13)
  v_mfma_f32_16x16x32_bf16 v[156:159], v[232:235], v[84:87], v[156:159]
  ds_read_b128 v[52:55], v252 offset:9216
  s_waitcnt lgkmcnt(13)
  v_mfma_f32_16x16x32_bf16 v[152:155], v[236:239], v[88:91], v[152:155]
  ds_read_b128 v[56:59], v252 offset:10240
  s_waitcnt lgkmcnt(13)
  v_mfma_f32_16x16x32_bf16 v[156:159], v[236:239], v[92:95], v[156:159]
  ds_read_b128 v[60:63], v252 offset:11264
  s_waitcnt lgkmcnt(13)
  v_mfma_f32_16x16x32_bf16 v[152:155], v[240:243], v[96:99], v[152:155]
  ds_read_b128 v[64:67], v252 offset:12288
  s_waitcnt lgkmcnt(13)
  v_mfma_f32_16x16x32_bf16 v[156:159], v[240:243], v[100:103], v[156:159]
  ds_read_b128 v[68:71], v252 offset:13312
  s_waitcnt lgkmcnt(13)
  v_mfma_f32_16x16x32_bf16 v[144:147], v[160:163], v[16:19], v[144:147]
  ds_read_b128 v[72:75], v252 offset:14336
  s_waitcnt lgkmcnt(13)
  v_mfma_f32_16x16x32_bf16 v[148:151], v[160:163], v[20:23], v[148:151]
  ds_read_b128 v[76:79], v252 offset:15360
  s_waitcnt lgkmcnt(13)
  v_mfma_f32_16x16x32_bf16 v[144:147], v[164:167], v[24:27], v[144:147]
  ds_read_b128 v[16:19], v252 offset:16384
  s_waitcnt lgkmcnt(13)
  v_mfma_f32_16x16x32_bf16 v[148:151], v[164:167], v[28:31], v[148:151]
  ds_read_b128 v[20:23], v252 offset:17408
  s_waitcnt lgkmcnt(13)
  v_mfma_f32_16x16x32_bf16 v[144:147], v[168:171], v[32:35], v[144:147]
  ds_read_b128 v[24:27], v252 offset:18432
  s_waitcnt lgkmcnt(13)
  v_mfma_f32_16x16x32_bf16 v[148:151], v[168:171], v[36:39], v[148:151]
  ds_read_b128 v[28:31], v252 offset:19456
  s_waitcnt lgkmcnt(13)
  v_mfma_f32_16x16x32_bf16 v[144:147], v[172:175], v[40:43], v[144:147]
  ds_read_b128 v[32:35], v252 offset:20480
  s_waitcnt lgkmcnt(13)
  v_mfma_f32_16x16x32_bf16 v[148:151], v[172:175], v[44:47], v[148:151]
  ds_read_b128 v[36:39], v252 offset:21504
  s_waitcnt lgkmcnt(13)
  v_mfma_f32_16x16x32_bf16 v[144:147], v[176:179], v[48:51], v[144:147]
  ds_read_b128 v[40:43], v252 offset:22528
  s_waitcnt lgkmcnt(13)
  v_mfma_f32_16x16x32_bf16 v[148:151], v[176:179], v[52:55], v[148:151]
  ds_read_b128 v[44:47], v252 offset:23552
  s_waitcnt lgkmcnt(13)
  v_mfma_f32_16x16x32_bf16 v[144:147], v[180:183], v[56:59], v[144:147]
  ds_read_b128 v[48:51], v252 offset:24576
  s_waitcnt lgkmcnt(13)
  v_mfma_f32_16x16x32_bf16 v[148:151], v[180:183], v[60:63], v[148:151]
  ds_read_b128 v[52:55], v252 offset:25600
  s_waitcnt lgkmcnt(13)
  v_mfma_f32_16x16x32_bf16 v[144:147], v[184:187], v[64:67], v[144:147]
  ds_read_b128 v[56:59], v252 offset:26624
  s_waitcnt lgkmcnt(13)
  v_mfma_f32_16x16x32_bf16 v[148:151], v[184:187], v[68:71], v[148:151]
  ds_read_b128 v[60:63], v252 offset:27648
  s_waitcnt lgkmcnt(13)
  v_mfma_f32_16x16x32_bf16 v[144:147], v[188:191], v[72:75], v[144:147]
  ds_read_b128 v[64:67], v252 offset:28672
  s_waitcnt lgkmcnt(13)
  v_mfma_f32_16x16x32_bf16 v[148:151], v[188:191], v[76:79], v[148:151]
  ds_read_b128 v[68:71], v252 offset:29696
  s_waitcnt lgkmcnt(13)
  v_mfma_f32_16x16x32_bf16 v[144:147], v[192:195], v[16:19], v[144:147]
  ds_read_b128 v[72:75], v252 offset:30720
  s_waitcnt lgkmcnt(13)
  v_mfma_f32_16x16x32_bf16 v[148:151], v[192:195], v[20:23], v[148:151]
  ds_read_b128 v[76:79], v252 offset:31744
  s_waitcnt lgkmcnt(13)
  v_mfma_f32_16x16x32_bf16 v[144:147], v[196:199], v[24:27], v[144:147]
  ds_read_b128 v[16:19], v252 offset:32768
  s_waitcnt lgkmcnt(13)
  v_mfma_f32_16x16x32_bf16 v[148:151], v[196:199], v[28:31], v[148:151]
  ds_read_b128 v[20:23], v252 offset:33792
  s_waitcnt lgkmcnt(13)
  v_mfma_f32_16x16x32_bf16 v[144:147], v[200:203], v[32:35], v[144:147]
  ds_read_b128 v[24:27], v252 offset:34816
  s_waitcnt lgkmcnt(13)
  v_mfma_f32_16x16x32_bf16 v[148:151], v[200:203], v[36:39], v[148:151]
  ds_read_b128 v[28:31], v252 offset:35840
  s_waitcnt lgkmcnt(13)
  v_mfma_f32_16x16x32_bf16 v[144:147], v[204:207], v[40:43], v[144:147]
  ds_write_b128 v7, v[152:155] offset:0
  s_waitcnt lgkmcnt(13)
  v_mfma_f32_16x16x32_bf16 v[148:151], v[204:207], v[44:47], v[148:151]
  ds_write_b128 v7, v[156:159] offset:1024
  s_waitcnt lgkmcnt(13)
  v_mfma_f32_16x16x32_bf16 v[144:147], v[208:211], v[48:51], v[144:147]
  s_waitcnt lgkmcnt(12)
  v_mfma_f32_16x16x32_bf16 v[148:151], v[208:211], v[52:55], v[148:151]
  s_waitcnt lgkmcnt(11)
  v_mfma_f32_16x16x32_bf16 v[144:147], v[212:215], v[56:59], v[144:147]
  s_waitcnt lgkmcnt(10)
  v_mfma_f32_16x16x32_bf16 v[148:151], v[212:215], v[60:63], v[148:151]
  s_waitcnt lgkmcnt(9)
  v_mfma_f32_16x16x32_bf16 v[144:147], v[216:219], v[64:67], v[144:147]
  s_waitcnt lgkmcnt(8)
  v_mfma_f32_16x16x32_bf16 v[148:151], v[216:219], v[68:71], v[148:151]
  s_waitcnt lgkmcnt(7)
  v_mfma_f32_16x16x32_bf16 v[144:147], v[220:223], v[72:75], v[144:147]
  s_waitcnt lgkmcnt(6)
  v_mfma_f32_16x16x32_bf16 v[148:151], v[220:223], v[76:79], v[148:151]
  s_waitcnt lgkmcnt(5)
  v_mfma_f32_16x16x32_bf16 v[144:147], v[224:227], v[16:19], v[144:147]
  s_waitcnt lgkmcnt(4)
  v_mfma_f32_16x16x32_bf16 v[148:151], v[224:227], v[20:23], v[148:151]
  s_waitcnt lgkmcnt(3)
  v_mfma_f32_16x16x32_bf16 v[144:147], v[228:231], v[24:27], v[144:147]
  s_waitcnt lgkmcnt(2)
  v_mfma_f32_16x16x32_bf16 v[148:151], v[228:231], v[28:31], v[148:151]
  s_cmp_eq_u32 s43, 2
  s_cbranch_scc1 f_kernel_fin7
  s_nop 3
  v_cvt_pk_bf16_f32 v16, v144, v145
  v_cvt_pk_bf16_f32 v17, v146, v147
  v_cvt_pk_bf16_f32 v18, v148, v149
  v_cvt_pk_bf16_f32 v19, v150, v151
  buffer_store_dwordx4 v[16:19], v8, s[24:27], s64 offen sc1
  v_mul_f32 v20, v144, v144
  v_mul_f32 v21, v148, v148
  v_fmac_f32 v20, v145, v145
  v_fmac_f32 v21, v149, v149
  v_fmac_f32 v20, v146, v146
  v_fmac_f32 v21, v150, v150
  v_fmac_f32 v20, v147, v147
  v_fmac_f32 v21, v151, v151
  ds_write_b64 v9, v[20:21]
  v_and_b32 v5, 7, v1
  v_mul_u32_u24 v10, 4112, v5
  v_bfe_u32 v6, v1, 3, 2
  v_lshl_add_u32 v10, v6, 8, v10
  v_lshrrev_b32 v7, 5, v1
  v_lshl_add_u32 v10, v7, 4, v10
  s_lshl_b32 s62, s3, 5
  s_add_u32 s62, s62, 36864
  v_add_u32 v10, s62, v10
  s_lshl_b32 s62, s3, 9
  s_add_u32 s62, s62, 69760
  v_lshl_add_u32 v9, v1, 3, s62
  v_lshlrev_b32 v8, 14, v6
  v_lshl_add_u32 v8, v7, 4, v8
  v_cmp_eq_u32 vcc, 0, v5
  v_mov_b32 v5, 1073741824
  s_nop 0
  v_cndmask_b32 v8, v5, v8, vcc
  v_and_b32 v22, 31, v1
  v_lshlrev_b32 v7, 3, v7
  v_cmp_eq_u32 vcc, 16, v22
  s_nop 1
  v_cndmask_b32 v7, v5, v7, vcc
  v_cmp_eq_u32 vcc, 3, v6
  s_cmp_eq_u32 s45, 3
  s_cselect_b64 vcc, vcc, 0
  v_cndmask_b32 v6, 1.0, 0, vcc
  s_lshl_b32 s62, s43, 1
  s_add_u32 s62, s62, s3
  s_cmp_ge_u32 s62, 2
  s_cbranch_scc1 f_kernel_wx8
  s_mul_i32 s62, s40, 18
  s_lshl_b32 s63, s3, 4
  s_add_u32 s62, s62, s63
  s_lshl_b32 s62, s62, 14
  s_lshl_b32 s63, s45, 11
  s_add_u32 s62, s62, s63
  s_lshr_b32 s63, s41, 2
  s_lshl_b32 s63, s63, 8
  s_add_u32 s62, s62, s63
  s_add_u32 s62, s62, 51380224
  s_mov_b32 s70, 0x05040100
  s_mov_b32 s71, 0x07060302
  v_lshlrev_b32 v40, 4, v2
  v_lshl_add_u32 v40, v3, 16, v40
  s_cmp_eq_u32 s3, 0
  s_cselect_b64 exec, -1, 0xffff
  s_waitcnt vmcnt(7)
  v_perm_b32 v44, v108, v104, s70
  s_waitcnt vmcnt(5)
  v_perm_b32 v45, v116, v112, s70
  s_waitcnt vmcnt(3)
  v_perm_b32 v46, v124, v120, s70
  s_waitcnt vmcnt(1)
  v_perm_b32 v47, v132, v128, s70
  buffer_store_dwordx4 v[44:47], v40, s[24:27], s62 offen sc1
  s_add_u32 s62, s62, 8192
  v_perm_b32 v48, v108, v104, s71
  v_perm_b32 v49, v116, v112, s71
  v_perm_b32 v50, v124, v120, s71
  v_perm_b32 v51, v132, v128, s71
  buffer_store_dwordx4 v[48:51], v40, s[24:27], s62 offen sc1
  s_add_u32 s62, s62, 8192
  v_perm_b32 v52, v109, v105, s70
  v_perm_b32 v53, v117, v113, s70
  v_perm_b32 v54, v125, v121, s70
  v_perm_b32 v55, v133, v129, s70
  buffer_store_dwordx4 v[52:55], v40, s[24:27], s62 offen sc1
  s_add_u32 s62, s62, 8192
  v_perm_b32 v56, v109, v105, s71
  v_perm_b32 v57, v117, v113, s71
  v_perm_b32 v58, v125, v121, s71
  v_perm_b32 v59, v133, v129, s71
  buffer_store_dwordx4 v[56:59], v40, s[24:27], s62 offen sc1
  s_add_u32 s62, s62, 8192
  s_cmp_lg_u32 s3, 0
  s_cbranch_scc1 f_kernel_wy9
  v_perm_b32 v60, v110, v106, s70
  v_perm_b32 v61, v118, v114, s70
  v_perm_b32 v62, v126, v122, s70
  v_perm_b32 v63, v134, v130, s70
  buffer_store_dwordx4 v[60:63], v40, s[24:27], s62 offen sc1
  s_add_u32 s62, s62, 8192
  v_perm_b32 v64, v110, v106, s71
  v_perm_b32 v65, v118, v114, s71
  v_perm_b32 v66, v126, v122, s71
  v_perm_b32 v67, v134, v130, s71
  buffer_store_dwordx4 v[64:67], v40, s[24:27], s62 offen sc1
  s_add_u32 s62, s62, 8192
  v_perm_b32 v68, v111, v107, s70
  v_perm_b32 v69, v119, v115, s70
  v_perm_b32 v70, v127, v123, s70
  v_perm_b32 v71, v135, v131, s70
  buffer_store_dwordx4 v[68:71], v40, s[24:27], s62 offen sc1
  s_add_u32 s62, s62, 8192
  v_perm_b32 v72, v111, v107, s71
  v_perm_b32 v73, v119, v115, s71
  v_perm_b32 v74, v127, v123, s71
  v_perm_b32 v75, v135, v131, s71
  buffer_store_dwordx4 v[72:75], v40, s[24:27], s62 offen sc1
f_kernel_wy9:
  s_mov_b64 exec, -1
f_kernel_wx8:
  s_waitcnt lgkmcnt(0)
  s_barrier
  ds_read_b128 v[24:27], v10 offset:0
  ds_read_b128 v[28:31], v10 offset:1024
  ds_read_b64 v[32:33], v9
  s_waitcnt lgkmcnt(2)
  v_add_f32_dpp v24, v24, v24 quad_perm:[1,0,3,2] row_mask:0xf bank_mask:0xf
  v_add_f32_dpp v25, v25, v25 quad_perm:[1,0,3,2] row_mask:0xf bank_mask:0xf
  v_add_f32_dpp v26, v26, v26 quad_perm:[1,0,3,2] row_mask:0xf bank_mask:0xf
  v_add_f32_dpp v27, v27, v27 quad_perm:[1,0,3,2] row_mask:0xf bank_mask:0xf
  s_waitcnt lgkmcnt(1)
  v_add_f32_dpp v28, v28, v28 quad_perm:[1,0,3,2] row_mask:0xf bank_mask:0xf
  v_add_f32_dpp v29, v29, v29 quad_perm:[1,0,3,2] row_mask:0xf bank_mask:0xf
  v_add_f32_dpp v30, v30, v30 quad_perm:[1,0,3,2] row_mask:0xf bank_mask:0xf
  v_add_f32_dpp v31, v31, v31 quad_perm:[1,0,3,2] row_mask:0xf bank_mask:0xf
  s_waitcnt lgkmcnt(0)
  v_add_f32_dpp v32, v32, v32 quad_perm:[1,0,3,2] row_mask:0xf bank_mask:0xf
  v_add_f32_dpp v33, v33, v33 quad_perm:[1,0,3,2] row_mask:0xf bank_mask:0xf
  v_add_f32_dpp v24, v24, v24 quad_perm:[2,3,0,1] row_mask:0xf bank_mask:0xf
  v_add_f32_dpp v25, v25, v25 quad_perm:[2,3,0,1] row_mask:0xf bank_mask:0xf
  v_add_f32_dpp v26, v26, v26 quad_perm:[2,3,0,1] row_mask:0xf bank_mask:0xf
  v_add_f32_dpp v27, v27, v27 quad_perm:[2,3,0,1] row_mask:0xf bank_mask:0xf
  v_add_f32_dpp v28, v28, v28 quad_perm:[2,3,0,1] row_mask:0xf bank_mask:0xf
  v_add_f32_dpp v29, v29, v29 quad_perm:[2,3,0,1] row_mask:0xf bank_mask:0xf
  v_add_f32_dpp v30, v30, v30 quad_perm:[2,3,0,1] row_mask:0xf bank_mask:0xf
  v_add_f32_dpp v31, v31, v31 quad_perm:[2,3,0,1] row_mask:0xf bank_mask:0xf
  v_add_f32_dpp v32, v32, v32 quad_perm:[2,3,0,1] row_mask:0xf bank_mask:0xf
  v_add_f32_dpp v33, v33, v33 quad_perm:[2,3,0,1] row_mask:0xf bank_mask:0xf
  v_add_f32_dpp v24, v24, v24 row_half_mirror row_mask:0xf bank_mask:0xf
  v_add_f32_dpp v25, v25, v25 row_half_mirror row_mask:0xf bank_mask:0xf
  v_add_f32_dpp v26, v26, v26 row_half_mirror row_mask:0xf bank_mask:0xf
  v_add_f32_dpp v27, v27, v27 row_half_mirror row_mask:0xf bank_mask:0xf
  v_add_f32_dpp v28, v28, v28 row_half_mirror row_mask:0xf bank_mask:0xf
  v_add_f32_dpp v29, v29, v29 row_half_mirror row_mask:0xf bank_mask:0xf
  v_add_f32_dpp v30, v30, v30 row_half_mirror row_mask:0xf bank_mask:0xf
  v_add_f32_dpp v31, v31, v31 row_half_mirror row_mask:0xf bank_mask:0xf
  v_add_f32_dpp v32, v32, v32 row_half_mirror row_mask:0xf bank_mask:0xf
  v_add_f32_dpp v33, v33, v33 row_half_mirror row_mask:0xf bank_mask:0xf
  v_cvt_pk_bf16_f32 v20, v24, v25
  v_cvt_pk_bf16_f32 v21, v26, v27
  v_cvt_pk_bf16_f32 v22, v28, v29
  v_cvt_pk_bf16_f32 v23, v30, v31
  buffer_store_dwordx4 v[20:23], v8, s[24:27], s65 offen sc1
  v_mul_f32 v27, v6, v27
  v_mul_f32 v31, v6, v31
  v_fmac_f32 v32, v24, v24
  v_fmac_f32 v33, v28, v28
  v_fmac_f32 v32, v25, v25
  v_fmac_f32 v33, v29, v29
  v_fmac_f32 v32, v26, v26
  v_fmac_f32 v33, v30, v30
  v_fmac_f32 v32, v27, v27
  v_fmac_f32 v33, v31, v31
  s_nop 0
  v_add_f32_dpp v32, v32, v32 row_mirror row_mask:0xf bank_mask:0xf
  v_add_f32_dpp v33, v33, v33 row_mirror row_mask:0xf bank_mask:0xf
  s_nop 0
  v_add_f32_dpp v32, v32, v32 row_bcast:15 row_mask:0xa bank_mask:0xf
  v_add_f32_dpp v33, v33, v33 row_bcast:15 row_mask:0xa bank_mask:0xf
  buffer_store_dwordx2 v[32:33], v7, s[24:27], s66 offen sc1
  s_waitcnt vmcnt(0)
  s_barrier
  s_cmp_lg_u32 s3, 7
  s_cbranch_scc1 f_kernel_sig10
  s_add_u32 s62, s50, s52
  v_lshlrev_b32 v12, 12, v1
  v_mov_b32 v13, s42
  s_mov_b64 exec, 0xff
  buffer_store_dword v13, v12, s[24:27], s62 offen sc1
  s_mov_b64 exec, -1
f_kernel_sig10:
  s_cmp_ge_u32 s46, 144
  s_cbranch_scc1 f_kernel_hlp11
  s_and_b32 s62, s3, 3
  s_lshr_b32 s63, s3, 2
  s_lshl_b32 s64, s62, 4
  v_add_u32 v9, s64, v2
  v_mul_u32_u24 v7, 1088, v3
  v_lshl_add_u32 v7, v9, 2, v7
  v_mul_u32_u24 v8, 272, v2
  v_lshl_add_u32 v8, v3, 4, v8
  s_mul_i32 s64, s63, 4352
  v_add_u32 v7, s64, v7
  v_add_u32 v8, s64, v8
  v_add_u32 v5, s64, v7
  v_add_u32 v6, s64, v8
  s_lshl_b32 s64, s46, 14
  s_add_u32 s64, s64, s48
  s_lshl_b32 s65, s63, 13
  s_add_u32 s64, s64, s65
  s_lshl_b32 s65, s62, 8
  s_add_u32 s64, s64, s65
  s_add_u32 s65, s64, 2359296
  s_lshl_b32 s68, s63, 12
  s_add_u32 s68, s68, s51
  s_lshl_b32 s62, s62, 7
  s_add_u32 s68, s68, s62
  s_add_u32 s69, s68, 8192
  s_add_u32 s70, s68, 16384
  s_add_u32 s71, s68, 24576
  s_cmp_eq_u32 s46, 143
  s_cselect_b32 s66, 0, 1.0
  s_lshl_b32 s73, s46, 14
  s_lshl_b32 s62, s3, 11
  s_add_u32 s73, s73, s62
  s_add_u32 s73, s73, 51380224
  v_lshlrev_b32 v10, 3, v2
  v_lshl_add_u32 v10, v3, 10, v10
  v_lshlrev_b32 v9, 1, v10
  s_mov_b32 s72, 0x45e38e39
  v_mov_b32 v172, 0x4227c5ac
  s_cmp_eq_u32 s43, 0
  s_cbranch_scc1 f_kernel_wl17
  buffer_load_dwordx4 v[152:155], v4, s[24:27], s73 offen offset:0 sc1
  buffer_load_dwordx4 v[156:159], v4, s[24:27], s73 offen offset:1024 sc1
f_kernel_wl17:
  s_and_b32 s62, s3, 3
  s_lshl_b32 s62, s62, 4
  v_add_u32 v184, s62, v2
  v_cvt_f32_u32 v184, v184
  v_lshlrev_b32 v185, 2, v3
  v_cvt_f32_u32 v185, v185
  v_mul_f32 v186, 0x3c800000, v184
  v_mul_f32 v187, v186, v185
  v_mov_b32 v128, v187
  v_fmamk_f32 v129, v186, 0x3f800000, v187
  v_fmamk_f32 v130, v186, 0x40000000, v187
  v_fmamk_f32 v131, v186, 0x40400000, v187
  v_sin_f32 v132, v128
  v_cos_f32 v128, v128
  v_sin_f32 v133, v129
  v_cos_f32 v129, v129
  v_sin_f32 v134, v130
  v_cos_f32 v130, v130
  v_sin_f32 v135, v131
  v_cos_f32 v131, v131
  v_cvt_pk_bf16_f32 v56, v128, v132
  v_cvt_pk_bf16_f32 v60, -v132, v128
  v_cvt_pk_bf16_f32 v57, v129, v133
  v_cvt_pk_bf16_f32 v61, -v133, v129
  v_cvt_pk_bf16_f32 v58, v130, v134
  v_cvt_pk_bf16_f32 v62, -v134, v130
  v_cvt_pk_bf16_f32 v59, v131, v135
  v_cvt_pk_bf16_f32 v63, -v135, v131
  v_fmamk_f32 v128, v186, 0x41800000, v187
  v_fmamk_f32 v129, v186, 0x41880000, v187
  v_fmamk_f32 v130, v186, 0x41900000, v187
  v_fmamk_f32 v131, v186, 0x41980000, v187
  v_sin_f32 v132, v128
  v_cos_f32 v128, v128
  v_sin_f32 v133, v129
  v_cos_f32 v129, v129
  v_sin_f32 v134, v130
  v_cos_f32 v130, v130
  v_sin_f32 v135, v131
  v_cos_f32 v131, v131
  v_cvt_pk_bf16_f32 v64, v128, v132
  v_cvt_pk_bf16_f32 v68, -v132, v128
  v_cvt_pk_bf16_f32 v65, v129, v133
  v_cvt_pk_bf16_f32 v69, -v133, v129
  v_cvt_pk_bf16_f32 v66, v130, v134
  v_cvt_pk_bf16_f32 v70, -v134, v130
  v_cvt_pk_bf16_f32 v67, v131, v135
  v_cvt_pk_bf16_f32 v71, -v135, v131
  v_fmamk_f32 v128, v186, 0x42000000, v187
  v_fmamk_f32 v129, v186, 0x42040000, v187
  v_fmamk_f32 v130, v186, 0x42080000, v187
  v_fmamk_f32 v131, v186, 0x420c0000, v187
  v_sin_f32 v132, v128
  v_cos_f32 v128, v128
  v_sin_f32 v133, v129
  v_cos_f32 v129, v129
  v_sin_f32 v134, v130
  v_cos_f32 v130, v130
  v_sin_f32 v135, v131
  v_cos_f32 v131, v131
  v_cvt_pk_bf16_f32 v72, v128, v132
  v_cvt_pk_bf16_f32 v76, -v132, v128
  v_cvt_pk_bf16_f32 v73, v129, v133
  v_cvt_pk_bf16_f32 v77, -v133, v129
  v_cvt_pk_bf16_f32 v74, v130, v134
  v_cvt_pk_bf16_f32 v78, -v134, v130
  v_cvt_pk_bf16_f32 v75, v131, v135
  v_cvt_pk_bf16_f32 v79, -v135, v131
  v_fmamk_f32 v128, v186, 0x42400000, v187
  v_fmamk_f32 v129, v186, 0x42440000, v187
  v_fmamk_f32 v130, v186, 0x42480000, v187
  v_fmamk_f32 v131, v186, 0x424c0000, v187
  v_sin_f32 v132, v128
  v_cos_f32 v128, v128
  v_sin_f32 v133, v129
  v_cos_f32 v129, v129
  v_sin_f32 v134, v130
  v_cos_f32 v130, v130
  v_sin_f32 v135, v131
  v_cos_f32 v131, v131
  v_cvt_pk_bf16_f32 v80, v128, v132
  v_cvt_pk_bf16_f32 v84, -v132, v128
  v_cvt_pk_bf16_f32 v81, v129, v133
  v_cvt_pk_bf16_f32 v85, -v133, v129
  v_cvt_pk_bf16_f32 v82, v130, v134
  v_cvt_pk_bf16_f32 v86, -v134, v130
  v_cvt_pk_bf16_f32 v83, v131, v135
  v_cvt_pk_bf16_f32 v87, -v135, v131
f_kernel_c118:
  s_cmp_lg_u32 s3, 7
  s_cbranch_scc1 f_kernel_wsk19
  s_add_u32 s62, s50, s56
  v_lshlrev_b32 v11, 6, v1
  s_mov_b32 s63, 0
f_kernel_wlp20:
  s_add_u32 s63, s63, 1
  buffer_load_dwordx4 v[12:15], v11, s[24:27], s62 offen sc1
  s_waitcnt vmcnt(0)
  v_xor_b32 v12, s42, v12
  v_xor_b32 v13, s42, v13
  v_xor_b32 v14, s42, v14
  v_xor_b32 v15, s42, v15
  v_or3_b32 v12, v12, v13, v14
  v_or_b32 v12, v12, v15
  v_cmp_ne_u32 vcc, 0, v12
  s_nop 4
  s_cbranch_vccz f_kernel_wdn21
  s_cmp_lt_u32 s63, 20000
  s_cbranch_scc1 f_kernel_wlp20
f_kernel_wdn21:
  s_mov_b64 exec, -1
f_kernel_wsk19:
  s_barrier
  buffer_load_dwordx2 v[24:25], v10, s[24:27], s68 offen offset:0 sc1
  buffer_load_dwordx2 v[26:27], v10, s[24:27], s69 offen offset:0 sc1
  buffer_load_dwordx2 v[28:29], v10, s[24:27], s70 offen offset:0 sc1
  buffer_load_dwordx2 v[30:31], v10, s[24:27], s71 offen offset:0 sc1
  buffer_load_dwordx4 v[16:19], v9, s[24:27], s64 offen offset:0 sc1
  buffer_load_dwordx2 v[32:33], v10, s[24:27], s68 offen offset:512 sc1
  buffer_load_dwordx2 v[34:35], v10, s[24:27], s69 offen offset:512 sc1
  buffer_load_dwordx2 v[36:37], v10, s[24:27], s70 offen offset:512 sc1
  buffer_load_dwordx2 v[38:39], v10, s[24:27], s71 offen offset:512 sc1
  buffer_load_dwordx4 v[20:23], v9, s[24:27], s64 offen offset:1024 sc1
  s_cmp_lg_u32 s43, 0
  s_cbranch_scc1 f_kernel_wl22
  buffer_load_dwordx4 v[152:155], v4, s[24:27], s73 offen offset:0 sc1
  buffer_load_dwordx4 v[156:159], v4, s[24:27], s73 offen offset:1024 sc1
f_kernel_wl22:
  s_and_b32 s62, s3, 3
  s_lshl_b32 s62, s62, 4
  v_add_u32 v184, s62, v2
  v_cvt_f32_u32 v184, v184
  v_lshlrev_b32 v185, 2, v3
  v_cvt_f32_u32 v185, v185
  v_mul_f32 v186, 0x3a000000, v184
  v_mul_f32 v187, v186, v185
  v_mov_b32 v88, v187
  v_fmamk_f32 v89, v186, 0x3f800000, v187
  v_fmamk_f32 v90, v186, 0x40000000, v187
  v_fmamk_f32 v91, v186, 0x40400000, v187
  v_fmamk_f32 v92, v186, 0x41800000, v187
  v_fmamk_f32 v93, v186, 0x41880000, v187
  v_fmamk_f32 v94, v186, 0x41900000, v187
  v_fmamk_f32 v95, v186, 0x41980000, v187
  v_sin_f32 v96, v88
  v_cos_f32 v88, v88
  v_sin_f32 v97, v89
  v_cos_f32 v89, v89
  v_sin_f32 v98, v90
  v_cos_f32 v90, v90
  v_sin_f32 v99, v91
  v_cos_f32 v91, v91
  v_sin_f32 v100, v92
  v_cos_f32 v92, v92
  v_sin_f32 v101, v93
  v_cos_f32 v93, v93
  v_sin_f32 v102, v94
  v_cos_f32 v94, v94
  v_sin_f32 v103, v95
  v_cos_f32 v95, v95
  v_cvt_f32_u32 v184, v2
  v_mul_f32 v186, 0x3d000000, v184
  v_mul_f32 v187, v186, v185
  v_mov_b32 v128, v187
  v_fmamk_f32 v129, v186, 0x3f800000, v187
  v_fmamk_f32 v130, v186, 0x40000000, v187
  v_fmamk_f32 v131, v186, 0x40400000, v187
  v_fmamk_f32 v132, v186, 0x41800000, v187
  v_fmamk_f32 v133, v186, 0x41880000, v187
  v_fmamk_f32 v134, v186, 0x41900000, v187
  v_fmamk_f32 v135, v186, 0x41980000, v187
  v_sin_f32 v136, v128
  v_cos_f32 v128, v128
  v_sin_f32 v137, v129
  v_cos_f32 v129, v129
  v_sin_f32 v138, v130
  v_cos_f32 v130, v130
  v_sin_f32 v139, v131
  v_cos_f32 v131, v131
  v_sin_f32 v140, v132
  v_cos_f32 v132, v132
  v_sin_f32 v141, v133
  v_cos_f32 v133, v133
  v_sin_f32 v142, v134
  v_cos_f32 v134, v134
  v_sin_f32 v143, v135
  v_cos_f32 v135, v135
  v_cvt_pk_bf16_f32 v104, v128, v129
  v_cvt_pk_bf16_f32 v116, v128, -v129
  v_cvt_pk_bf16_f32 v108, v136, v137
  v_cvt_pk_bf16_f32 v120, v136, -v137
  v_cvt_pk_bf16_f32 v112, -v136, -v137
  v_cvt_pk_bf16_f32 v124, -v136, v137
  v_cvt_pk_bf16_f32 v105, v130, v131
  v_cvt_pk_bf16_f32 v117, v130, -v131
  v_cvt_pk_bf16_f32 v109, v138, v139
  v_cvt_pk_bf16_f32 v121, v138, -v139
  v_cvt_pk_bf16_f32 v113, -v138, -v139
  v_cvt_pk_bf16_f32 v125, -v138, v139
  v_cvt_pk_bf16_f32 v106, v132, v133
  v_cvt_pk_bf16_f32 v118, v132, -v133
  v_cvt_pk_bf16_f32 v110, v140, v141
  v_cvt_pk_bf16_f32 v122, v140, -v141
  v_cvt_pk_bf16_f32 v114, -v140, -v141
  v_cvt_pk_bf16_f32 v126, -v140, v141
  v_cvt_pk_bf16_f32 v107, v134, v135
  v_cvt_pk_bf16_f32 v119, v134, -v135
  v_cvt_pk_bf16_f32 v111, v142, v143
  v_cvt_pk_bf16_f32 v123, v142, -v143
  v_cvt_pk_bf16_f32 v115, -v142, -v143
  v_cvt_pk_bf16_f32 v127, -v142, v143
  s_waitcnt vmcnt(8)
  v_pk_add_f32 v[24:25], v[24:25], v[26:27]
  s_waitcnt vmcnt(6)
  v_pk_add_f32 v[28:29], v[28:29], v[30:31]
  v_pk_add_f32 v[24:25], v[24:25], v[28:29]
  v_fma_f32 v24, v24, s72, v172
  v_fma_f32 v25, v25, s72, v172
  v_rsq_f32 v26, v24
  v_rsq_f32 v28, v25
  s_waitcnt vmcnt(5)
  v_lshlrev_b32 v176, 16, v16
  v_and_b32 v177, s60, v16
  v_lshlrev_b32 v178, 16, v17
  v_and_b32 v179, s60, v17
  v_mul_f32 v27, s66, v26
  v_pk_mul_f32 v[40:41], v[176:177], v[26:27] op_sel_hi:[1,0]
  v_pk_mul_f32 v[42:43], v[178:179], v[26:27]
  v_cvt_pk_bf16_f32 v40, v40, v41
  ds_write_b32 v7, v40 offset:0
  v_cvt_pk_bf16_f32 v42, v42, v43
  ds_write_b32 v7, v42 offset:8704
  v_lshlrev_b32 v180, 16, v18
  v_and_b32 v181, s60, v18
  v_lshlrev_b32 v182, 16, v19
  v_and_b32 v183, s60, v19
  v_mul_f32 v29, s66, v28
  v_pk_mul_f32 v[44:45], v[180:181], v[28:29] op_sel_hi:[1,0]
  v_pk_mul_f32 v[46:47], v[182:183], v[28:29]
  v_cvt_pk_bf16_f32 v44, v44, v45
  ds_write_b32 v7, v44 offset:272
  v_cvt_pk_bf16_f32 v46, v46, v47
  ds_write_b32 v7, v46 offset:8976
  s_waitcnt vmcnt(3)
  v_pk_add_f32 v[32:33], v[32:33], v[34:35]
  s_waitcnt vmcnt(1)
  v_pk_add_f32 v[36:37], v[36:37], v[38:39]
  v_pk_add_f32 v[32:33], v[32:33], v[36:37]
  v_fma_f32 v32, v32, s72, v172
  v_fma_f32 v33, v33, s72, v172
  v_rsq_f32 v34, v32
  v_rsq_f32 v36, v33
  s_waitcnt vmcnt(0)
  v_lshlrev_b32 v184, 16, v20
  v_and_b32 v185, s60, v20
  v_lshlrev_b32 v186, 16, v21
  v_and_b32 v187, s60, v21
  v_mul_f32 v35, s66, v34
  v_pk_mul_f32 v[48:49], v[184:185], v[34:35] op_sel_hi:[1,0]
  v_pk_mul_f32 v[50:51], v[186:187], v[34:35]
  v_cvt_pk_bf16_f32 v48, v48, v49
  ds_write_b32 v7, v48 offset:544
  v_cvt_pk_bf16_f32 v50, v50, v51
  ds_write_b32 v7, v50 offset:9248
  v_lshlrev_b32 v188, 16, v22
  v_and_b32 v189, s60, v22
  v_lshlrev_b32 v190, 16, v23
  v_and_b32 v191, s60, v23
  v_mul_f32 v37, s66, v36
  v_pk_mul_f32 v[52:53], v[188:189], v[36:37] op_sel_hi:[1,0]
  v_pk_mul_f32 v[54:55], v[190:191], v[36:37]
  v_cvt_pk_bf16_f32 v52, v52, v53
  ds_write_b32 v7, v52 offset:816
  v_cvt_pk_bf16_f32 v54, v54, v55
  ds_write_b32 v7, v54 offset:9520
  s_waitcnt lgkmcnt(0)
  s_barrier
  ds_read_b128 v[24:27], v6 offset:0
  ds_read_b128 v[28:31], v6 offset:4352
  ds_read_b128 v[32:35], v6 offset:64
  ds_read_b128 v[36:39], v6 offset:4416
  ds_read_b128 v[40:43], v6 offset:128
  ds_read_b128 v[44:47], v6 offset:4480
  ds_read_b128 v[48:51], v6 offset:192
  ds_read_b128 v[52:55], v6 offset:4544
  s_waitcnt lgkmcnt(7)
  v_mfma_f32_16x16x32_bf16 v[128:131], v[24:27], v[56:59], 0
  v_mfma_f32_16x16x32_bf16 v[136:139], v[24:27], v[60:63], 0
  s_waitcnt lgkmcnt(6)
  v_mfma_f32_16x16x32_bf16 v[132:135], v[28:31], v[56:59], 0
  v_mfma_f32_16x16x32_bf16 v[140:143], v[28:31], v[60:63], 0
  s_waitcnt lgkmcnt(5)
  v_mfma_f32_16x16x32_bf16 v[128:131], v[32:35], v[64:67], v[128:131]
  v_mfma_f32_16x16x32_bf16 v[136:139], v[32:35], v[68:71], v[136:139]
  s_waitcnt lgkmcnt(4)
  v_mfma_f32_16x16x32_bf16 v[132:135], v[36:39], v[64:67], v[132:135]
  v_mfma_f32_16x16x32_bf16 v[140:143], v[36:39], v[68:71], v[140:143]
  s_waitcnt lgkmcnt(3)
  v_mfma_f32_16x16x32_bf16 v[128:131], v[40:43], v[72:75], v[128:131]
  v_mfma_f32_16x16x32_bf16 v[136:139], v[40:43], v[76:79], v[136:139]
  s_waitcnt lgkmcnt(2)
  v_mfma_f32_16x16x32_bf16 v[132:135], v[44:47], v[72:75], v[132:135]
  v_mfma_f32_16x16x32_bf16 v[140:143], v[44:47], v[76:79], v[140:143]
  s_waitcnt lgkmcnt(1)
  v_mfma_f32_16x16x32_bf16 v[128:131], v[48:51], v[80:83], v[128:131]
  v_mfma_f32_16x16x32_bf16 v[136:139], v[48:51], v[84:87], v[136:139]
  s_waitcnt lgkmcnt(0)
  v_mfma_f32_16x16x32_bf16 v[132:135], v[52:55], v[80:83], v[132:135]
  v_mfma_f32_16x16x32_bf16 v[140:143], v[52:55], v[84:87], v[140:143]
  v_lshlrev_b32 v144, 16, v152
  v_and_b32 v152, s60, v152
  v_lshlrev_b32 v145, 16, v153
  v_and_b32 v153, s60, v153
  v_lshlrev_b32 v146, 16, v154
  v_and_b32 v154, s60, v154
  v_lshlrev_b32 v147, 16, v155
  v_and_b32 v155, s60, v155
  v_lshlrev_b32 v148, 16, v156
  v_and_b32 v156, s60, v156
  v_lshlrev_b32 v149, 16, v157
  v_and_b32 v157, s60, v157
  v_lshlrev_b32 v150, 16, v158
  v_and_b32 v158, s60, v158
  v_lshlrev_b32 v151, 16, v159
  v_and_b32 v159, s60, v159
  v_pk_mul_f32 v[168:169], v[136:137], v[96:97]
  v_pk_mul_f32 v[170:171], v[128:129], v[96:97]
  v_pk_fma_f32 v[128:129], v[128:129], v[88:89], v[168:169]
  v_pk_fma_f32 v[136:137], v[136:137], v[88:89], v[170:171] neg_lo:[0,0,1] neg_hi:[0,0,1]
  v_cvt_pk_bf16_f32 v160, v128, v129
  v_cvt_pk_bf16_f32 v164, v136, v137
  v_pk_mul_f32 v[168:169], v[138:139], v[98:99]
  v_pk_mul_f32 v[170:171], v[130:131], v[98:99]
  v_pk_fma_f32 v[130:131], v[130:131], v[90:91], v[168:169]
  v_pk_fma_f32 v[138:139], v[138:139], v[90:91], v[170:171] neg_lo:[0,0,1] neg_hi:[0,0,1]
  v_cvt_pk_bf16_f32 v161, v130, v131
  v_cvt_pk_bf16_f32 v165, v138, v139
  v_pk_mul_f32 v[168:169], v[140:141], v[100:101]
  v_pk_mul_f32 v[170:171], v[132:133], v[100:101]
  v_pk_fma_f32 v[132:133], v[132:133], v[92:93], v[168:169]
  v_pk_fma_f32 v[140:141], v[140:141], v[92:93], v[170:171] neg_lo:[0,0,1] neg_hi:[0,0,1]
  v_cvt_pk_bf16_f32 v162, v132, v133
  v_cvt_pk_bf16_f32 v166, v140, v141
  v_pk_mul_f32 v[168:169], v[142:143], v[102:103]
  v_pk_mul_f32 v[170:171], v[134:135], v[102:103]
  v_pk_fma_f32 v[134:135], v[134:135], v[94:95], v[168:169]
  v_pk_fma_f32 v[142:143], v[142:143], v[94:95], v[170:171] neg_lo:[0,0,1] neg_hi:[0,0,1]
  v_cvt_pk_bf16_f32 v163, v134, v135
  v_cvt_pk_bf16_f32 v167, v142, v143
  s_nop 0
  v_mfma_f32_16x16x32_bf16 v[128:131], v[104:107], v[160:163], 0
  v_mfma_f32_16x16x32_bf16 v[136:139], v[104:107], v[164:167], 0
  v_mfma_f32_16x16x32_bf16 v[132:135], v[116:119], v[160:163], 0
  v_mfma_f32_16x16x32_bf16 v[140:143], v[116:119], v[164:167], 0
  v_mfma_f32_16x16x32_bf16 v[128:131], v[108:111], v[164:167], v[128:131]
  v_mfma_f32_16x16x32_bf16 v[136:139], v[112:115], v[160:163], v[136:139]
  v_mfma_f32_16x16x32_bf16 v[132:135], v[120:123], v[164:167], v[132:135]
  v_mfma_f32_16x16x32_bf16 v[140:143], v[124:127], v[160:163], v[140:143]
  s_nop 5
  v_pk_mul_f32 v[168:169], v[136:137], v[152:153]
  v_pk_mul_f32 v[170:171], v[128:129], v[152:153]
  v_pk_fma_f32 v[128:129], v[128:129], v[144:145], v[168:169] neg_lo:[0,0,1] neg_hi:[0,0,1]
  v_pk_fma_f32 v[136:137], v[136:137], v[144:145], v[170:171]
  v_cvt_pk_bf16_f32 v160, v128, v129
  v_cvt_pk_bf16_f32 v164, v136, v137
  v_pk_mul_f32 v[168:169], v[138:139], v[154:155]
  v_pk_mul_f32 v[170:171], v[130:131], v[154:155]
  v_pk_fma_f32 v[130:131], v[130:131], v[146:147], v[168:169] neg_lo:[0,0,1] neg_hi:[0,0,1]
  v_pk_fma_f32 v[138:139], v[138:139], v[146:147], v[170:171]
  v_cvt_pk_bf16_f32 v161, v130, v131
  v_cvt_pk_bf16_f32 v165, v138, v139
  v_pk_mul_f32 v[168:169], v[140:141], v[156:157]
  v_pk_mul_f32 v[170:171], v[132:133], v[156:157]
  v_pk_fma_f32 v[132:133], v[132:133], v[148:149], v[168:169] neg_lo:[0,0,1] neg_hi:[0,0,1]
  v_pk_fma_f32 v[140:141], v[140:141], v[148:149], v[170:171]
  v_cvt_pk_bf16_f32 v162, v132, v133
  v_cvt_pk_bf16_f32 v166, v140, v141
  v_pk_mul_f32 v[168:169], v[142:143], v[158:159]
  v_pk_mul_f32 v[170:171], v[134:135], v[158:159]
  v_pk_fma_f32 v[134:135], v[134:135], v[150:151], v[168:169] neg_lo:[0,0,1] neg_hi:[0,0,1]
  v_pk_fma_f32 v[142:143], v[142:143], v[150:151], v[170:171]
  v_cvt_pk_bf16_f32 v163, v134, v135
  v_cvt_pk_bf16_f32 v167, v142, v143
  s_nop 0
  v_mfma_f32_16x16x32_bf16 v[128:131], v[104:107], v[160:163], 0
  v_mfma_f32_16x16x32_bf16 v[136:139], v[104:107], v[164:167], 0
  v_mfma_f32_16x16x32_bf16 v[132:135], v[116:119], v[160:163], 0
  v_mfma_f32_16x16x32_bf16 v[140:143], v[116:119], v[164:167], 0
  v_mfma_f32_16x16x32_bf16 v[128:131], v[112:115], v[164:167], v[128:131]
  v_mfma_f32_16x16x32_bf16 v[136:139], v[108:111], v[160:163], v[136:139]
  v_mfma_f32_16x16x32_bf16 v[132:135], v[124:127], v[164:167], v[132:135]
  v_mfma_f32_16x16x32_bf16 v[140:143], v[120:123], v[160:163], v[140:143]
  s_nop 5
  v_pk_mul_f32 v[168:169], v[136:137], v[96:97]
  v_pk_mul_f32 v[170:171], v[128:129], v[96:97]
  v_pk_fma_f32 v[128:129], v[128:129], v[88:89], v[168:169] neg_lo:[0,0,1] neg_hi:[0,0,1]
  v_pk_fma_f32 v[136:137], v[136:137], v[88:89], v[170:171]
  v_cvt_pk_bf16_f32 v160, v128, -v136
  ds_write_b32 v5, v160 offset:17408
  v_cvt_pk_bf16_f32 v161, v129, -v137
  ds_write_b32 v5, v161 offset:17680
  v_pk_mul_f32 v[168:169], v[138:139], v[98:99]
  v_pk_mul_f32 v[170:171], v[130:131], v[98:99]
  v_pk_fma_f32 v[130:131], v[130:131], v[90:91], v[168:169] neg_lo:[0,0,1] neg_hi:[0,0,1]
  v_pk_fma_f32 v[138:139], v[138:139], v[90:91], v[170:171]
  v_cvt_pk_bf16_f32 v162, v130, -v138
  ds_write_b32 v5, v162 offset:17952
  v_cvt_pk_bf16_f32 v163, v131, -v139
  ds_write_b32 v5, v163 offset:18224
  v_pk_mul_f32 v[168:169], v[140:141], v[100:101]
  v_pk_mul_f32 v[170:171], v[132:133], v[100:101]
  v_pk_fma_f32 v[132:133], v[132:133], v[92:93], v[168:169] neg_lo:[0,0,1] neg_hi:[0,0,1]
  v_pk_fma_f32 v[140:141], v[140:141], v[92:93], v[170:171]
  v_cvt_pk_bf16_f32 v164, v132, -v140
  ds_write_b32 v5, v164 offset:21760
  v_cvt_pk_bf16_f32 v165, v133, -v141
  ds_write_b32 v5, v165 offset:22032
  v_pk_mul_f32 v[168:169], v[142:143], v[102:103]
  v_pk_mul_f32 v[170:171], v[134:135], v[102:103]
  v_pk_fma_f32 v[134:135], v[134:135], v[94:95], v[168:169] neg_lo:[0,0,1] neg_hi:[0,0,1]
  v_pk_fma_f32 v[142:143], v[142:143], v[94:95], v[170:171]
  v_cvt_pk_bf16_f32 v166, v134, -v142
  ds_write_b32 v5, v166 offset:22304
  v_cvt_pk_bf16_f32 v167, v135, -v143
  ds_write_b32 v5, v167 offset:22576
  s_waitcnt lgkmcnt(0)
  s_barrier
  ds_read_b128 v[24:27], v8 offset:17408
  ds_read_b128 v[28:31], v8 offset:26112
  ds_read_b128 v[32:35], v8 offset:17472
  ds_read_b128 v[36:39], v8 offset:26176
  ds_read_b128 v[40:43], v8 offset:17536
  ds_read_b128 v[44:47], v8 offset:26240
  ds_read_b128 v[48:51], v8 offset:17600
  ds_read_b128 v[52:55], v8 offset:26304
  s_waitcnt lgkmcnt(7)
  v_mfma_f32_16x16x32_bf16 v[128:131], v[24:27], v[56:59], 0
  v_mfma_f32_16x16x32_bf16 v[136:139], v[24:27], v[60:63], 0
  s_waitcnt lgkmcnt(6)
  v_mfma_f32_16x16x32_bf16 v[132:135], v[28:31], v[56:59], 0
  v_mfma_f32_16x16x32_bf16 v[140:143], v[28:31], v[60:63], 0
  s_waitcnt lgkmcnt(5)
  v_mfma_f32_16x16x32_bf16 v[128:131], v[32:35], v[64:67], v[128:131]
  v_mfma_f32_16x16x32_bf16 v[136:139], v[32:35], v[68:71], v[136:139]
  s_waitcnt lgkmcnt(4)
  v_mfma_f32_16x16x32_bf16 v[132:135], v[36:39], v[64:67], v[132:135]
  v_mfma_f32_16x16x32_bf16 v[140:143], v[36:39], v[68:71], v[140:143]
  s_waitcnt lgkmcnt(3)
  v_mfma_f32_16x16x32_bf16 v[128:131], v[40:43], v[72:75], v[128:131]
  v_mfma_f32_16x16x32_bf16 v[136:139], v[40:43], v[76:79], v[136:139]
  s_waitcnt lgkmcnt(2)
  v_mfma_f32_16x16x32_bf16 v[132:135], v[44:47], v[72:75], v[132:135]
  v_mfma_f32_16x16x32_bf16 v[140:143], v[44:47], v[76:79], v[140:143]
  s_waitcnt lgkmcnt(1)
  v_mfma_f32_16x16x32_bf16 v[128:131], v[48:51], v[80:83], v[128:131]
  v_mfma_f32_16x16x32_bf16 v[136:139], v[48:51], v[84:87], v[136:139]
  s_waitcnt lgkmcnt(0)
  v_mfma_f32_16x16x32_bf16 v[132:135], v[52:55], v[80:83], v[132:135]
  v_mfma_f32_16x16x32_bf16 v[140:143], v[52:55], v[84:87], v[140:143]
  s_nop 3
  v_add_f32 v176, v176, v128
  v_sub_f32 v177, v177, v136
  v_cvt_pk_bf16_f32 v16, v176, v177
  v_add_f32 v178, v178, v132
  v_fma_f32 v179, -v140, s66, v179
  v_cvt_pk_bf16_f32 v17, v178, v179
  v_add_f32 v180, v180, v129
  v_sub_f32 v181, v181, v137
  v_cvt_pk_bf16_f32 v18, v180, v181
  v_add_f32 v182, v182, v133
  v_fma_f32 v183, -v141, s66, v183
  v_cvt_pk_bf16_f32 v19, v182, v183
  buffer_store_dwordx4 v[16:19], v9, s[24:27], s65 offen offset:0 sc1
  v_add_f32 v184, v184, v130
  v_sub_f32 v185, v185, v138
  v_cvt_pk_bf16_f32 v20, v184, v185
  v_add_f32 v186, v186, v134
  v_fma_f32 v187, -v142, s66, v187
  v_cvt_pk_bf16_f32 v21, v186, v187
  v_add_f32 v188, v188, v131
  v_sub_f32 v189, v189, v139
  v_cvt_pk_bf16_f32 v22, v188, v189
  v_add_f32 v190, v190, v135
  v_fma_f32 v191, -v143, s66, v191
  v_cvt_pk_bf16_f32 v23, v190, v191
  buffer_store_dwordx4 v[20:23], v9, s[24:27], s65 offen offset:1024 sc1
  s_branch f_kernel_jn12
f_kernel_hlp11:
  s_cmp_lg_u32 s43, 0
  s_cbranch_scc1 f_kernel_h315
  s_cmp_ge_u32 s47, 27
  s_cbranch_scc1 f_kernel_jn12
  v_lshrrev_b32 v40, 3, v1
  v_mul_u32_u24 v42, 0xd80, v40
  v_and_b32 v40, 2, v40
  v_and_b32 v41, 7, v1
  v_xor_b32 v40, v40, v41
  s_and_b32 s62, s3, 1
  s_lshl_b32 s63, s62, 2
  v_xor_b32 v40, s63, v40
  v_lshl_add_u32 v40, v40, 4, v42
  s_lshr_b32 s63, s3, 1
  s_mul_i32 s63, s63, 18
  s_add_u32 s62, s62, s63
  s_lshl_b32 s63, s47, 7
  s_mul_i32 s75, s62, 27648
  s_add_u32 s75, s75, s63
  s_lshl_b32 s62, s62, 10
  s_add_u32 m0, s62, 74240
  s_mov_b32 s32, s12
  s_mov_b32 s33, s13
  s_mov_b32 s34, 1990656
  s_mov_b32 s35, 0x00020000
  buffer_load_dwordx4 v40, s[32:35], s75 offen lds
  s_add_u32 s75, s75, 55296
  s_add_u32 m0, m0, 2048
  s_nop 0
  buffer_load_dwordx4 v40, s[32:35], s75 offen lds
  s_add_u32 s75, s75, 55296
  s_add_u32 m0, m0, 2048
  s_nop 0
  buffer_load_dwordx4 v40, s[32:35], s75 offen lds
  s_add_u32 s75, s75, 55296
  s_add_u32 m0, m0, 2048
  s_nop 0
  buffer_load_dwordx4 v40, s[32:35], s75 offen lds
  s_add_u32 s75, s75, 55296
  s_add_u32 m0, m0, 2048
  s_nop 0
  buffer_load_dwordx4 v40, s[32:35], s75 offen lds
  s_add_u32 s75, s75, 55296
  s_add_u32 m0, m0, 2048
  s_nop 0
  buffer_load_dwordx4 v40, s[32:35], s75 offen lds
  s_add_u32 s75, s75, 55296
  s_add_u32 m0, m0, 2048
  s_nop 0
  buffer_load_dwordx4 v40, s[32:35], s75 offen lds
  s_add_u32 s75, s75, 55296
  s_add_u32 m0, m0, 2048
  s_nop 0
  buffer_load_dwordx4 v40, s[32:35], s75 offen lds
  s_add_u32 s75, s75, 55296
  s_add_u32 m0, m0, 2048
  s_nop 0
  buffer_load_dwordx4 v40, s[32:35], s75 offen lds
f_kernel_h113:
  v_lshrrev_b32 v5, 2, v2
  v_lshl_add_u32 v5, v3, 3, v5
  v_lshlrev_b32 v5, 7, v5
  v_and_b32 v6, 3, v2
  v_lshl_add_u32 v5, v6, 3, v5
  v_add_u32 v5, 74240, v5
  v_lshrrev_b32 v6, 3, v2
  v_and_b32 v7, 1, v3
  v_lshl_add_u32 v6, v7, 1, v6
  s_lshl_b32 s62, s3, 13
  s_and_b32 s63, s3, 1
  s_lshl_b32 s63, s63, 12
  s_add_u32 s63, s63, 65536
  v_xor_b32 v8, 0, v6
  v_lshl_add_u32 v112, v8, 5, v5
  v_add_u32 v116, s62, v112
  v_add_u32 v120, s63, v112
  v_xor_b32 v8, 1, v6
  v_lshl_add_u32 v113, v8, 5, v5
  v_add_u32 v117, s62, v113
  v_add_u32 v121, s63, v113
  v_xor_b32 v8, 2, v6
  v_lshl_add_u32 v114, v8, 5, v5
  v_add_u32 v118, s62, v114
  v_add_u32 v122, s63, v114
  v_xor_b32 v8, 3, v6
  v_lshl_add_u32 v115, v8, 5, v5
  v_add_u32 v119, s62, v115
  v_add_u32 v123, s63, v115
  s_mul_i32 s68, s47, 57
  s_lshr_b32 s68, s68, 9
  s_mul_i32 s62, s68, 9
  s_sub_u32 s62, s47, s62
  s_lshl_b32 s62, s62, 6
  s_mul_i32 s69, s68, 73728
  s_lshl_b32 s70, s68, 5
  s_sub_u32 s70, 220992, s70
  s_cmp_eq_u32 s68, 0
  s_cselect_b32 s70, 221184, s70
  s_cselect_b32 s72, 5, 6
  s_cselect_b32 s71, 0x3eae1a93, 1.0
  s_mul_i32 s64, s45, 9216
  s_add_u32 s64, s64, 10485760
  s_add_u32 s65, s64, 8192
  s_lshl_b32 s63, s3, 10
  s_add_u32 s64, s64, s63
  v_lshl_add_u32 v5, v7, 4, s62
  v_add_u32 v5, v5, v2
  v_mul_u32_u24 v8, 0xe39, v5
  v_lshrrev_b32 v8, 16, v8
  v_mul_u32_u24 v9, 18, v8
  v_sub_u32 v9, v5, v9
  v_lshrrev_b32 v10, 2, v8
  v_mul_u32_u24 v124, 258048, v10
  v_lshl_add_u32 v124, v9, 4, v124
  v_bfe_u32 v10, v8, 1, 1
  v_mul_u32_u24 v10, 36864, v10
  v_and_b32 v11, 1, v8
  v_lshl_add_u32 v10, v11, 8, v10
  v_add_u32 v10, s69, v10
  v_and_b32 v11, 3, v8
  v_lshlrev_b32 v11, s72, v11
  v_add_u32 v11, s70, v11
  v_cmp_gt_u32 vcc, 16, v9
  s_nop 1
  v_cndmask_b32 v10, v11, v10, vcc
  v_add_u32 v124, v124, v10
  v_add_u32 v5, 32, v5
  v_mul_u32_u24 v8, 0xe39, v5
  v_lshrrev_b32 v8, 16, v8
  v_mul_u32_u24 v9, 18, v8
  v_sub_u32 v9, v5, v9
  v_lshrrev_b32 v10, 2, v8
  v_mul_u32_u24 v125, 258048, v10
  v_lshl_add_u32 v125, v9, 4, v125
  v_bfe_u32 v10, v8, 1, 1
  v_mul_u32_u24 v10, 36864, v10
  v_and_b32 v11, 1, v8
  v_lshl_add_u32 v10, v11, 8, v10
  v_add_u32 v10, s69, v10
  v_and_b32 v11, 3, v8
  v_lshlrev_b32 v11, s72, v11
  v_add_u32 v11, s70, v11
  v_cmp_gt_u32 vcc, 16, v9
  s_nop 1
  v_cndmask_b32 v10, v11, v10, vcc
  v_add_u32 v125, v125, v10
  v_lshrrev_b32 v6, 1, v3
  v_lshl_add_u32 v124, v6, 9, v124
  v_lshl_add_u32 v125, v6, 9, v125
  s_lshl_b32 s63, s3, 3
  s_add_u32 s62, s62, s63
  v_lshrrev_b32 v6, 3, v1
  v_add_u32 v5, s62, v6
  v_mul_u32_u24 v8, 0xe39, v5
  v_lshrrev_b32 v8, 16, v8
  v_mul_u32_u24 v9, 18, v8
  v_sub_u32 v9, v5, v9
  v_lshrrev_b32 v10, 2, v8
  v_mul_u32_u24 v126, 258048, v10
  v_lshl_add_u32 v126, v9, 4, v126
  v_bfe_u32 v10, v8, 1, 1
  v_mul_u32_u24 v10, 36864, v10
  v_and_b32 v11, 1, v8
  v_lshl_add_u32 v10, v11, 8, v10
  v_add_u32 v10, s69, v10
  v_and_b32 v11, 3, v8
  v_lshlrev_b32 v11, s72, v11
  v_add_u32 v11, s70, v11
  v_cmp_gt_u32 vcc, 16, v9
  s_nop 1
  v_cndmask_b32 v10, v11, v10, vcc
  v_add_u32 v126, v126, v10
  s_mul_i32 s62, s3, 4112
  s_add_u32 s62, s62, 36864
  v_add_u32 v7, s62, v4
  s_cmp_ge_u32 s3, 4
  s_cbranch_scc1 f_kernel_g023
  s_waitcnt vmcnt(0)
f_kernel_g023:
  s_barrier
  ds_read_b64_tr_b16 v[16:17], v112 offset:0
  ds_read_b64_tr_b16 v[18:19], v112 offset:512
  ds_read_b64_tr_b16 v[20:21], v113 offset:0
  ds_read_b64_tr_b16 v[22:23], v113 offset:512
  ds_read_b64_tr_b16 v[24:25], v114 offset:0
  ds_read_b64_tr_b16 v[26:27], v114 offset:512
  ds_read_b64_tr_b16 v[28:29], v115 offset:0
  ds_read_b64_tr_b16 v[30:31], v115 offset:512
  ds_read_b64_tr_b16 v[32:33], v112 offset:4096
  ds_read_b64_tr_b16 v[34:35], v112 offset:4608
  ds_read_b64_tr_b16 v[36:37], v113 offset:4096
  ds_read_b64_tr_b16 v[38:39], v113 offset:4608
  ds_read_b64_tr_b16 v[40:41], v114 offset:4096
  ds_read_b64_tr_b16 v[42:43], v114 offset:4608
  s_waitcnt lgkmcnt(12)
  v_mfma_f32_16x16x32_bf16 v[144:147], v[160:163], v[16:19], 0
  ds_read_b64_tr_b16 v[44:45], v115 offset:4096
  ds_read_b64_tr_b16 v[46:47], v115 offset:4608
  s_waitcnt lgkmcnt(12)
  v_mfma_f32_16x16x32_bf16 v[148:151], v[160:163], v[20:23], 0
  ds_read_b64_tr_b16 v[16:17], v112 offset:8192
  ds_read_b64_tr_b16 v[18:19], v112 offset:8704
  s_waitcnt lgkmcnt(12)
  v_mfma_f32_16x16x32_bf16 v[152:155], v[160:163], v[24:27], 0
  ds_read_b64_tr_b16 v[20:21], v113 offset:8192
  ds_read_b64_tr_b16 v[22:23], v113 offset:8704
  s_waitcnt lgkmcnt(12)
  v_mfma_f32_16x16x32_bf16 v[156:159], v[160:163], v[28:31], 0
  ds_read_b64_tr_b16 v[24:25], v114 offset:8192
  ds_read_b64_tr_b16 v[26:27], v114 offset:8704
  s_waitcnt lgkmcnt(12)
  v_mfma_f32_16x16x32_bf16 v[144:147], v[164:167], v[32:35], v[144:147]
  ds_read_b64_tr_b16 v[28:29], v115 offset:8192
  ds_read_b64_tr_b16 v[30:31], v115 offset:8704
  s_waitcnt lgkmcnt(12)
  v_mfma_f32_16x16x32_bf16 v[148:151], v[164:167], v[36:39], v[148:151]
  ds_read_b64_tr_b16 v[32:33], v112 offset:12288
  ds_read_b64_tr_b16 v[34:35], v112 offset:12800
  s_waitcnt lgkmcnt(12)
  v_mfma_f32_16x16x32_bf16 v[152:155], v[164:167], v[40:43], v[152:155]
  ds_read_b64_tr_b16 v[36:37], v113 offset:12288
  ds_read_b64_tr_b16 v[38:39], v113 offset:12800
  s_waitcnt lgkmcnt(12)
  v_mfma_f32_16x16x32_bf16 v[156:159], v[164:167], v[44:47], v[156:159]
  ds_read_b64_tr_b16 v[40:41], v114 offset:12288
  ds_read_b64_tr_b16 v[42:43], v114 offset:12800
  s_waitcnt lgkmcnt(12)
  v_mfma_f32_16x16x32_bf16 v[144:147], v[168:171], v[16:19], v[144:147]
  ds_read_b64_tr_b16 v[44:45], v115 offset:12288
  ds_read_b64_tr_b16 v[46:47], v115 offset:12800
  s_waitcnt lgkmcnt(12)
  v_mfma_f32_16x16x32_bf16 v[148:151], v[168:171], v[20:23], v[148:151]
  ds_read_b64_tr_b16 v[16:17], v112 offset:16384
  ds_read_b64_tr_b16 v[18:19], v112 offset:16896
  s_waitcnt lgkmcnt(12)
  v_mfma_f32_16x16x32_bf16 v[152:155], v[168:171], v[24:27], v[152:155]
  ds_read_b64_tr_b16 v[20:21], v113 offset:16384
  ds_read_b64_tr_b16 v[22:23], v113 offset:16896
  s_waitcnt lgkmcnt(12)
  v_mfma_f32_16x16x32_bf16 v[156:159], v[168:171], v[28:31], v[156:159]
  ds_read_b64_tr_b16 v[24:25], v114 offset:16384
  ds_read_b64_tr_b16 v[26:27], v114 offset:16896
  s_waitcnt lgkmcnt(12)
  v_mfma_f32_16x16x32_bf16 v[144:147], v[172:175], v[32:35], v[144:147]
  ds_read_b64_tr_b16 v[28:29], v115 offset:16384
  ds_read_b64_tr_b16 v[30:31], v115 offset:16896
  s_waitcnt lgkmcnt(12)
  v_mfma_f32_16x16x32_bf16 v[148:151], v[172:175], v[36:39], v[148:151]
  ds_read_b64_tr_b16 v[32:33], v112 offset:20480
  ds_read_b64_tr_b16 v[34:35], v112 offset:20992
  s_waitcnt lgkmcnt(12)
  v_mfma_f32_16x16x32_bf16 v[152:155], v[172:175], v[40:43], v[152:155]
  ds_read_b64_tr_b16 v[36:37], v113 offset:20480
  ds_read_b64_tr_b16 v[38:39], v113 offset:20992
  s_waitcnt lgkmcnt(12)
  v_mfma_f32_16x16x32_bf16 v[156:159], v[172:175], v[44:47], v[156:159]
  ds_read_b64_tr_b16 v[40:41], v114 offset:20480
  ds_read_b64_tr_b16 v[42:43], v114 offset:20992
  s_waitcnt lgkmcnt(12)
  v_mfma_f32_16x16x32_bf16 v[144:147], v[176:179], v[16:19], v[144:147]
  ds_read_b64_tr_b16 v[44:45], v115 offset:20480
  ds_read_b64_tr_b16 v[46:47], v115 offset:20992
  s_waitcnt lgkmcnt(12)
  v_mfma_f32_16x16x32_bf16 v[148:151], v[176:179], v[20:23], v[148:151]
  ds_read_b64_tr_b16 v[16:17], v112 offset:24576
  ds_read_b64_tr_b16 v[18:19], v112 offset:25088
  s_waitcnt lgkmcnt(12)
  v_mfma_f32_16x16x32_bf16 v[152:155], v[176:179], v[24:27], v[152:155]
  ds_read_b64_tr_b16 v[20:21], v113 offset:24576
  ds_read_b64_tr_b16 v[22:23], v113 offset:25088
  s_waitcnt lgkmcnt(12)
  v_mfma_f32_16x16x32_bf16 v[156:159], v[176:179], v[28:31], v[156:159]
  ds_read_b64_tr_b16 v[24:25], v114 offset:24576
  ds_read_b64_tr_b16 v[26:27], v114 offset:25088
  s_waitcnt lgkmcnt(12)
  v_mfma_f32_16x16x32_bf16 v[144:147], v[180:183], v[32:35], v[144:147]
  ds_read_b64_tr_b16 v[28:29], v115 offset:24576
  ds_read_b64_tr_b16 v[30:31], v115 offset:25088
  s_waitcnt lgkmcnt(12)
  v_mfma_f32_16x16x32_bf16 v[148:151], v[180:183], v[36:39], v[148:151]
  ds_read_b64_tr_b16 v[32:33], v112 offset:28672
  ds_read_b64_tr_b16 v[34:35], v112 offset:29184
  s_waitcnt lgkmcnt(12)
  v_mfma_f32_16x16x32_bf16 v[152:155], v[180:183], v[40:43], v[152:155]
  ds_read_b64_tr_b16 v[36:37], v113 offset:28672
  ds_read_b64_tr_b16 v[38:39], v113 offset:29184
  s_waitcnt lgkmcnt(12)
  v_mfma_f32_16x16x32_bf16 v[156:159], v[180:183], v[44:47], v[156:159]
  ds_read_b64_tr_b16 v[40:41], v114 offset:28672
  ds_read_b64_tr_b16 v[42:43], v114 offset:29184
  s_waitcnt lgkmcnt(12)
  v_mfma_f32_16x16x32_bf16 v[144:147], v[184:187], v[16:19], v[144:147]
  ds_read_b64_tr_b16 v[44:45], v115 offset:28672
  ds_read_b64_tr_b16 v[46:47], v115 offset:29184
  s_waitcnt lgkmcnt(12)
  v_mfma_f32_16x16x32_bf16 v[148:151], v[184:187], v[20:23], v[148:151]
  ds_read_b64_tr_b16 v[16:17], v112 offset:32768
  ds_read_b64_tr_b16 v[18:19], v112 offset:33280
  s_waitcnt lgkmcnt(12)
  v_mfma_f32_16x16x32_bf16 v[152:155], v[184:187], v[24:27], v[152:155]
  ds_read_b64_tr_b16 v[20:21], v113 offset:32768
  ds_read_b64_tr_b16 v[22:23], v113 offset:33280
  s_waitcnt lgkmcnt(12)
  v_mfma_f32_16x16x32_bf16 v[156:159], v[184:187], v[28:31], v[156:159]
  ds_read_b64_tr_b16 v[24:25], v114 offset:32768
  ds_read_b64_tr_b16 v[26:27], v114 offset:33280
  s_waitcnt lgkmcnt(12)
  v_mfma_f32_16x16x32_bf16 v[144:147], v[188:191], v[32:35], v[144:147]
  ds_read_b64_tr_b16 v[28:29], v115 offset:32768
  ds_read_b64_tr_b16 v[30:31], v115 offset:33280
  s_waitcnt lgkmcnt(12)
  v_mfma_f32_16x16x32_bf16 v[148:151], v[188:191], v[36:39], v[148:151]
  s_waitcnt vmcnt(0)
  s_barrier
  ds_read_b64_tr_b16 v[32:33], v116 offset:0
  ds_read_b64_tr_b16 v[34:35], v116 offset:512
  s_waitcnt lgkmcnt(12)
  v_mfma_f32_16x16x32_bf16 v[152:155], v[188:191], v[40:43], v[152:155]
  ds_read_b64_tr_b16 v[36:37], v117 offset:0
  ds_read_b64_tr_b16 v[38:39], v117 offset:512
  s_waitcnt lgkmcnt(12)
  v_mfma_f32_16x16x32_bf16 v[156:159], v[188:191], v[44:47], v[156:159]
  ds_read_b64_tr_b16 v[40:41], v118 offset:0
  ds_read_b64_tr_b16 v[42:43], v118 offset:512
  s_waitcnt lgkmcnt(12)
  v_mfma_f32_16x16x32_bf16 v[144:147], v[192:195], v[16:19], v[144:147]
  ds_read_b64_tr_b16 v[44:45], v119 offset:0
  ds_read_b64_tr_b16 v[46:47], v119 offset:512
  s_waitcnt lgkmcnt(12)
  v_mfma_f32_16x16x32_bf16 v[148:151], v[192:195], v[20:23], v[148:151]
  ds_read_b64_tr_b16 v[16:17], v116 offset:4096
  ds_read_b64_tr_b16 v[18:19], v116 offset:4608
  s_waitcnt lgkmcnt(12)
  v_mfma_f32_16x16x32_bf16 v[152:155], v[192:195], v[24:27], v[152:155]
  ds_read_b64_tr_b16 v[20:21], v117 offset:4096
  ds_read_b64_tr_b16 v[22:23], v117 offset:4608
  s_waitcnt lgkmcnt(12)
  v_mfma_f32_16x16x32_bf16 v[156:159], v[192:195], v[28:31], v[156:159]
  ds_read_b64_tr_b16 v[24:25], v118 offset:4096
  ds_read_b64_tr_b16 v[26:27], v118 offset:4608
  s_waitcnt lgkmcnt(12)
  v_mfma_f32_16x16x32_bf16 v[96:99], v[232:235], v[32:35], 0
  ds_read_b64_tr_b16 v[28:29], v119 offset:4096
  ds_read_b64_tr_b16 v[30:31], v119 offset:4608
  s_waitcnt lgkmcnt(12)
  v_mfma_f32_16x16x32_bf16 v[100:103], v[232:235], v[36:39], 0
  ds_read_b64_tr_b16 v[32:33], v120 offset:0
  ds_read_b64_tr_b16 v[34:35], v120 offset:512
  s_waitcnt lgkmcnt(12)
  v_mfma_f32_16x16x32_bf16 v[104:107], v[232:235], v[40:43], 0
  ds_read_b64_tr_b16 v[36:37], v121 offset:0
  ds_read_b64_tr_b16 v[38:39], v121 offset:512
  s_waitcnt lgkmcnt(12)
  v_mfma_f32_16x16x32_bf16 v[108:111], v[232:235], v[44:47], 0
  ds_read_b64_tr_b16 v[40:41], v122 offset:0
  ds_read_b64_tr_b16 v[42:43], v122 offset:512
  s_waitcnt lgkmcnt(12)
  v_mfma_f32_16x16x32_bf16 v[96:99], v[236:239], v[16:19], v[96:99]
  ds_read_b64_tr_b16 v[44:45], v123 offset:0
  ds_read_b64_tr_b16 v[46:47], v123 offset:512
  s_waitcnt lgkmcnt(12)
  v_mfma_f32_16x16x32_bf16 v[100:103], v[236:239], v[20:23], v[100:103]
  ds_read_b64_tr_b16 v[16:17], v112 offset:36864
  ds_read_b64_tr_b16 v[18:19], v112 offset:37376
  s_waitcnt lgkmcnt(12)
  v_mfma_f32_16x16x32_bf16 v[104:107], v[236:239], v[24:27], v[104:107]
  ds_read_b64_tr_b16 v[20:21], v113 offset:36864
  ds_read_b64_tr_b16 v[22:23], v113 offset:37376
  s_waitcnt lgkmcnt(12)
  v_mfma_f32_16x16x32_bf16 v[108:111], v[236:239], v[28:31], v[108:111]
  ds_read_b64_tr_b16 v[24:25], v114 offset:36864
  ds_read_b64_tr_b16 v[26:27], v114 offset:37376
  s_waitcnt lgkmcnt(12)
  v_mfma_f32_16x16x32_bf16 v[96:99], v[240:243], v[32:35], v[96:99]
  ds_read_b64_tr_b16 v[28:29], v115 offset:36864
  ds_read_b64_tr_b16 v[30:31], v115 offset:37376
  s_waitcnt lgkmcnt(12)
  v_mfma_f32_16x16x32_bf16 v[100:103], v[240:243], v[36:39], v[100:103]
  ds_read_b64_tr_b16 v[32:33], v112 offset:40960
  ds_read_b64_tr_b16 v[34:35], v112 offset:41472
  s_waitcnt lgkmcnt(12)
  v_mfma_f32_16x16x32_bf16 v[104:107], v[240:243], v[40:43], v[104:107]
  ds_read_b64_tr_b16 v[36:37], v113 offset:40960
  ds_read_b64_tr_b16 v[38:39], v113 offset:41472
  s_waitcnt lgkmcnt(12)
  v_mfma_f32_16x16x32_bf16 v[108:111], v[240:243], v[44:47], v[108:111]
  ds_read_b64_tr_b16 v[40:41], v114 offset:40960
  ds_read_b64_tr_b16 v[42:43], v114 offset:41472
  s_waitcnt lgkmcnt(12)
  v_mfma_f32_16x16x32_bf16 v[144:147], v[196:199], v[16:19], v[144:147]
  ds_read_b64_tr_b16 v[44:45], v115 offset:40960
  ds_read_b64_tr_b16 v[46:47], v115 offset:41472
  s_waitcnt lgkmcnt(12)
  v_mfma_f32_16x16x32_bf16 v[148:151], v[196:199], v[20:23], v[148:151]
  ds_read_b64_tr_b16 v[16:17], v112 offset:45056
  ds_read_b64_tr_b16 v[18:19], v112 offset:45568
  s_waitcnt lgkmcnt(12)
  v_mfma_f32_16x16x32_bf16 v[152:155], v[196:199], v[24:27], v[152:155]
  ds_read_b64_tr_b16 v[20:21], v113 offset:45056
  ds_read_b64_tr_b16 v[22:23], v113 offset:45568
  s_waitcnt lgkmcnt(12)
  v_mfma_f32_16x16x32_bf16 v[156:159], v[196:199], v[28:31], v[156:159]
  ds_read_b64_tr_b16 v[24:25], v114 offset:45056
  ds_read_b64_tr_b16 v[26:27], v114 offset:45568
  s_waitcnt lgkmcnt(12)
  v_mfma_f32_16x16x32_bf16 v[144:147], v[200:203], v[32:35], v[144:147]
  ds_read_b64_tr_b16 v[28:29], v115 offset:45056
  ds_read_b64_tr_b16 v[30:31], v115 offset:45568
  s_waitcnt lgkmcnt(12)
  v_mfma_f32_16x16x32_bf16 v[148:151], v[200:203], v[36:39], v[148:151]
  ds_read_b64_tr_b16 v[32:33], v112 offset:49152
  ds_read_b64_tr_b16 v[34:35], v112 offset:49664
  s_waitcnt lgkmcnt(12)
  v_mfma_f32_16x16x32_bf16 v[152:155], v[200:203], v[40:43], v[152:155]
  ds_read_b64_tr_b16 v[36:37], v113 offset:49152
  ds_read_b64_tr_b16 v[38:39], v113 offset:49664
  s_waitcnt lgkmcnt(12)
  v_mfma_f32_16x16x32_bf16 v[156:159], v[200:203], v[44:47], v[156:159]
  ds_read_b64_tr_b16 v[40:41], v114 offset:49152
  ds_read_b64_tr_b16 v[42:43], v114 offset:49664
  s_waitcnt lgkmcnt(12)
  v_mfma_f32_16x16x32_bf16 v[144:147], v[204:207], v[16:19], v[144:147]
  ds_read_b64_tr_b16 v[44:45], v115 offset:49152
  ds_read_b64_tr_b16 v[46:47], v115 offset:49664
  s_waitcnt lgkmcnt(12)
  v_mfma_f32_16x16x32_bf16 v[148:151], v[204:207], v[20:23], v[148:151]
  ds_read_b64_tr_b16 v[16:17], v112 offset:53248
  ds_read_b64_tr_b16 v[18:19], v112 offset:53760
  s_waitcnt lgkmcnt(12)
  v_mfma_f32_16x16x32_bf16 v[152:155], v[204:207], v[24:27], v[152:155]
  ds_read_b64_tr_b16 v[20:21], v113 offset:53248
  ds_read_b64_tr_b16 v[22:23], v113 offset:53760
  s_waitcnt lgkmcnt(12)
  v_mfma_f32_16x16x32_bf16 v[156:159], v[204:207], v[28:31], v[156:159]
  ds_read_b64_tr_b16 v[24:25], v114 offset:53248
  ds_read_b64_tr_b16 v[26:27], v114 offset:53760
  s_waitcnt lgkmcnt(12)
  v_mfma_f32_16x16x32_bf16 v[144:147], v[208:211], v[32:35], v[144:147]
  ds_read_b64_tr_b16 v[28:29], v115 offset:53248
  ds_read_b64_tr_b16 v[30:31], v115 offset:53760
  s_waitcnt lgkmcnt(12)
  v_mfma_f32_16x16x32_bf16 v[148:151], v[208:211], v[36:39], v[148:151]
  ds_read_b64_tr_b16 v[32:33], v112 offset:57344
  ds_read_b64_tr_b16 v[34:35], v112 offset:57856
  s_waitcnt lgkmcnt(12)
  v_mfma_f32_16x16x32_bf16 v[152:155], v[208:211], v[40:43], v[152:155]
  ds_read_b64_tr_b16 v[36:37], v113 offset:57344
  ds_read_b64_tr_b16 v[38:39], v113 offset:57856
  s_waitcnt lgkmcnt(12)
  v_mfma_f32_16x16x32_bf16 v[156:159], v[208:211], v[44:47], v[156:159]
  ds_read_b64_tr_b16 v[40:41], v114 offset:57344
  ds_read_b64_tr_b16 v[42:43], v114 offset:57856
  s_waitcnt lgkmcnt(12)
  v_mfma_f32_16x16x32_bf16 v[144:147], v[212:215], v[16:19], v[144:147]
  ds_read_b64_tr_b16 v[44:45], v115 offset:57344
  ds_read_b64_tr_b16 v[46:47], v115 offset:57856
  s_waitcnt lgkmcnt(12)
  v_mfma_f32_16x16x32_bf16 v[148:151], v[212:215], v[20:23], v[148:151]
  ds_read_b64_tr_b16 v[16:17], v112 offset:61440
  ds_read_b64_tr_b16 v[18:19], v112 offset:61952
  s_waitcnt lgkmcnt(12)
  v_mfma_f32_16x16x32_bf16 v[152:155], v[212:215], v[24:27], v[152:155]
  ds_read_b64_tr_b16 v[20:21], v113 offset:61440
  ds_read_b64_tr_b16 v[22:23], v113 offset:61952
  s_waitcnt lgkmcnt(12)
  v_mfma_f32_16x16x32_bf16 v[156:159], v[212:215], v[28:31], v[156:159]
  ds_read_b64_tr_b16 v[24:25], v114 offset:61440
  ds_read_b64_tr_b16 v[26:27], v114 offset:61952
  s_waitcnt lgkmcnt(12)
  v_mfma_f32_16x16x32_bf16 v[144:147], v[216:219], v[32:35], v[144:147]
  ds_read_b64_tr_b16 v[28:29], v115 offset:61440
  ds_read_b64_tr_b16 v[30:31], v115 offset:61952
  s_waitcnt lgkmcnt(12)
  v_mfma_f32_16x16x32_bf16 v[148:151], v[216:219], v[36:39], v[148:151]
  v_add_u32 v112, 0x10000, v112
  ds_read_b64_tr_b16 v[32:33], v112 offset:0
  ds_read_b64_tr_b16 v[34:35], v112 offset:512
  s_waitcnt lgkmcnt(12)
  v_mfma_f32_16x16x32_bf16 v[152:155], v[216:219], v[40:43], v[152:155]
  v_add_u32 v113, 0x10000, v113
  ds_read_b64_tr_b16 v[36:37], v113 offset:0
  ds_read_b64_tr_b16 v[38:39], v113 offset:512
  s_waitcnt lgkmcnt(12)
  v_mfma_f32_16x16x32_bf16 v[156:159], v[216:219], v[44:47], v[156:159]
  v_add_u32 v114, 0x10000, v114
  ds_read_b64_tr_b16 v[40:41], v114 offset:0
  ds_read_b64_tr_b16 v[42:43], v114 offset:512
  s_waitcnt lgkmcnt(12)
  v_mfma_f32_16x16x32_bf16 v[144:147], v[220:223], v[16:19], v[144:147]
  v_add_u32 v115, 0x10000, v115
  ds_read_b64_tr_b16 v[44:45], v115 offset:0
  ds_read_b64_tr_b16 v[46:47], v115 offset:512
  s_waitcnt lgkmcnt(12)
  v_mfma_f32_16x16x32_bf16 v[148:151], v[220:223], v[20:23], v[148:151]
  ds_read_b64_tr_b16 v[16:17], v112 offset:4096
  ds_read_b64_tr_b16 v[18:19], v112 offset:4608
  s_waitcnt lgkmcnt(12)
  v_mfma_f32_16x16x32_bf16 v[152:155], v[220:223], v[24:27], v[152:155]
  ds_read_b64_tr_b16 v[20:21], v113 offset:4096
  ds_read_b64_tr_b16 v[22:23], v113 offset:4608
  s_waitcnt lgkmcnt(12)
  v_mfma_f32_16x16x32_bf16 v[156:159], v[220:223], v[28:31], v[156:159]
  ds_read_b64_tr_b16 v[24:25], v114 offset:4096
  ds_read_b64_tr_b16 v[26:27], v114 offset:4608
  s_waitcnt lgkmcnt(12)
  v_mfma_f32_16x16x32_bf16 v[144:147], v[224:227], v[32:35], v[144:147]
  ds_read_b64_tr_b16 v[28:29], v115 offset:4096
  ds_read_b64_tr_b16 v[30:31], v115 offset:4608
  s_waitcnt lgkmcnt(12)
  v_mfma_f32_16x16x32_bf16 v[148:151], v[224:227], v[36:39], v[148:151]
  s_waitcnt lgkmcnt(10)
  v_mfma_f32_16x16x32_bf16 v[152:155], v[224:227], v[40:43], v[152:155]
  s_waitcnt lgkmcnt(8)
  v_mfma_f32_16x16x32_bf16 v[156:159], v[224:227], v[44:47], v[156:159]
  s_waitcnt lgkmcnt(6)
  v_mfma_f32_16x16x32_bf16 v[144:147], v[228:231], v[16:19], v[144:147]
  ds_write_b128 v7, v[96:99] offset:0
  s_waitcnt lgkmcnt(5)
  v_mfma_f32_16x16x32_bf16 v[148:151], v[228:231], v[20:23], v[148:151]
  ds_write_b128 v7, v[100:103] offset:1024
  s_waitcnt lgkmcnt(4)
  v_mfma_f32_16x16x32_bf16 v[152:155], v[228:231], v[24:27], v[152:155]
  ds_write_b128 v7, v[104:107] offset:2048
  s_waitcnt lgkmcnt(3)
  v_mfma_f32_16x16x32_bf16 v[156:159], v[228:231], v[28:31], v[156:159]
  ds_write_b128 v7, v[108:111] offset:3072
  v_and_b32 v5, 7, v1
  v_mul_u32_u24 v10, 4112, v5
  v_lshl_add_u32 v10, v6, 4, v10
  s_lshr_b32 s62, s3, 1
  s_lshl_b32 s62, s62, 10
  s_and_b32 s63, s3, 1
  s_lshl_b32 s63, s63, 7
  s_add_u32 s62, s62, s63
  s_add_u32 s62, s62, 36864
  v_add_u32 v10, s62, v10
  v_lshl_add_u32 v126, v5, 9, v126
  v_mov_b32 v6, 1073741824
  v_cmp_gt_u32 vcc, 2, v5
  s_nop 1
  v_cndmask_b32 v126, v6, v126, vcc
  s_cmp_ge_u32 s3, 4
  s_cbranch_scc1 f_kernel_g124
  s_cmp_ge_u32 s47, 18
  s_cbranch_scc1 f_kernel_g124
  s_mov_b32 s28, s14
  s_mov_b32 s29, s15
  s_mov_b32 s30, 663552
  s_mov_b32 s31, 0x00020000
  v_lshrrev_b32 v44, 2, v1
  v_lshrrev_b32 v40, 3, v44
  v_mul_u32_u24 v40, 18, v40
  v_and_b32 v41, 7, v44
  v_add_u32 v40, v40, v41
  v_lshrrev_b32 v41, 2, v44
  v_mul_u32_u24 v41, 0x48, v41
  v_bfe_u32 v42, v44, 1, 1
  v_mul_u32_u24 v42, 18, v42
  v_and_b32 v43, 1, v44
  v_add3_u32 v41, v41, v42, v43
  s_mul_i32 s72, s47, 36
  s_mul_i32 s63, s47, 288
  s_sub_u32 s63, s63, 4592
  s_cmp_lt_u32 s47, 16
  s_cselect_b64 vcc, -1, 0
  s_cselect_b32 s72, s72, s63
  s_cselect_b32 s73, 8, 36
  s_mul_i32 s73, s73, 1152
  v_cndmask_b32 v40, v41, v40, vcc
  v_mul_u32_u24 v40, 0x480, v40
  v_and_b32 v41, 2, v3
  v_xor_b32 v41, v41, v1
  v_and_b32 v41, 3, v41
  v_lshl_add_u32 v40, v41, 4, v40
  s_mul_i32 s72, s72, 1152
  s_bitcmp1_b32 s3, 0
  s_cselect_b32 s62, s73, 0
  s_cselect_b32 s63, 1024, 0
  s_add_u32 s72, s72, s62
  s_bitcmp1_b32 s3, 1
  s_cselect_b32 s62, 576, 0
  s_add_u32 s72, s72, s62
  s_lshl_b32 s62, s62, 5
  s_add_u32 m0, s62, s63
  s_nop 0
  buffer_load_dwordx4 v40, s[28:31], s72 offen offset:0 lds
  s_add_u32 m0, m0, 1984
  s_nop 0
  buffer_load_dwordx4 v40, s[28:31], s72 offen offset:64 lds
  s_add_u32 m0, m0, 1984
  s_nop 0
  buffer_load_dwordx4 v40, s[28:31], s72 offen offset:128 lds
  s_add_u32 m0, m0, 1984
  s_nop 0
  buffer_load_dwordx4 v40, s[28:31], s72 offen offset:192 lds
  s_add_u32 m0, m0, 1984
  s_nop 0
  buffer_load_dwordx4 v40, s[28:31], s72 offen offset:256 lds
  s_add_u32 m0, m0, 1984
  s_nop 0
  buffer_load_dwordx4 v40, s[28:31], s72 offen offset:320 lds
  s_add_u32 m0, m0, 1984
  s_nop 0
  buffer_load_dwordx4 v40, s[28:31], s72 offen offset:384 lds
  s_add_u32 m0, m0, 1984
  s_nop 0
  buffer_load_dwordx4 v40, s[28:31], s72 offen offset:448 lds
  s_add_u32 m0, m0, 1984
  s_nop 0
  buffer_load_dwordx4 v40, s[28:31], s72 offen offset:512 lds
f_kernel_g124:
  s_waitcnt lgkmcnt(0)
  s_barrier
  ds_read_b128 v[48:51], v10 offset:0
  ds_read_b128 v[52:55], v10 offset:256
  ds_read_b128 v[56:59], v10 offset:512
  ds_read_b128 v[60:63], v10 offset:768
  v_mul_f32 v144, s71, v144
  v_mul_f32 v145, s71, v145
  v_mul_f32 v146, s71, v146
  v_mul_f32 v147, s71, v147
  v_mul_f32 v148, s71, v148
  v_mul_f32 v149, s71, v149
  v_mul_f32 v150, s71, v150
  v_mul_f32 v151, s71, v151
  v_cvt_pk_bf16_f32 v16, v144, v145
  v_cvt_pk_bf16_f32 v17, v146, v147
  v_cvt_pk_bf16_f32 v18, v148, v149
  v_cvt_pk_bf16_f32 v19, v150, v151
  s_nop 0
  v_permlane16_swap_b32 v16, v18
  v_permlane16_swap_b32 v17, v19
  buffer_store_dwordx4 v[16:19], v124, s[24:27], s64 offen sc1
  v_mul_f32 v152, s71, v152
  v_mul_f32 v153, s71, v153
  v_mul_f32 v154, s71, v154
  v_mul_f32 v155, s71, v155
  v_mul_f32 v156, s71, v156
  v_mul_f32 v157, s71, v157
  v_mul_f32 v158, s71, v158
  v_mul_f32 v159, s71, v159
  v_cvt_pk_bf16_f32 v20, v152, v153
  v_cvt_pk_bf16_f32 v21, v154, v155
  v_cvt_pk_bf16_f32 v22, v156, v157
  v_cvt_pk_bf16_f32 v23, v158, v159
  s_nop 0
  v_permlane16_swap_b32 v20, v22
  v_permlane16_swap_b32 v21, v23
  buffer_store_dwordx4 v[20:23], v125, s[24:27], s64 offen sc1
  s_waitcnt lgkmcnt(3)
  v_add_f32_dpp v48, v48, v48 quad_perm:[1,0,3,2] row_mask:0xf bank_mask:0xf
  v_add_f32_dpp v49, v49, v49 quad_perm:[1,0,3,2] row_mask:0xf bank_mask:0xf
  v_add_f32_dpp v50, v50, v50 quad_perm:[1,0,3,2] row_mask:0xf bank_mask:0xf
  v_add_f32_dpp v51, v51, v51 quad_perm:[1,0,3,2] row_mask:0xf bank_mask:0xf
  s_waitcnt lgkmcnt(2)
  v_add_f32_dpp v52, v52, v52 quad_perm:[1,0,3,2] row_mask:0xf bank_mask:0xf
  v_add_f32_dpp v53, v53, v53 quad_perm:[1,0,3,2] row_mask:0xf bank_mask:0xf
  v_add_f32_dpp v54, v54, v54 quad_perm:[1,0,3,2] row_mask:0xf bank_mask:0xf
  v_add_f32_dpp v55, v55, v55 quad_perm:[1,0,3,2] row_mask:0xf bank_mask:0xf
  s_waitcnt lgkmcnt(1)
  v_add_f32_dpp v56, v56, v56 quad_perm:[1,0,3,2] row_mask:0xf bank_mask:0xf
  v_add_f32_dpp v57, v57, v57 quad_perm:[1,0,3,2] row_mask:0xf bank_mask:0xf
  v_add_f32_dpp v58, v58, v58 quad_perm:[1,0,3,2] row_mask:0xf bank_mask:0xf
  v_add_f32_dpp v59, v59, v59 quad_perm:[1,0,3,2] row_mask:0xf bank_mask:0xf
  s_waitcnt lgkmcnt(0)
  v_add_f32_dpp v60, v60, v60 quad_perm:[1,0,3,2] row_mask:0xf bank_mask:0xf
  v_add_f32_dpp v61, v61, v61 quad_perm:[1,0,3,2] row_mask:0xf bank_mask:0xf
  v_add_f32_dpp v62, v62, v62 quad_perm:[1,0,3,2] row_mask:0xf bank_mask:0xf
  v_add_f32_dpp v63, v63, v63 quad_perm:[1,0,3,2] row_mask:0xf bank_mask:0xf
  v_add_f32_dpp v48, v48, v48 quad_perm:[2,3,0,1] row_mask:0xf bank_mask:0xf
  v_add_f32_dpp v49, v49, v49 quad_perm:[2,3,0,1] row_mask:0xf bank_mask:0xf
  v_add_f32_dpp v50, v50, v50 quad_perm:[2,3,0,1] row_mask:0xf bank_mask:0xf
  v_add_f32_dpp v51, v51, v51 quad_perm:[2,3,0,1] row_mask:0xf bank_mask:0xf
  v_add_f32_dpp v52, v52, v52 quad_perm:[2,3,0,1] row_mask:0xf bank_mask:0xf
  v_add_f32_dpp v53, v53, v53 quad_perm:[2,3,0,1] row_mask:0xf bank_mask:0xf
  v_add_f32_dpp v54, v54, v54 quad_perm:[2,3,0,1] row_mask:0xf bank_mask:0xf
  v_add_f32_dpp v55, v55, v55 quad_perm:[2,3,0,1] row_mask:0xf bank_mask:0xf
  v_add_f32_dpp v56, v56, v56 quad_perm:[2,3,0,1] row_mask:0xf bank_mask:0xf
  v_add_f32_dpp v57, v57, v57 quad_perm:[2,3,0,1] row_mask:0xf bank_mask:0xf
  v_add_f32_dpp v58, v58, v58 quad_perm:[2,3,0,1] row_mask:0xf bank_mask:0xf
  v_add_f32_dpp v59, v59, v59 quad_perm:[2,3,0,1] row_mask:0xf bank_mask:0xf
  v_add_f32_dpp v60, v60, v60 quad_perm:[2,3,0,1] row_mask:0xf bank_mask:0xf
  v_add_f32_dpp v61, v61, v61 quad_perm:[2,3,0,1] row_mask:0xf bank_mask:0xf
  v_add_f32_dpp v62, v62, v62 quad_perm:[2,3,0,1] row_mask:0xf bank_mask:0xf
  v_add_f32_dpp v63, v63, v63 quad_perm:[2,3,0,1] row_mask:0xf bank_mask:0xf
  v_add_f32_dpp v48, v48, v48 row_half_mirror row_mask:0xf bank_mask:0xf
  v_add_f32_dpp v49, v49, v49 row_half_mirror row_mask:0xf bank_mask:0xf
  v_add_f32_dpp v50, v50, v50 row_half_mirror row_mask:0xf bank_mask:0xf
  v_add_f32_dpp v51, v51, v51 row_half_mirror row_mask:0xf bank_mask:0xf
  v_add_f32_dpp v52, v52, v52 row_half_mirror row_mask:0xf bank_mask:0xf
  v_add_f32_dpp v53, v53, v53 row_half_mirror row_mask:0xf bank_mask:0xf
  v_add_f32_dpp v54, v54, v54 row_half_mirror row_mask:0xf bank_mask:0xf
  v_add_f32_dpp v55, v55, v55 row_half_mirror row_mask:0xf bank_mask:0xf
  v_add_f32_dpp v56, v56, v56 row_half_mirror row_mask:0xf bank_mask:0xf
  v_add_f32_dpp v57, v57, v57 row_half_mirror row_mask:0xf bank_mask:0xf
  v_add_f32_dpp v58, v58, v58 row_half_mirror row_mask:0xf bank_mask:0xf
  v_add_f32_dpp v59, v59, v59 row_half_mirror row_mask:0xf bank_mask:0xf
  v_add_f32_dpp v60, v60, v60 row_half_mirror row_mask:0xf bank_mask:0xf
  v_add_f32_dpp v61, v61, v61 row_half_mirror row_mask:0xf bank_mask:0xf
  v_add_f32_dpp v62, v62, v62 row_half_mirror row_mask:0xf bank_mask:0xf
  v_add_f32_dpp v63, v63, v63 row_half_mirror row_mask:0xf bank_mask:0xf
  s_cmp_eq_u32 s45, 3
  s_cselect_b32 s62, 0, s71
  v_cmp_eq_u32 vcc, 1, v5
  s_nop 1
  v_cndmask_b32 v48, v48, v56, vcc
  v_cndmask_b32 v49, v49, v57, vcc
  v_cndmask_b32 v50, v50, v58, vcc
  v_cndmask_b32 v51, v51, v59, vcc
  v_cndmask_b32 v52, v52, v60, vcc
  v_cndmask_b32 v53, v53, v61, vcc
  v_cndmask_b32 v54, v54, v62, vcc
  v_cndmask_b32 v55, v55, v63, vcc
  v_mov_b32 v6, s71
  v_mov_b32 v7, s62
  v_cndmask_b32 v6, v6, v7, vcc
  v_mul_f32 v48, s71, v48
  v_mul_f32 v49, s71, v49
  v_mul_f32 v50, s71, v50
  v_mul_f32 v51, s71, v51
  v_mul_f32 v52, s71, v52
  v_mul_f32 v53, s71, v53
  v_mul_f32 v54, s71, v54
  v_mul_f32 v55, v6, v55
  v_cvt_pk_bf16_f32 v24, v48, v49
  v_cvt_pk_bf16_f32 v25, v50, v51
  v_cvt_pk_bf16_f32 v26, v52, v53
  v_cvt_pk_bf16_f32 v27, v54, v55
  buffer_store_dwordx4 v[24:27], v126, s[24:27], s65 offen sc1
  s_waitcnt vmcnt(0)
  s_barrier
  s_cmp_lg_u32 s3, 7
  s_cbranch_scc1 f_kernel_sig25
  s_add_u32 s62, s50, s53
  v_lshlrev_b32 v12, 12, v1
  v_mov_b32 v13, s42
  s_add_u32 s62, s62, 65536
  s_mov_b64 exec, 0xff
  buffer_store_dword v13, v12, s[24:27], s62 offen sc1
  s_mov_b64 exec, -1
f_kernel_sig25:
  s_branch f_kernel_jn12
f_kernel_h315:
  s_lshl_b32 s62, s47, 3
  s_add_u32 s62, s62, s3
  s_cmp_ge_u32 s62, 162
  s_cbranch_scc1 f_kernel_wot26
  s_mov_b32 s28, s14
  s_mov_b32 s29, s15
  s_mov_b32 s30, 663552
  s_mov_b32 s31, 0x00020000
  s_mul_i32 s63, s62, 0xe39
  s_lshr_b32 s63, s63, 16
  s_mul_i32 s64, s63, 18
  s_sub_u32 s64, s62, s64
  s_lshl_b32 s62, s62, 10
  s_mul_i32 s65, s45, 165888
  s_add_u32 s62, s62, s65
  s_add_u32 s62, s62, 13631488
  s_lshl_b32 s63, s63, 5
  s_mul_i32 s65, s45, 288
  s_add_u32 s63, s63, s65
  v_lshrrev_b32 v5, 1, v3
  v_mul_u32_u24 v5, 18, v5
  v_and_b32 v6, 1, v3
  v_lshl_add_u32 v5, v6, 2, v5
  v_mul_u32_u24 v6, 0x48, v3
  s_mul_i32 s65, s64, 36
  s_mul_i32 s66, s64, 288
  s_sub_u32 s66, s66, 4592
  s_cmp_lt_u32 s64, 16
  s_cselect_b64 vcc, -1, 0
  s_cselect_b32 s65, s65, s66
  s_cselect_b32 s66, 2, 18
  s_cselect_b32 s68, 8, 36
  s_mul_i32 s66, s66, 1152
  s_mul_i32 s68, s68, 1152
  v_cndmask_b32 v5, v6, v5, vcc
  v_mul_u32_u24 v5, 0x480, v5
  v_lshl_add_u32 v5, v2, 1, v5
  s_mul_i32 s65, s65, 1152
  s_add_u32 s64, s65, s63
  s_add_u32 s65, s64, s66
  s_add_u32 s66, s64, s68
  s_add_u32 s68, s65, s68
  buffer_load_ushort v16, v5, s[28:31], s64 offen
  buffer_load_ushort v20, v5, s[28:31], s64 offen offset:1152
  buffer_load_ushort v17, v5, s[28:31], s65 offen
  buffer_load_ushort v21, v5, s[28:31], s65 offen offset:1152
  buffer_load_ushort v18, v5, s[28:31], s66 offen
  buffer_load_ushort v22, v5, s[28:31], s66 offen offset:1152
  buffer_load_ushort v19, v5, s[28:31], s68 offen
  buffer_load_ushort v23, v5, s[28:31], s68 offen offset:1152
  s_waitcnt vmcnt(6)
  v_lshl_or_b32 v16, v20, 16, v16
  s_waitcnt vmcnt(4)
  v_lshl_or_b32 v17, v21, 16, v17
  s_waitcnt vmcnt(2)
  v_lshl_or_b32 v18, v22, 16, v18
  s_waitcnt vmcnt(0)
  v_lshl_or_b32 v19, v23, 16, v19
  buffer_store_dwordx4 v[16:19], v4, s[24:27], s62 offen sc1
f_kernel_wot26:
f_kernel_jn12:
  s_waitcnt vmcnt(0)
  s_barrier
  s_cmp_lg_u32 s3, 7
  s_cbranch_scc1 f_kernel_sig27
  s_add_u32 s62, s50, s52
  v_lshlrev_b32 v12, 12, v1
  v_mov_b32 v13, s42
  s_add_u32 s62, s62, 131072
  s_mov_b64 exec, 0xff
  buffer_store_dword v13, v12, s[24:27], s62 offen sc1
  s_mov_b64 exec, -1
f_kernel_sig27:
  s_cmp_lg_u32 s43, 0
  s_cbranch_scc1 f_kernel_h416
  s_cmp_ge_u32 s47, 18
  s_cbranch_scc1 f_kernel_h214
  s_lshl_b32 s62, s3, 12
  v_add_u32 v5, s62, v252
  s_and_b32 s62, s3, 1
  s_lshl_b32 s62, s62, 11
  s_add_u32 s62, s62, 32768
  v_add_u32 v6, s62, v252
  s_mul_i32 s62, s3, 4112
  s_add_u32 s62, s62, 36864
  v_add_u32 v7, s62, v4
  v_mov_b32 v144, 0
  v_mov_b32 v145, 0
  v_mov_b32 v146, 0
  v_mov_b32 v147, 0
  v_mov_b32 v148, 0
  v_mov_b32 v149, 0
  v_mov_b32 v150, 0
  v_mov_b32 v151, 0
  v_mov_b32 v152, 0
  v_mov_b32 v153, 0
  v_mov_b32 v154, 0
  v_mov_b32 v155, 0
  v_mov_b32 v156, 0
  v_mov_b32 v157, 0
  v_mov_b32 v158, 0
  v_mov_b32 v159, 0
  s_mul_i32 s64, s45, 165888
  s_lshl_b32 s62, s47, 10
  s_add_u32 s64, s64, s62
  s_add_u32 s64, s64, 12582912
  s_lshl_b32 s62, s3, 7
  s_add_u32 s65, s64, s62
  s_add_u32 s65, s65, 147456
  s_mul_i32 s62, s3, 18432
  s_add_u32 s64, s64, s62
  ds_read_b128 v[80:83], v5 offset:0
  ds_read_b128 v[84:87], v5 offset:1024
  ds_read_b128 v[88:91], v5 offset:2048
  ds_read_b128 v[92:95], v5 offset:3072
  ds_read_b128 v[96:99], v6 offset:0
  ds_read_b128 v[100:103], v6 offset:1024
  ds_read_b128 v[16:19], v252 offset:0
  ds_read_b128 v[20:23], v252 offset:1024
  ds_read_b128 v[24:27], v252 offset:2048
  ds_read_b128 v[28:31], v252 offset:3072
  ds_read_b128 v[32:35], v252 offset:4096
  ds_read_b128 v[36:39], v252 offset:5120
  ds_read_b128 v[40:43], v252 offset:6144
  ds_read_b128 v[44:47], v252 offset:7168
  s_waitcnt lgkmcnt(13)
  v_mfma_f32_16x16x32_bf16 v[152:155], v[80:83], v[232:235], v[152:155]
  ds_read_b128 v[48:51], v252 offset:8192
  s_waitcnt lgkmcnt(13)
  v_mfma_f32_16x16x32_bf16 v[156:159], v[84:87], v[232:235], v[156:159]
  ds_read_b128 v[52:55], v252 offset:9216
  s_waitcnt lgkmcnt(13)
  v_mfma_f32_16x16x32_bf16 v[152:155], v[88:91], v[236:239], v[152:155]
  ds_read_b128 v[56:59], v252 offset:10240
  s_waitcnt lgkmcnt(13)
  v_mfma_f32_16x16x32_bf16 v[156:159], v[92:95], v[236:239], v[156:159]
  ds_read_b128 v[60:63], v252 offset:11264
  s_waitcnt lgkmcnt(13)
  v_mfma_f32_16x16x32_bf16 v[152:155], v[96:99], v[240:243], v[152:155]
  ds_read_b128 v[64:67], v252 offset:12288
  s_waitcnt lgkmcnt(13)
  v_mfma_f32_16x16x32_bf16 v[156:159], v[100:103], v[240:243], v[156:159]
  ds_read_b128 v[68:71], v252 offset:13312
  s_waitcnt lgkmcnt(13)
  v_mfma_f32_16x16x32_bf16 v[144:147], v[16:19], v[160:163], v[144:147]
  ds_read_b128 v[72:75], v252 offset:14336
  s_waitcnt lgkmcnt(13)
  v_mfma_f32_16x16x32_bf16 v[148:151], v[20:23], v[160:163], v[148:151]
  ds_read_b128 v[76:79], v252 offset:15360
  s_waitcnt lgkmcnt(13)
  v_mfma_f32_16x16x32_bf16 v[144:147], v[24:27], v[164:167], v[144:147]
  ds_read_b128 v[16:19], v252 offset:16384
  s_waitcnt lgkmcnt(13)
  v_mfma_f32_16x16x32_bf16 v[148:151], v[28:31], v[164:167], v[148:151]
  ds_read_b128 v[20:23], v252 offset:17408
  s_waitcnt lgkmcnt(13)
  v_mfma_f32_16x16x32_bf16 v[144:147], v[32:35], v[168:171], v[144:147]
  ds_read_b128 v[24:27], v252 offset:18432
  s_waitcnt lgkmcnt(13)
  v_mfma_f32_16x16x32_bf16 v[148:151], v[36:39], v[168:171], v[148:151]
  ds_read_b128 v[28:31], v252 offset:19456
  s_waitcnt lgkmcnt(13)
  v_mfma_f32_16x16x32_bf16 v[144:147], v[40:43], v[172:175], v[144:147]
  ds_read_b128 v[32:35], v252 offset:20480
  s_waitcnt lgkmcnt(13)
  v_mfma_f32_16x16x32_bf16 v[148:151], v[44:47], v[172:175], v[148:151]
  ds_read_b128 v[36:39], v252 offset:21504
  s_waitcnt lgkmcnt(13)
  v_mfma_f32_16x16x32_bf16 v[144:147], v[48:51], v[176:179], v[144:147]
  ds_read_b128 v[40:43], v252 offset:22528
  s_waitcnt lgkmcnt(13)
  v_mfma_f32_16x16x32_bf16 v[148:151], v[52:55], v[176:179], v[148:151]
  ds_read_b128 v[44:47], v252 offset:23552
  s_waitcnt lgkmcnt(13)
  v_mfma_f32_16x16x32_bf16 v[144:147], v[56:59], v[180:183], v[144:147]
  ds_read_b128 v[48:51], v252 offset:24576
  s_waitcnt lgkmcnt(13)
  v_mfma_f32_16x16x32_bf16 v[148:151], v[60:63], v[180:183], v[148:151]
  ds_read_b128 v[52:55], v252 offset:25600
  s_waitcnt lgkmcnt(13)
  v_mfma_f32_16x16x32_bf16 v[144:147], v[64:67], v[184:187], v[144:147]
  ds_read_b128 v[56:59], v252 offset:26624
  s_waitcnt lgkmcnt(13)
  v_mfma_f32_16x16x32_bf16 v[148:151], v[68:71], v[184:187], v[148:151]
  ds_read_b128 v[60:63], v252 offset:27648
  s_waitcnt lgkmcnt(13)
  v_mfma_f32_16x16x32_bf16 v[144:147], v[72:75], v[188:191], v[144:147]
  ds_read_b128 v[64:67], v252 offset:28672
  s_waitcnt lgkmcnt(13)
  v_mfma_f32_16x16x32_bf16 v[148:151], v[76:79], v[188:191], v[148:151]
  ds_read_b128 v[68:71], v252 offset:29696
  s_waitcnt lgkmcnt(13)
  v_mfma_f32_16x16x32_bf16 v[144:147], v[16:19], v[192:195], v[144:147]
  ds_read_b128 v[72:75], v252 offset:30720
  s_waitcnt lgkmcnt(13)
  v_mfma_f32_16x16x32_bf16 v[148:151], v[20:23], v[192:195], v[148:151]
  ds_read_b128 v[76:79], v252 offset:31744
  s_waitcnt lgkmcnt(13)
  v_mfma_f32_16x16x32_bf16 v[144:147], v[24:27], v[196:199], v[144:147]
  ds_read_b128 v[16:19], v252 offset:32768
  s_waitcnt lgkmcnt(13)
  v_mfma_f32_16x16x32_bf16 v[148:151], v[28:31], v[196:199], v[148:151]
  ds_read_b128 v[20:23], v252 offset:33792
  s_waitcnt lgkmcnt(13)
  v_mfma_f32_16x16x32_bf16 v[144:147], v[32:35], v[200:203], v[144:147]
  ds_read_b128 v[24:27], v252 offset:34816
  s_waitcnt lgkmcnt(13)
  v_mfma_f32_16x16x32_bf16 v[148:151], v[36:39], v[200:203], v[148:151]
  ds_read_b128 v[28:31], v252 offset:35840
  s_waitcnt lgkmcnt(13)
  v_mfma_f32_16x16x32_bf16 v[144:147], v[40:43], v[204:207], v[144:147]
  ds_write_b128 v7, v[152:155] offset:0
  s_waitcnt lgkmcnt(13)
  v_mfma_f32_16x16x32_bf16 v[148:151], v[44:47], v[204:207], v[148:151]
  ds_write_b128 v7, v[156:159] offset:1024
  s_waitcnt lgkmcnt(13)
  v_mfma_f32_16x16x32_bf16 v[144:147], v[48:51], v[208:211], v[144:147]
  s_waitcnt lgkmcnt(12)
  v_mfma_f32_16x16x32_bf16 v[148:151], v[52:55], v[208:211], v[148:151]
  s_waitcnt lgkmcnt(11)
  v_mfma_f32_16x16x32_bf16 v[144:147], v[56:59], v[212:215], v[144:147]
  s_waitcnt lgkmcnt(10)
  v_mfma_f32_16x16x32_bf16 v[148:151], v[60:63], v[212:215], v[148:151]
  s_waitcnt lgkmcnt(9)
  v_mfma_f32_16x16x32_bf16 v[144:147], v[64:67], v[216:219], v[144:147]
  s_waitcnt lgkmcnt(8)
  v_mfma_f32_16x16x32_bf16 v[148:151], v[68:71], v[216:219], v[148:151]
  s_waitcnt lgkmcnt(7)
  v_mfma_f32_16x16x32_bf16 v[144:147], v[72:75], v[220:223], v[144:147]
  s_waitcnt lgkmcnt(6)
  v_mfma_f32_16x16x32_bf16 v[148:151], v[76:79], v[220:223], v[148:151]
  s_waitcnt lgkmcnt(5)
  v_mfma_f32_16x16x32_bf16 v[144:147], v[16:19], v[224:227], v[144:147]
  s_waitcnt lgkmcnt(4)
  v_mfma_f32_16x16x32_bf16 v[148:151], v[20:23], v[224:227], v[148:151]
  s_waitcnt lgkmcnt(3)
  v_mfma_f32_16x16x32_bf16 v[144:147], v[24:27], v[228:231], v[144:147]
  s_waitcnt lgkmcnt(2)
  v_mfma_f32_16x16x32_bf16 v[148:151], v[28:31], v[228:231], v[148:151]
  v_and_b32 v5, 7, v1
  v_mul_u32_u24 v10, 4112, v5
  v_lshrrev_b32 v6, 3, v1
  v_lshlrev_b32 v6, 4, v6
  s_lshl_b32 s62, s3, 7
  s_add_u32 s62, s62, 36864
  v_add3_u32 v10, v10, v6, s62
  v_mov_b32 v7, 1073741824
  v_cmp_eq_u32 vcc, 0, v5
  s_nop 1
  v_cndmask_b32 v6, v7, v6, vcc
  v_cvt_pk_bf16_f32 v16, v144, v145
  v_cvt_pk_bf16_f32 v17, v146, v147
  v_cvt_pk_bf16_f32 v18, v148, v149
  v_cvt_pk_bf16_f32 v19, v150, v151
  buffer_store_dwordx4 v[16:19], v4, s[24:27], s64 offen sc1
  s_waitcnt lgkmcnt(0)
  s_barrier
  ds_read_b128 v[24:27], v10 offset:0
  ds_read_b128 v[28:31], v10 offset:1024
  s_waitcnt lgkmcnt(1)
  v_add_f32_dpp v24, v24, v24 quad_perm:[1,0,3,2] row_mask:0xf bank_mask:0xf
  v_add_f32_dpp v25, v25, v25 quad_perm:[1,0,3,2] row_mask:0xf bank_mask:0xf
  v_add_f32_dpp v26, v26, v26 quad_perm:[1,0,3,2] row_mask:0xf bank_mask:0xf
  v_add_f32_dpp v27, v27, v27 quad_perm:[1,0,3,2] row_mask:0xf bank_mask:0xf
  s_waitcnt lgkmcnt(0)
  v_add_f32_dpp v28, v28, v28 quad_perm:[1,0,3,2] row_mask:0xf bank_mask:0xf
  v_add_f32_dpp v29, v29, v29 quad_perm:[1,0,3,2] row_mask:0xf bank_mask:0xf
  v_add_f32_dpp v30, v30, v30 quad_perm:[1,0,3,2] row_mask:0xf bank_mask:0xf
  v_add_f32_dpp v31, v31, v31 quad_perm:[1,0,3,2] row_mask:0xf bank_mask:0xf
  v_add_f32_dpp v24, v24, v24 quad_perm:[2,3,0,1] row_mask:0xf bank_mask:0xf
  v_add_f32_dpp v25, v25, v25 quad_perm:[2,3,0,1] row_mask:0xf bank_mask:0xf
  v_add_f32_dpp v26, v26, v26 quad_perm:[2,3,0,1] row_mask:0xf bank_mask:0xf
  v_add_f32_dpp v27, v27, v27 quad_perm:[2,3,0,1] row_mask:0xf bank_mask:0xf
  v_add_f32_dpp v28, v28, v28 quad_perm:[2,3,0,1] row_mask:0xf bank_mask:0xf
  v_add_f32_dpp v29, v29, v29 quad_perm:[2,3,0,1] row_mask:0xf bank_mask:0xf
  v_add_f32_dpp v30, v30, v30 quad_perm:[2,3,0,1] row_mask:0xf bank_mask:0xf
  v_add_f32_dpp v31, v31, v31 quad_perm:[2,3,0,1] row_mask:0xf bank_mask:0xf
  v_add_f32_dpp v24, v24, v24 row_half_mirror row_mask:0xf bank_mask:0xf
  v_add_f32_dpp v25, v25, v25 row_half_mirror row_mask:0xf bank_mask:0xf
  v_add_f32_dpp v26, v26, v26 row_half_mirror row_mask:0xf bank_mask:0xf
  v_add_f32_dpp v27, v27, v27 row_half_mirror row_mask:0xf bank_mask:0xf
  v_add_f32_dpp v28, v28, v28 row_half_mirror row_mask:0xf bank_mask:0xf
  v_add_f32_dpp v29, v29, v29 row_half_mirror row_mask:0xf bank_mask:0xf
  v_add_f32_dpp v30, v30, v30 row_half_mirror row_mask:0xf bank_mask:0xf
  v_add_f32_dpp v31, v31, v31 row_half_mirror row_mask:0xf bank_mask:0xf
  v_cvt_pk_bf16_f32 v20, v24, v25
  v_cvt_pk_bf16_f32 v21, v26, v27
  v_cvt_pk_bf16_f32 v22, v28, v29
  v_cvt_pk_bf16_f32 v23, v30, v31
  buffer_store_dwordx4 v[20:23], v6, s[24:27], s65 offen sc1
f_kernel_h214:
  s_cmp_lg_u32 s3, 7
  s_cbranch_scc1 f_kernel_wsk28
  s_add_u32 s62, s50, s56
  s_add_u32 s62, s62, 65536
  v_lshlrev_b32 v11, 6, v1
  s_mov_b64 exec, 0x7ffffff
  s_mov_b32 s63, 0
f_kernel_wlp29:
  s_add_u32 s63, s63, 1
  buffer_load_dwordx4 v[12:15], v11, s[24:27], s62 offen sc1
  s_waitcnt vmcnt(0)
  v_xor_b32 v12, s42, v12
  v_xor_b32 v13, s42, v13
  v_xor_b32 v14, s42, v14
  v_xor_b32 v15, s42, v15
  v_or3_b32 v12, v12, v13, v14
  v_or_b32 v12, v12, v15
  v_cmp_ne_u32 vcc, 0, v12
  s_nop 4
  s_cbranch_vccz f_kernel_wdn30
  s_cmp_lt_u32 s63, 20000
  s_cbranch_scc1 f_kernel_wlp29
f_kernel_wdn30:
  s_mov_b64 exec, -1
f_kernel_wsk28:
  s_barrier
f_kernel_h416:
  s_cmp_eq_u32 s3, 7
  s_cbranch_scc1 f_kernel_nob31
  s_and_b32 s62, s41, 7
  s_mul_i32 s62, s62, 258048
  s_mul_i32 s63, s3, 36864
  s_add_u32 s62, s62, s63
  s_add_u32 s70, s62, 10485760
  buffer_load_dwordx4 v[192:195], v4, s[24:27], s70 offen offset:0 sc1
  buffer_load_dwordx4 v[196:199], v4, s[24:27], s70 offen offset:1024 sc1
  buffer_load_dwordx4 v[200:203], v4, s[24:27], s70 offen offset:2048 sc1
  buffer_load_dwordx4 v[204:207], v4, s[24:27], s70 offen offset:3072 sc1
  s_add_u32 s70, s70, 4096
  buffer_load_dwordx4 v[208:211], v4, s[24:27], s70 offen offset:0 sc1
  buffer_load_dwordx4 v[212:215], v4, s[24:27], s70 offen offset:1024 sc1
  buffer_load_dwordx4 v[216:219], v4, s[24:27], s70 offen offset:2048 sc1
  buffer_load_dwordx4 v[220:223], v4, s[24:27], s70 offen offset:3072 sc1
  s_add_u32 s70, s70, 4096
  buffer_load_dwordx4 v[224:227], v4, s[24:27], s70 offen offset:0 sc1
  buffer_load_dwordx4 v[228:231], v4, s[24:27], s70 offen offset:1024 sc1
  buffer_load_dwordx4 v[232:235], v4, s[24:27], s70 offen offset:2048 sc1
  buffer_load_dwordx4 v[236:239], v4, s[24:27], s70 offen offset:3072 sc1
  s_add_u32 s70, s70, 4096
  buffer_load_dwordx4 v[240:243], v4, s[24:27], s70 offen offset:0 sc1
  buffer_load_dwordx4 v[244:247], v4, s[24:27], s70 offen offset:1024 sc1
  buffer_load_dwordx4 v[248:251], v4, s[24:27], s70 offen offset:2048 sc1
  buffer_load_dwordx4 v[188:191], v4, s[24:27], s70 offen offset:3072 sc1
  s_add_u32 s70, s70, 4096
f_kernel_nob31:
  v_and_b32 v10, 31, v1
  v_lshrrev_b32 v16, 5, v1
  v_lshlrev_b32 v17, 4, v10
  v_lshl_add_u32 v5, v16, 10, v17
  v_add_u32 v6, 0x10000, v5
  v_lshl_add_u32 v7, v16, 14, v17
  s_lshr_b32 s62, s44, 1
  s_lshl_b32 s64, s62, 9
  s_lshl_b32 s63, s3, 15
  s_add_u32 s64, s64, s63
  s_add_u32 s64, s64, s48
  s_add_u32 s64, s64, 2359296
  s_mul_i32 s65, s62, 4608
  s_and_b32 s62, s41, 7
  s_mul_i32 s62, s62, 589824
  s_add_u32 s65, s65, s62
  s_add_u32 s65, s65, s49
  s_add_u32 s65, s65, 16777216
  s_and_b32 s62, s3, 1
  s_mul_i32 s62, s62, 294912
  s_cmp_ge_u32 s3, 4
  s_cbranch_scc1 f_kernel_qv32
  s_add_u32 s65, s65, s62
  s_cmp_ge_u32 s3, 2
  s_cselect_b32 s62, 5242880, 0
  s_add_u32 s65, s65, s62
  s_add_u32 s66, s65, 147456
  v_lshlrev_b32 v9, 2, v10
  v_add_u32 v9, 73728, v9
  s_branch f_kernel_qe34
f_kernel_qv32:
  s_add_u32 s65, s65, 1024
  v_lshlrev_b32 v9, 4, v16
  v_add_u32 v9, 73728, v9
  s_cmp_ge_u32 s3, 6
  s_cbranch_scc1 f_kernel_q633
  s_add_u32 s65, s65, s62
  s_add_u32 s65, s65, 5242880
  v_lshrrev_b32 v17, 4, v10
  v_mul_u32_u24 v17, 147456, v17
  v_mul_u32_u24 v18, 20, v16
  v_xor_b32 v18, v18, v2
  v_lshl_add_u32 v8, v18, 4, v17
  s_branch f_kernel_qe34
f_kernel_q633:
  v_lshrrev_b32 v18, 2, v10
  v_mul_u32_u24 v18, 147392, v18
  v_lshl_add_u32 v18, v16, 6, v18
  v_add_u32 v18, 5243392, v18
  v_lshlrev_b32 v19, 7, v16
  v_subrev_u32 v19, 256, v19
  v_cmp_gt_u32 vcc, 16, v10
  s_nop 1
  v_cndmask_b32 v18, v19, v18, vcc
  v_add_u32 v8, v18, v17
  v_mov_b32 v17, 1073741824
  v_cmp_lt_u32 vcc, 23, v10
  s_nop 1
  v_cndmask_b32 v8, v8, v17, vcc
f_kernel_qe34:
  v_cmp_eq_u32 s[68:69], 3, v3
  s_cmp_eq_u32 s3, 7
  s_cbranch_scc1 f_kernel_s735
  s_cmp_eq_u32 s43, 0
  s_cbranch_scc1 f_kernel_ns36
  s_mul_i32 s71, s45, 144
  s_add_u32 s63, s71, 128
  v_add_u32 v58, s63, v2
  v_cvt_f32_u32 v59, v58
  v_mul_f32 v59, s59, v59
  s_lshl_b32 s63, s3, 5
  s_add_u32 s63, s63, 1
  v_lshl_add_u32 v60, v3, 2, s63
  v_mul_u32_u24 v66, v58, v60
  v_cvt_f32_u32 v64, v66
  v_mul_f32 v65, s59, v64
  v_floor_f32 v65, v65
  v_fma_f32 v64, v65, s58, v64
  v_mul_f32 v64, s59, v64
  v_fmamk_f32 v66, v59, 0x3f800000, v64
  v_fmamk_f32 v68, v59, 0x40000000, v64
  v_fmamk_f32 v70, v59, 0x40400000, v64
  v_sin_f32_e64 v65, -v64
  v_cos_f32 v64, v64
  v_sin_f32_e64 v67, -v66
  v_cos_f32 v66, v66
  v_sin_f32_e64 v69, -v68
  v_cos_f32 v68, v68
  v_sin_f32_e64 v71, -v70
  v_cos_f32 v70, v70
  v_add_u32 v60, 16, v60
  v_mul_u32_u24 v74, v58, v60
  v_cvt_f32_u32 v72, v74
  v_mul_f32 v73, s59, v72
  v_floor_f32 v73, v73
  v_fma_f32 v72, v73, s58, v72
  v_mul_f32 v72, s59, v72
  v_fmamk_f32 v74, v59, 0x3f800000, v72
  v_fmamk_f32 v76, v59, 0x40000000, v72
  v_fmamk_f32 v78, v59, 0x40400000, v72
  v_sin_f32_e64 v73, -v72
  v_cos_f32 v72, v72
  v_sin_f32_e64 v75, -v74
  v_cos_f32 v74, v74
  v_sin_f32_e64 v77, -v76
  v_cos_f32 v76, v76
  v_sin_f32_e64 v79, -v78
  v_cos_f32 v78, v78
  v_cvt_pk_bf16_f32 v184, v64, v65
  v_cvt_pk_bf16_f32 v185, v66, v67
  v_cvt_pk_bf16_f32 v186, v68, v69
  v_cvt_pk_bf16_f32 v187, v70, v71
  v_cvt_pk_bf16_f32 v48, v72, v73
  v_cvt_pk_bf16_f32 v49, v74, v75
  v_cvt_pk_bf16_f32 v50, v76, v77
  v_cvt_pk_bf16_f32 v51, v78, v79
  s_cmp_ge_u32 s3, 2
  s_cbranch_scc1 f_kernel_n337
  s_lshl_b32 s63, s3, 4
  s_add_u32 s63, s63, 257
  v_lshl_add_u32 v60, v3, 2, s63
  v_mul_u32_u24 v66, v58, v60
  v_cvt_f32_u32 v64, v66
  v_mul_f32 v65, s59, v64
  v_floor_f32 v65, v65
  v_fma_f32 v64, v65, s58, v64
  v_mul_f32 v64, s59, v64
  v_fmamk_f32 v66, v59, 0x3f800000, v64
  v_fmamk_f32 v68, v59, 0x40000000, v64
  v_fmamk_f32 v70, v59, 0x40400000, v64
  v_sin_f32_e64 v65, -v64
  v_cos_f32 v64, v64
  v_sin_f32_e64 v67, -v66
  v_cos_f32 v66, v66
  v_sin_f32_e64 v69, -v68
  v_cos_f32 v68, v68
  v_sin_f32_e64 v71, -v70
  v_cos_f32 v70, v70
  s_cmp_eq_u32 s3, 0
  s_cbranch_scc1 f_kernel_n438
  v_mul_f32 v57, 0x3f3504f3, v70
  v_cndmask_b32 v70, v70, v57, s[68:69]
  v_mov_b32 v57, 0x3f3504f3
  v_cndmask_b32 v71, v71, v57, s[68:69]
f_kernel_n438:
  v_cvt_pk_bf16_f32 v52, v64, v65
  v_cvt_pk_bf16_f32 v53, v66, v67
  v_cvt_pk_bf16_f32 v54, v68, v69
  v_cvt_pk_bf16_f32 v55, v70, v71
f_kernel_n337:
  s_lshl_b32 s63, s3, 4
  s_add_u32 s63, s63, s71
  v_add_u32 v58, s63, v2
  v_cvt_f32_u32 v59, v58
  v_mul_f32 v59, s59, v59
  v_lshlrev_b32 v60, 4, v58
  v_cvt_f32_u32 v56, v60
  v_mul_f32 v57, s59, v56
  v_floor_f32 v57, v57
  v_fma_f32 v56, v57, s58, v56
  v_mul_f32 v56, s59, v56
  v_cos_f32 v56, v56
  v_lshl_add_u32 v60, v3, 2, 1
  v_mul_u32_u24 v66, v58, v60
  v_cvt_f32_u32 v64, v66
  v_mul_f32 v65, s59, v64
  v_floor_f32 v65, v65
  v_fma_f32 v64, v65, s58, v64
  v_mul_f32 v64, s59, v64
  v_fmamk_f32 v66, v59, 0x3f800000, v64
  v_fmamk_f32 v68, v59, 0x40000000, v64
  v_fmamk_f32 v70, v59, 0x40400000, v64
  v_sin_f32_e64 v65, -v64
  v_cos_f32 v64, v64
  v_sin_f32_e64 v67, -v66
  v_cos_f32 v66, v66
  v_sin_f32_e64 v69, -v68
  v_cos_f32 v68, v68
  v_sin_f32_e64 v71, -v70
  v_cos_f32 v70, v70
  v_add_f32 v56, v56, v56
  v_add_u32 v60, 16, v60
  v_mul_u32_u24 v74, v58, v60
  v_cvt_f32_u32 v72, v74
  v_mul_f32 v73, s59, v72
  v_floor_f32 v73, v73
  v_fma_f32 v72, v73, s58, v72
  v_mul_f32 v72, s59, v72
  v_fmamk_f32 v74, v59, 0x3f800000, v72
  v_fmamk_f32 v76, v59, 0x40000000, v72
  v_fmamk_f32 v78, v59, 0x40400000, v72
  v_sin_f32_e64 v73, -v72
  v_cos_f32 v72, v72
  v_sin_f32_e64 v75, -v74
  v_cos_f32 v74, v74
  v_sin_f32_e64 v77, -v76
  v_cos_f32 v76, v76
  v_sin_f32_e64 v79, -v78
  v_cos_f32 v78, v78
  v_cvt_pk_bf16_f32 v96, v64, v65
  v_cvt_pk_bf16_f32 v97, v66, v67
  v_cvt_pk_bf16_f32 v98, v68, v69
  v_cvt_pk_bf16_f32 v99, v70, v71
  v_pk_fma_f32 v[64:65], v[72:73], v[56:57], v[64:65] op_sel_hi:[1,0,1] neg_lo:[0,0,1] neg_hi:[0,0,1]
  v_pk_fma_f32 v[66:67], v[74:75], v[56:57], v[66:67] op_sel_hi:[1,0,1] neg_lo:[0,0,1] neg_hi:[0,0,1]
  v_pk_fma_f32 v[68:69], v[76:77], v[56:57], v[68:69] op_sel_hi:[1,0,1] neg_lo:[0,0,1] neg_hi:[0,0,1]
  v_pk_fma_f32 v[70:71], v[78:79], v[56:57], v[70:71] op_sel_hi:[1,0,1] neg_lo:[0,0,1] neg_hi:[0,0,1]
  v_cvt_pk_bf16_f32 v100, v72, v73
  v_cvt_pk_bf16_f32 v101, v74, v75
  v_cvt_pk_bf16_f32 v102, v76, v77
  v_cvt_pk_bf16_f32 v103, v78, v79
  v_pk_fma_f32 v[72:73], v[64:65], v[56:57], v[72:73] op_sel_hi:[1,0,1] neg_lo:[0,0,1] neg_hi:[0,0,1]
  v_pk_fma_f32 v[74:75], v[66:67], v[56:57], v[74:75] op_sel_hi:[1,0,1] neg_lo:[0,0,1] neg_hi:[0,0,1]
  v_pk_fma_f32 v[76:77], v[68:69], v[56:57], v[76:77] op_sel_hi:[1,0,1] neg_lo:[0,0,1] neg_hi:[0,0,1]
  v_pk_fma_f32 v[78:79], v[70:71], v[56:57], v[78:79] op_sel_hi:[1,0,1] neg_lo:[0,0,1] neg_hi:[0,0,1]
  v_cvt_pk_bf16_f32 v104, v64, v65
  v_cvt_pk_bf16_f32 v105, v66, v67
  v_cvt_pk_bf16_f32 v106, v68, v69
  v_cvt_pk_bf16_f32 v107, v70, v71
  v_pk_fma_f32 v[64:65], v[72:73], v[56:57], v[64:65] op_sel_hi:[1,0,1] neg_lo:[0,0,1] neg_hi:[0,0,1]
  v_pk_fma_f32 v[66:67], v[74:75], v[56:57], v[66:67] op_sel_hi:[1,0,1] neg_lo:[0,0,1] neg_hi:[0,0,1]
  v_pk_fma_f32 v[68:69], v[76:77], v[56:57], v[68:69] op_sel_hi:[1,0,1] neg_lo:[0,0,1] neg_hi:[0,0,1]
  v_pk_fma_f32 v[70:71], v[78:79], v[56:57], v[70:71] op_sel_hi:[1,0,1] neg_lo:[0,0,1] neg_hi:[0,0,1]
  v_cvt_pk_bf16_f32 v108, v72, v73
  v_cvt_pk_bf16_f32 v109, v74, v75
  v_cvt_pk_bf16_f32 v110, v76, v77
  v_cvt_pk_bf16_f32 v111, v78, v79
  v_pk_fma_f32 v[72:73], v[64:65], v[56:57], v[72:73] op_sel_hi:[1,0,1] neg_lo:[0,0,1] neg_hi:[0,0,1]
  v_pk_fma_f32 v[74:75], v[66:67], v[56:57], v[74:75] op_sel_hi:[1,0,1] neg_lo:[0,0,1] neg_hi:[0,0,1]
  v_pk_fma_f32 v[76:77], v[68:69], v[56:57], v[76:77] op_sel_hi:[1,0,1] neg_lo:[0,0,1] neg_hi:[0,0,1]
  v_pk_fma_f32 v[78:79], v[70:71], v[56:57], v[78:79] op_sel_hi:[1,0,1] neg_lo:[0,0,1] neg_hi:[0,0,1]
  v_cvt_pk_bf16_f32 v112, v64, v65
  v_cvt_pk_bf16_f32 v113, v66, v67
  v_cvt_pk_bf16_f32 v114, v68, v69
  v_cvt_pk_bf16_f32 v115, v70, v71
  v_pk_fma_f32 v[64:65], v[72:73], v[56:57], v[64:65] op_sel_hi:[1,0,1] neg_lo:[0,0,1] neg_hi:[0,0,1]
  v_pk_fma_f32 v[66:67], v[74:75], v[56:57], v[66:67] op_sel_hi:[1,0,1] neg_lo:[0,0,1] neg_hi:[0,0,1]
  v_pk_fma_f32 v[68:69], v[76:77], v[56:57], v[68:69] op_sel_hi:[1,0,1] neg_lo:[0,0,1] neg_hi:[0,0,1]
  v_pk_fma_f32 v[70:71], v[78:79], v[56:57], v[70:71] op_sel_hi:[1,0,1] neg_lo:[0,0,1] neg_hi:[0,0,1]
  v_cvt_pk_bf16_f32 v116, v72, v73
  v_cvt_pk_bf16_f32 v117, v74, v75
  v_cvt_pk_bf16_f32 v118, v76, v77
  v_cvt_pk_bf16_f32 v119, v78, v79
  v_pk_fma_f32 v[72:73], v[64:65], v[56:57], v[72:73] op_sel_hi:[1,0,1] neg_lo:[0,0,1] neg_hi:[0,0,1]
  v_pk_fma_f32 v[74:75], v[66:67], v[56:57], v[74:75] op_sel_hi:[1,0,1] neg_lo:[0,0,1] neg_hi:[0,0,1]
  v_pk_fma_f32 v[76:77], v[68:69], v[56:57], v[76:77] op_sel_hi:[1,0,1] neg_lo:[0,0,1] neg_hi:[0,0,1]
  v_pk_fma_f32 v[78:79], v[70:71], v[56:57], v[78:79] op_sel_hi:[1,0,1] neg_lo:[0,0,1] neg_hi:[0,0,1]
f_kernel_ns36:
f_kernel_s735:
  s_cmp_lg_u32 s3, 7
  s_cbranch_scc1 f_kernel_wsk39
  s_add_u32 s62, s50, s56
  s_add_u32 s62, s62, 131072
  v_lshlrev_b32 v11, 6, v1
  s_mov_b32 s63, 0
f_kernel_wlp40:
  s_add_u32 s63, s63, 1
  buffer_load_dwordx4 v[12:15], v11, s[24:27], s62 offen sc1
  s_waitcnt vmcnt(0)
  v_xor_b32 v12, s42, v12
  v_xor_b32 v13, s42, v13
  v_xor_b32 v14, s42, v14
  v_xor_b32 v15, s42, v15
  v_or3_b32 v12, v12, v13, v14
  v_or_b32 v12, v12, v15
  v_cmp_ne_u32 vcc, 0, v12
  s_nop 4
  s_cbranch_vccz f_kernel_wdn41
  s_cmp_lt_u32 s63, 20000
  s_cbranch_scc1 f_kernel_wlp40
f_kernel_wdn41:
  s_mov_b64 exec, -1
f_kernel_wsk39:
  s_barrier
  s_lshl_b32 s62, s3, 10
  s_mov_b32 m0, s62
  s_nop 0
  buffer_load_dwordx4 v7, s[24:27], s64 offen sc1 lds
  s_add_u32 m0, s62, 8192
  s_add_u32 s64, s64, 262144
  buffer_load_dwordx4 v7, s[24:27], s64 offen sc1 lds
  s_add_u32 m0, s62, 16384
  s_add_u32 s64, s64, 262144
  buffer_load_dwordx4 v7, s[24:27], s64 offen sc1 lds
  s_add_u32 m0, s62, 24576
  s_add_u32 s64, s64, 262144
  buffer_load_dwordx4 v7, s[24:27], s64 offen sc1 lds
  s_add_u32 m0, s62, 32768
  s_add_u32 s64, s64, 262144
  buffer_load_dwordx4 v7, s[24:27], s64 offen sc1 lds
  s_add_u32 m0, s62, 40960
  s_add_u32 s64, s64, 262144
  buffer_load_dwordx4 v7, s[24:27], s64 offen sc1 lds
  s_cmp_ge_u32 s3, 4
  s_cbranch_scc1 f_kernel_mv42
  s_cmp_eq_u32 s43, 0
  s_cbranch_scc1 f_kernel_ns45
  v_cvt_pk_bf16_f32 v120, v64, v65
  v_cvt_pk_bf16_f32 v121, v66, v67
  v_cvt_pk_bf16_f32 v122, v68, v69
  v_cvt_pk_bf16_f32 v123, v70, v71
  v_pk_fma_f32 v[64:65], v[72:73], v[56:57], v[64:65] op_sel_hi:[1,0,1] neg_lo:[0,0,1] neg_hi:[0,0,1]
  v_pk_fma_f32 v[66:67], v[74:75], v[56:57], v[66:67] op_sel_hi:[1,0,1] neg_lo:[0,0,1] neg_hi:[0,0,1]
  v_pk_fma_f32 v[68:69], v[76:77], v[56:57], v[68:69] op_sel_hi:[1,0,1] neg_lo:[0,0,1] neg_hi:[0,0,1]
  v_pk_fma_f32 v[70:71], v[78:79], v[56:57], v[70:71] op_sel_hi:[1,0,1] neg_lo:[0,0,1] neg_hi:[0,0,1]
  v_cvt_pk_bf16_f32 v124, v72, v73
  v_cvt_pk_bf16_f32 v125, v74, v75
  v_cvt_pk_bf16_f32 v126, v76, v77
  v_cvt_pk_bf16_f32 v127, v78, v79
  v_pk_fma_f32 v[72:73], v[64:65], v[56:57], v[72:73] op_sel_hi:[1,0,1] neg_lo:[0,0,1] neg_hi:[0,0,1]
  v_pk_fma_f32 v[74:75], v[66:67], v[56:57], v[74:75] op_sel_hi:[1,0,1] neg_lo:[0,0,1] neg_hi:[0,0,1]
  v_pk_fma_f32 v[76:77], v[68:69], v[56:57], v[76:77] op_sel_hi:[1,0,1] neg_lo:[0,0,1] neg_hi:[0,0,1]
  v_pk_fma_f32 v[78:79], v[70:71], v[56:57], v[78:79] op_sel_hi:[1,0,1] neg_lo:[0,0,1] neg_hi:[0,0,1]
  v_cvt_pk_bf16_f32 v128, v64, v65
  v_cvt_pk_bf16_f32 v129, v66, v67
  v_cvt_pk_bf16_f32 v130, v68, v69
  v_cvt_pk_bf16_f32 v131, v70, v71
  v_pk_fma_f32 v[64:65], v[72:73], v[56:57], v[64:65] op_sel_hi:[1,0,1] neg_lo:[0,0,1] neg_hi:[0,0,1]
  v_pk_fma_f32 v[66:67], v[74:75], v[56:57], v[66:67] op_sel_hi:[1,0,1] neg_lo:[0,0,1] neg_hi:[0,0,1]
  v_pk_fma_f32 v[68:69], v[76:77], v[56:57], v[68:69] op_sel_hi:[1,0,1] neg_lo:[0,0,1] neg_hi:[0,0,1]
  v_pk_fma_f32 v[70:71], v[78:79], v[56:57], v[70:71] op_sel_hi:[1,0,1] neg_lo:[0,0,1] neg_hi:[0,0,1]
  v_cvt_pk_bf16_f32 v132, v72, v73
  v_cvt_pk_bf16_f32 v133, v74, v75
  v_cvt_pk_bf16_f32 v134, v76, v77
  v_cvt_pk_bf16_f32 v135, v78, v79
  v_pk_fma_f32 v[72:73], v[64:65], v[56:57], v[72:73] op_sel_hi:[1,0,1] neg_lo:[0,0,1] neg_hi:[0,0,1]
  v_pk_fma_f32 v[74:75], v[66:67], v[56:57], v[74:75] op_sel_hi:[1,0,1] neg_lo:[0,0,1] neg_hi:[0,0,1]
  v_pk_fma_f32 v[76:77], v[68:69], v[56:57], v[76:77] op_sel_hi:[1,0,1] neg_lo:[0,0,1] neg_hi:[0,0,1]
  v_pk_fma_f32 v[78:79], v[70:71], v[56:57], v[78:79] op_sel_hi:[1,0,1] neg_lo:[0,0,1] neg_hi:[0,0,1]
  v_cvt_pk_bf16_f32 v136, v64, v65
  v_cvt_pk_bf16_f32 v137, v66, v67
  v_cvt_pk_bf16_f32 v138, v68, v69
  v_cvt_pk_bf16_f32 v139, v70, v71
  v_pk_fma_f32 v[64:65], v[72:73], v[56:57], v[64:65] op_sel_hi:[1,0,1] neg_lo:[0,0,1] neg_hi:[0,0,1]
  v_pk_fma_f32 v[66:67], v[74:75], v[56:57], v[66:67] op_sel_hi:[1,0,1] neg_lo:[0,0,1] neg_hi:[0,0,1]
  v_pk_fma_f32 v[68:69], v[76:77], v[56:57], v[68:69] op_sel_hi:[1,0,1] neg_lo:[0,0,1] neg_hi:[0,0,1]
  v_pk_fma_f32 v[70:71], v[78:79], v[56:57], v[70:71] op_sel_hi:[1,0,1] neg_lo:[0,0,1] neg_hi:[0,0,1]
  v_cvt_pk_bf16_f32 v140, v72, v73
  v_cvt_pk_bf16_f32 v141, v74, v75
  v_cvt_pk_bf16_f32 v142, v76, v77
  v_cvt_pk_bf16_f32 v143, v78, v79
  v_pk_fma_f32 v[72:73], v[64:65], v[56:57], v[72:73] op_sel_hi:[1,0,1] neg_lo:[0,0,1] neg_hi:[0,0,1]
  v_pk_fma_f32 v[74:75], v[66:67], v[56:57], v[74:75] op_sel_hi:[1,0,1] neg_lo:[0,0,1] neg_hi:[0,0,1]
  v_pk_fma_f32 v[76:77], v[68:69], v[56:57], v[76:77] op_sel_hi:[1,0,1] neg_lo:[0,0,1] neg_hi:[0,0,1]
  v_pk_fma_f32 v[78:79], v[70:71], v[56:57], v[78:79] op_sel_hi:[1,0,1] neg_lo:[0,0,1] neg_hi:[0,0,1]
  v_cvt_pk_bf16_f32 v160, v64, v65
  v_cvt_pk_bf16_f32 v161, v66, v67
  v_cvt_pk_bf16_f32 v162, v68, v69
  v_cvt_pk_bf16_f32 v163, v70, v71
  v_pk_fma_f32 v[64:65], v[72:73], v[56:57], v[64:65] op_sel_hi:[1,0,1] neg_lo:[0,0,1] neg_hi:[0,0,1]
  v_pk_fma_f32 v[66:67], v[74:75], v[56:57], v[66:67] op_sel_hi:[1,0,1] neg_lo:[0,0,1] neg_hi:[0,0,1]
  v_pk_fma_f32 v[68:69], v[76:77], v[56:57], v[68:69] op_sel_hi:[1,0,1] neg_lo:[0,0,1] neg_hi:[0,0,1]
  v_pk_fma_f32 v[70:71], v[78:79], v[56:57], v[70:71] op_sel_hi:[1,0,1] neg_lo:[0,0,1] neg_hi:[0,0,1]
  v_cvt_pk_bf16_f32 v164, v72, v73
  v_cvt_pk_bf16_f32 v165, v74, v75
  v_cvt_pk_bf16_f32 v166, v76, v77
  v_cvt_pk_bf16_f32 v167, v78, v79
  v_pk_fma_f32 v[72:73], v[64:65], v[56:57], v[72:73] op_sel_hi:[1,0,1] neg_lo:[0,0,1] neg_hi:[0,0,1]
  v_pk_fma_f32 v[74:75], v[66:67], v[56:57], v[74:75] op_sel_hi:[1,0,1] neg_lo:[0,0,1] neg_hi:[0,0,1]
  v_pk_fma_f32 v[76:77], v[68:69], v[56:57], v[76:77] op_sel_hi:[1,0,1] neg_lo:[0,0,1] neg_hi:[0,0,1]
  v_pk_fma_f32 v[78:79], v[70:71], v[56:57], v[78:79] op_sel_hi:[1,0,1] neg_lo:[0,0,1] neg_hi:[0,0,1]
  v_cvt_pk_bf16_f32 v168, v64, v65
  v_cvt_pk_bf16_f32 v169, v66, v67
  v_cvt_pk_bf16_f32 v170, v68, v69
  v_cvt_pk_bf16_f32 v171, v70, v71
  v_pk_fma_f32 v[64:65], v[72:73], v[56:57], v[64:65] op_sel_hi:[1,0,1] neg_lo:[0,0,1] neg_hi:[0,0,1]
  v_pk_fma_f32 v[66:67], v[74:75], v[56:57], v[66:67] op_sel_hi:[1,0,1] neg_lo:[0,0,1] neg_hi:[0,0,1]
  v_pk_fma_f32 v[68:69], v[76:77], v[56:57], v[68:69] op_sel_hi:[1,0,1] neg_lo:[0,0,1] neg_hi:[0,0,1]
  v_pk_fma_f32 v[70:71], v[78:79], v[56:57], v[70:71] op_sel_hi:[1,0,1] neg_lo:[0,0,1] neg_hi:[0,0,1]
  v_cvt_pk_bf16_f32 v172, v72, v73
  v_cvt_pk_bf16_f32 v173, v74, v75
  v_cvt_pk_bf16_f32 v174, v76, v77
  v_cvt_pk_bf16_f32 v175, v78, v79
  v_pk_fma_f32 v[72:73], v[64:65], v[56:57], v[72:73] op_sel_hi:[1,0,1] neg_lo:[0,0,1] neg_hi:[0,0,1]
  v_pk_fma_f32 v[74:75], v[66:67], v[56:57], v[74:75] op_sel_hi:[1,0,1] neg_lo:[0,0,1] neg_hi:[0,0,1]
  v_pk_fma_f32 v[76:77], v[68:69], v[56:57], v[76:77] op_sel_hi:[1,0,1] neg_lo:[0,0,1] neg_hi:[0,0,1]
  v_pk_fma_f32 v[78:79], v[70:71], v[56:57], v[78:79] op_sel_hi:[1,0,1] neg_lo:[0,0,1] neg_hi:[0,0,1]
  v_cvt_pk_bf16_f32 v176, v64, v65
  v_cvt_pk_bf16_f32 v177, v66, v67
  v_cvt_pk_bf16_f32 v178, v68, v69
  v_cvt_pk_bf16_f32 v179, v70, v71
  v_mul_f32 v57, 0x3f3504f3, v78
  v_cndmask_b32 v78, v78, v57, s[68:69]
  v_mov_b32 v57, 0x3f3504f3
  v_cndmask_b32 v79, v79, v57, s[68:69]
  v_cvt_pk_bf16_f32 v180, v72, v73
  v_cvt_pk_bf16_f32 v181, v74, v75
  v_cvt_pk_bf16_f32 v182, v76, v77
  v_cvt_pk_bf16_f32 v183, v78, v79
f_kernel_ns45:
  s_waitcnt vmcnt(3)
  s_barrier
  ds_read_b128 v[16:19], v5 offset:0
  ds_read_b128 v[20:23], v5 offset:512
  ds_read_b128 v[24:27], v5 offset:2048
  ds_read_b128 v[28:31], v5 offset:2560
  ds_read_b128 v[32:35], v5 offset:4096
  ds_read_b128 v[36:39], v5 offset:4608
  s_waitcnt lgkmcnt(4)
  v_swap_b32 v18, v20
  v_swap_b32 v19, v21
  s_nop 1
  v_mfma_f32_32x32x16_bf16 v[64:79], v[192:195], v[16:19], 0
  ds_read_b128 v[40:43], v5 offset:6144
  ds_read_b128 v[44:47], v5 offset:6656
  v_mfma_f32_32x32x16_bf16 v[80:95], v[192:195], v[20:23], 0
  s_add_u32 m0, s62, 49152
  s_add_u32 s64, s64, 262144
  buffer_load_dwordx4 v7, s[24:27], s64 offen sc1 lds
  s_waitcnt lgkmcnt(4)
  v_swap_b32 v26, v28
  v_swap_b32 v27, v29
  s_nop 1
  v_mfma_f32_32x32x16_bf16 v[64:79], v[196:199], v[24:27], v[64:79]
  ds_read_b128 v[16:19], v5 offset:8192
  ds_read_b128 v[20:23], v5 offset:8704
  v_mfma_f32_32x32x16_bf16 v[80:95], v[196:199], v[28:31], v[80:95]
  s_add_u32 m0, s62, 57344
  s_add_u32 s64, s64, 262144
  buffer_load_dwordx4 v7, s[24:27], s64 offen sc1 lds
  s_waitcnt lgkmcnt(4)
  v_swap_b32 v34, v36
  v_swap_b32 v35, v37
  s_nop 1
  v_mfma_f32_32x32x16_bf16 v[64:79], v[200:203], v[32:35], v[64:79]
  ds_read_b128 v[24:27], v5 offset:10240
  ds_read_b128 v[28:31], v5 offset:10752
  v_mfma_f32_32x32x16_bf16 v[80:95], v[200:203], v[36:39], v[80:95]
  s_add_u32 m0, s62, 65536
  s_add_u32 s64, s64, 262144
  buffer_load_dwordx4 v7, s[24:27], s64 offen sc1 lds
  s_waitcnt lgkmcnt(4)
  v_swap_b32 v42, v44
  v_swap_b32 v43, v45
  s_nop 1
  v_mfma_f32_32x32x16_bf16 v[64:79], v[204:207], v[40:43], v[64:79]
  ds_read_b128 v[32:35], v5 offset:12288
  ds_read_b128 v[36:39], v5 offset:12800
  v_mfma_f32_32x32x16_bf16 v[80:95], v[204:207], v[44:47], v[80:95]
  buffer_load_dwordx4 v[192:195], v4, s[24:27], s70 offen offset:0 sc1
  s_waitcnt lgkmcnt(4)
  v_swap_b32 v18, v20
  v_swap_b32 v19, v21
  s_nop 1
  v_mfma_f32_32x32x16_bf16 v[64:79], v[208:211], v[16:19], v[64:79]
  ds_read_b128 v[40:43], v5 offset:14336
  ds_read_b128 v[44:47], v5 offset:14848
  v_mfma_f32_32x32x16_bf16 v[80:95], v[208:211], v[20:23], v[80:95]
  buffer_load_dwordx4 v[196:199], v4, s[24:27], s70 offen offset:1024 sc1
  s_waitcnt lgkmcnt(4)
  v_swap_b32 v26, v28
  v_swap_b32 v27, v29
  s_nop 1
  v_mfma_f32_32x32x16_bf16 v[64:79], v[212:215], v[24:27], v[64:79]
  ds_read_b128 v[16:19], v5 offset:16384
  ds_read_b128 v[20:23], v5 offset:16896
  v_mfma_f32_32x32x16_bf16 v[80:95], v[212:215], v[28:31], v[80:95]
  buffer_load_dwordx4 v[200:203], v4, s[24:27], s70 offen offset:2048 sc1
  s_waitcnt lgkmcnt(4)
  v_swap_b32 v34, v36
  v_swap_b32 v35, v37
  s_nop 1
  v_mfma_f32_32x32x16_bf16 v[64:79], v[216:219], v[32:35], v[64:79]
  ds_read_b128 v[24:27], v5 offset:18432
  ds_read_b128 v[28:31], v5 offset:18944
  v_mfma_f32_32x32x16_bf16 v[80:95], v[216:219], v[36:39], v[80:95]
  buffer_load_dwordx4 v[204:207], v4, s[24:27], s70 offen offset:3072 sc1
  s_add_u32 s70, s70, 4096
  s_waitcnt lgkmcnt(4)
  v_swap_b32 v42, v44
  v_swap_b32 v43, v45
  s_nop 1
  v_mfma_f32_32x32x16_bf16 v[64:79], v[220:223], v[40:43], v[64:79]
  ds_read_b128 v[32:35], v5 offset:20480
  ds_read_b128 v[36:39], v5 offset:20992
  v_mfma_f32_32x32x16_bf16 v[80:95], v[220:223], v[44:47], v[80:95]
  buffer_load_dwordx4 v[208:211], v4, s[24:27], s70 offen offset:0 sc1
  s_waitcnt lgkmcnt(4)
  v_swap_b32 v18, v20
  v_swap_b32 v19, v21
  s_nop 1
  v_mfma_f32_32x32x16_bf16 v[64:79], v[224:227], v[16:19], v[64:79]
  ds_read_b128 v[40:43], v5 offset:22528
  ds_read_b128 v[44:47], v5 offset:23040
  v_mfma_f32_32x32x16_bf16 v[80:95], v[224:227], v[20:23], v[80:95]
  buffer_load_dwordx4 v[212:215], v4, s[24:27], s70 offen offset:1024 sc1
  s_waitcnt lgkmcnt(4)
  v_swap_b32 v26, v28
  v_swap_b32 v27, v29
  s_waitcnt vmcnt(9)
  s_barrier
  v_mfma_f32_32x32x16_bf16 v[64:79], v[228:231], v[24:27], v[64:79]
  ds_read_b128 v[16:19], v5 offset:24576
  ds_read_b128 v[20:23], v5 offset:25088
  v_mfma_f32_32x32x16_bf16 v[80:95], v[228:231], v[28:31], v[80:95]
  buffer_load_dwordx4 v[216:219], v4, s[24:27], s70 offen offset:2048 sc1
  s_waitcnt lgkmcnt(4)
  v_swap_b32 v34, v36
  v_swap_b32 v35, v37
  s_nop 1
  v_mfma_f32_32x32x16_bf16 v[64:79], v[232:235], v[32:35], v[64:79]
  ds_read_b128 v[24:27], v5 offset:26624
  ds_read_b128 v[28:31], v5 offset:27136
  v_mfma_f32_32x32x16_bf16 v[80:95], v[232:235], v[36:39], v[80:95]
  buffer_load_dwordx4 v[220:223], v4, s[24:27], s70 offen offset:3072 sc1
  s_add_u32 s70, s70, 4096
  s_waitcnt lgkmcnt(4)
  v_swap_b32 v42, v44
  v_swap_b32 v43, v45
  s_nop 1
  v_mfma_f32_32x32x16_bf16 v[64:79], v[236:239], v[40:43], v[64:79]
  ds_read_b128 v[32:35], v5 offset:28672
  ds_read_b128 v[36:39], v5 offset:29184
  v_mfma_f32_32x32x16_bf16 v[80:95], v[236:239], v[44:47], v[80:95]
  buffer_load_dwordx4 v[224:227], v4, s[24:27], s70 offen offset:0 sc1
  s_waitcnt lgkmcnt(4)
  v_swap_b32 v18, v20
  v_swap_b32 v19, v21
  s_nop 1
  v_mfma_f32_32x32x16_bf16 v[64:79], v[240:243], v[16:19], v[64:79]
  ds_read_b128 v[40:43], v5 offset:30720
  ds_read_b128 v[44:47], v5 offset:31232
  v_mfma_f32_32x32x16_bf16 v[80:95], v[240:243], v[20:23], v[80:95]
  buffer_load_dwordx4 v[228:231], v4, s[24:27], s70 offen offset:1024 sc1
  s_waitcnt lgkmcnt(4)
  v_swap_b32 v26, v28
  v_swap_b32 v27, v29
  s_nop 1
  v_mfma_f32_32x32x16_bf16 v[64:79], v[244:247], v[24:27], v[64:79]
  ds_read_b128 v[16:19], v5 offset:32768
  ds_read_b128 v[20:23], v5 offset:33280
  v_mfma_f32_32x32x16_bf16 v[80:95], v[244:247], v[28:31], v[80:95]
  buffer_load_dwordx4 v[232:235], v4, s[24:27], s70 offen offset:2048 sc1
  s_waitcnt lgkmcnt(4)
  v_swap_b32 v34, v36
  v_swap_b32 v35, v37
  s_nop 1
  v_mfma_f32_32x32x16_bf16 v[64:79], v[248:251], v[32:35], v[64:79]
  ds_read_b128 v[24:27], v5 offset:34816
  ds_read_b128 v[28:31], v5 offset:35328
  v_mfma_f32_32x32x16_bf16 v[80:95], v[248:251], v[36:39], v[80:95]
  buffer_load_dwordx4 v[236:239], v4, s[24:27], s70 offen offset:3072 sc1
  s_add_u32 s70, s70, 4096
  s_waitcnt lgkmcnt(4)
  v_swap_b32 v42, v44
  v_swap_b32 v43, v45
  s_nop 1
  v_mfma_f32_32x32x16_bf16 v[64:79], v[188:191], v[40:43], v[64:79]
  ds_read_b128 v[32:35], v5 offset:36864
  ds_read_b128 v[36:39], v5 offset:37376
  v_mfma_f32_32x32x16_bf16 v[80:95], v[188:191], v[44:47], v[80:95]
  buffer_load_dwordx4 v[240:243], v4, s[24:27], s70 offen offset:0 sc1
  s_waitcnt lgkmcnt(4)
  v_swap_b32 v18, v20
  v_swap_b32 v19, v21
  s_waitcnt vmcnt(12)
  s_nop 0
  v_mfma_f32_32x32x16_bf16 v[64:79], v[192:195], v[16:19], v[64:79]
  ds_read_b128 v[40:43], v5 offset:38912
  ds_read_b128 v[44:47], v5 offset:39424
  v_mfma_f32_32x32x16_bf16 v[80:95], v[192:195], v[20:23], v[80:95]
  buffer_load_dwordx4 v[244:247], v4, s[24:27], s70 offen offset:1024 sc1
  s_waitcnt lgkmcnt(4)
  v_swap_b32 v26, v28
  v_swap_b32 v27, v29
  s_waitcnt vmcnt(12)
  s_nop 0
  v_mfma_f32_32x32x16_bf16 v[64:79], v[196:199], v[24:27], v[64:79]
  ds_read_b128 v[16:19], v5 offset:40960
  ds_read_b128 v[20:23], v5 offset:41472
  v_mfma_f32_32x32x16_bf16 v[80:95], v[196:199], v[28:31], v[80:95]
  buffer_load_dwordx4 v[248:251], v4, s[24:27], s70 offen offset:2048 sc1
  s_waitcnt lgkmcnt(4)
  v_swap_b32 v34, v36
  v_swap_b32 v35, v37
  s_waitcnt vmcnt(12)
  s_nop 0
  v_mfma_f32_32x32x16_bf16 v[64:79], v[200:203], v[32:35], v[64:79]
  ds_read_b128 v[24:27], v5 offset:43008
  ds_read_b128 v[28:31], v5 offset:43520
  v_mfma_f32_32x32x16_bf16 v[80:95], v[200:203], v[36:39], v[80:95]
  buffer_load_dwordx4 v[188:191], v4, s[24:27], s70 offen offset:3072 sc1
  s_add_u32 s70, s70, 4096
  s_waitcnt lgkmcnt(4)
  v_swap_b32 v42, v44
  v_swap_b32 v43, v45
  s_waitcnt vmcnt(12)
  s_nop 0
  v_mfma_f32_32x32x16_bf16 v[64:79], v[204:207], v[40:43], v[64:79]
  ds_read_b128 v[32:35], v5 offset:45056
  ds_read_b128 v[36:39], v5 offset:45568
  v_mfma_f32_32x32x16_bf16 v[80:95], v[204:207], v[44:47], v[80:95]
  buffer_load_dwordx4 v[192:195], v4, s[24:27], s70 offen offset:0 sc1
  s_waitcnt lgkmcnt(4)
  v_swap_b32 v18, v20
  v_swap_b32 v19, v21
  s_waitcnt vmcnt(12)
  s_nop 0
  v_mfma_f32_32x32x16_bf16 v[64:79], v[208:211], v[16:19], v[64:79]
  ds_read_b128 v[40:43], v5 offset:47104
  ds_read_b128 v[44:47], v5 offset:47616
  v_mfma_f32_32x32x16_bf16 v[80:95], v[208:211], v[20:23], v[80:95]
  buffer_load_dwordx4 v[196:199], v4, s[24:27], s70 offen offset:1024 sc1
  s_waitcnt lgkmcnt(4)
  v_swap_b32 v26, v28
  v_swap_b32 v27, v29
  s_waitcnt vmcnt(18)
  s_barrier
  s_waitcnt vmcnt(12)
  v_mfma_f32_32x32x16_bf16 v[64:79], v[212:215], v[24:27], v[64:79]
  ds_read_b128 v[16:19], v5 offset:49152
  ds_read_b128 v[20:23], v5 offset:49664
  v_mfma_f32_32x32x16_bf16 v[80:95], v[212:215], v[28:31], v[80:95]
  buffer_load_dwordx4 v[200:203], v4, s[24:27], s70 offen offset:2048 sc1
  s_waitcnt lgkmcnt(4)
  v_swap_b32 v34, v36
  v_swap_b32 v35, v37
  s_waitcnt vmcnt(12)
  s_nop 0
  v_mfma_f32_32x32x16_bf16 v[64:79], v[216:219], v[32:35], v[64:79]
  ds_read_b128 v[24:27], v5 offset:51200
  ds_read_b128 v[28:31], v5 offset:51712
  v_mfma_f32_32x32x16_bf16 v[80:95], v[216:219], v[36:39], v[80:95]
  buffer_load_dwordx4 v[204:207], v4, s[24:27], s70 offen offset:3072 sc1
  s_waitcnt lgkmcnt(4)
  v_swap_b32 v42, v44
  v_swap_b32 v43, v45
  s_waitcnt vmcnt(12)
  s_nop 0
  v_mfma_f32_32x32x16_bf16 v[64:79], v[220:223], v[40:43], v[64:79]
  ds_read_b128 v[32:35], v5 offset:53248
  ds_read_b128 v[36:39], v5 offset:53760
  v_mfma_f32_32x32x16_bf16 v[80:95], v[220:223], v[44:47], v[80:95]
  s_waitcnt lgkmcnt(4)
  v_swap_b32 v18, v20
  v_swap_b32 v19, v21
  s_waitcnt vmcnt(11)
  s_nop 0
  v_mfma_f32_32x32x16_bf16 v[64:79], v[224:227], v[16:19], v[64:79]
  ds_read_b128 v[40:43], v5 offset:55296
  ds_read_b128 v[44:47], v5 offset:55808
  v_mfma_f32_32x32x16_bf16 v[80:95], v[224:227], v[20:23], v[80:95]
  s_waitcnt lgkmcnt(4)
  v_swap_b32 v26, v28
  v_swap_b32 v27, v29
  s_waitcnt vmcnt(10)
  s_nop 0
  v_mfma_f32_32x32x16_bf16 v[64:79], v[228:231], v[24:27], v[64:79]
  ds_read_b128 v[16:19], v5 offset:57344
  ds_read_b128 v[20:23], v5 offset:57856
  v_mfma_f32_32x32x16_bf16 v[80:95], v[228:231], v[28:31], v[80:95]
  s_waitcnt lgkmcnt(4)
  v_swap_b32 v34, v36
  v_swap_b32 v35, v37
  s_waitcnt vmcnt(9)
  s_nop 0
  v_mfma_f32_32x32x16_bf16 v[64:79], v[232:235], v[32:35], v[64:79]
  ds_read_b128 v[24:27], v5 offset:59392
  ds_read_b128 v[28:31], v5 offset:59904
  v_mfma_f32_32x32x16_bf16 v[80:95], v[232:235], v[36:39], v[80:95]
  s_waitcnt lgkmcnt(4)
  v_swap_b32 v42, v44
  v_swap_b32 v43, v45
  s_waitcnt vmcnt(8)
  s_nop 0
  v_mfma_f32_32x32x16_bf16 v[64:79], v[236:239], v[40:43], v[64:79]
  ds_read_b128 v[32:35], v5 offset:61440
  ds_read_b128 v[36:39], v5 offset:61952
  v_mfma_f32_32x32x16_bf16 v[80:95], v[236:239], v[44:47], v[80:95]
  s_waitcnt lgkmcnt(4)
  v_swap_b32 v18, v20
  v_swap_b32 v19, v21
  s_waitcnt vmcnt(7)
  s_nop 0
  v_mfma_f32_32x32x16_bf16 v[64:79], v[240:243], v[16:19], v[64:79]
  ds_read_b128 v[40:43], v5 offset:63488
  ds_read_b128 v[44:47], v5 offset:64000
  v_mfma_f32_32x32x16_bf16 v[80:95], v[240:243], v[20:23], v[80:95]
  s_waitcnt lgkmcnt(4)
  v_swap_b32 v26, v28
  v_swap_b32 v27, v29
  s_waitcnt vmcnt(6)
  s_nop 0
  v_mfma_f32_32x32x16_bf16 v[64:79], v[244:247], v[24:27], v[64:79]
  ds_read_b128 v[16:19], v6 offset:0
  ds_read_b128 v[20:23], v6 offset:512
  v_mfma_f32_32x32x16_bf16 v[80:95], v[244:247], v[28:31], v[80:95]
  s_waitcnt lgkmcnt(4)
  v_swap_b32 v34, v36
  v_swap_b32 v35, v37
  s_waitcnt vmcnt(5)
  s_nop 0
  v_mfma_f32_32x32x16_bf16 v[64:79], v[248:251], v[32:35], v[64:79]
  ds_read_b128 v[24:27], v6 offset:2048
  ds_read_b128 v[28:31], v6 offset:2560
  v_mfma_f32_32x32x16_bf16 v[80:95], v[248:251], v[36:39], v[80:95]
  s_waitcnt lgkmcnt(4)
  v_swap_b32 v42, v44
  v_swap_b32 v43, v45
  s_waitcnt vmcnt(4)
  s_nop 0
  v_mfma_f32_32x32x16_bf16 v[64:79], v[188:191], v[40:43], v[64:79]
  ds_read_b128 v[32:35], v6 offset:4096
  ds_read_b128 v[36:39], v6 offset:4608
  v_mfma_f32_32x32x16_bf16 v[80:95], v[188:191], v[44:47], v[80:95]
  s_waitcnt lgkmcnt(4)
  v_swap_b32 v18, v20
  v_swap_b32 v19, v21
  s_waitcnt vmcnt(3)
  s_nop 0
  v_mfma_f32_32x32x16_bf16 v[64:79], v[192:195], v[16:19], v[64:79]
  ds_read_b128 v[40:43], v6 offset:6144
  ds_read_b128 v[44:47], v6 offset:6656
  v_mfma_f32_32x32x16_bf16 v[80:95], v[192:195], v[20:23], v[80:95]
  s_waitcnt lgkmcnt(4)
  v_swap_b32 v26, v28
  v_swap_b32 v27, v29
  s_waitcnt vmcnt(2)
  s_nop 0
  v_mfma_f32_32x32x16_bf16 v[64:79], v[196:199], v[24:27], v[64:79]
  v_mfma_f32_32x32x16_bf16 v[80:95], v[196:199], v[28:31], v[80:95]
  s_waitcnt lgkmcnt(2)
  v_swap_b32 v34, v36
  v_swap_b32 v35, v37
  s_waitcnt vmcnt(1)
  s_nop 0
  v_mfma_f32_32x32x16_bf16 v[64:79], v[200:203], v[32:35], v[64:79]
  v_mfma_f32_32x32x16_bf16 v[80:95], v[200:203], v[36:39], v[80:95]
  s_waitcnt lgkmcnt(0)
  v_swap_b32 v42, v44
  v_swap_b32 v43, v45
  s_waitcnt vmcnt(0)
  s_nop 0
  v_mfma_f32_32x32x16_bf16 v[64:79], v[204:207], v[40:43], v[64:79]
  v_mfma_f32_32x32x16_bf16 v[80:95], v[204:207], v[44:47], v[80:95]
  s_barrier
  ds_read_b32 v16, v9
  ds_read_b32 v18, v9 offset:128
  s_waitcnt lgkmcnt(1)
  s_nop 6
  v_pk_mul_f32 v[64:65], v[64:65], v[16:17] op_sel_hi:[1,0]
  v_pk_mul_f32 v[66:67], v[66:67], v[16:17] op_sel_hi:[1,0]
  v_pk_mul_f32 v[68:69], v[68:69], v[16:17] op_sel_hi:[1,0]
  v_pk_mul_f32 v[70:71], v[70:71], v[16:17] op_sel_hi:[1,0]
  v_cvt_pk_bf16_f32 v64, v64, v65
  v_cvt_pk_bf16_f32 v65, v66, v67
  v_cvt_pk_bf16_f32 v66, v68, v69
  v_cvt_pk_bf16_f32 v67, v70, v71
  buffer_store_dwordx4 v[64:67], v4, s[24:27], s65 offen offset:0 sc1
  v_pk_mul_f32 v[72:73], v[72:73], v[16:17] op_sel_hi:[1,0]
  v_pk_mul_f32 v[74:75], v[74:75], v[16:17] op_sel_hi:[1,0]
  v_pk_mul_f32 v[76:77], v[76:77], v[16:17] op_sel_hi:[1,0]
  v_pk_mul_f32 v[78:79], v[78:79], v[16:17] op_sel_hi:[1,0]
  v_cvt_pk_bf16_f32 v72, v72, v73
  v_cvt_pk_bf16_f32 v73, v74, v75
  v_cvt_pk_bf16_f32 v74, v76, v77
  v_cvt_pk_bf16_f32 v75, v78, v79
  buffer_store_dwordx4 v[72:75], v4, s[24:27], s66 offen offset:0 sc1
  s_waitcnt lgkmcnt(0)
  v_pk_mul_f32 v[80:81], v[80:81], v[18:19] op_sel_hi:[1,0]
  v_pk_mul_f32 v[82:83], v[82:83], v[18:19] op_sel_hi:[1,0]
  v_pk_mul_f32 v[84:85], v[84:85], v[18:19] op_sel_hi:[1,0]
  v_pk_mul_f32 v[86:87], v[86:87], v[18:19] op_sel_hi:[1,0]
  v_cvt_pk_bf16_f32 v80, v80, v81
  v_cvt_pk_bf16_f32 v81, v82, v83
  v_cvt_pk_bf16_f32 v82, v84, v85
  v_cvt_pk_bf16_f32 v83, v86, v87
  buffer_store_dwordx4 v[80:83], v4, s[24:27], s65 offen offset:2304 sc1
  v_pk_mul_f32 v[88:89], v[88:89], v[18:19] op_sel_hi:[1,0]
  v_pk_mul_f32 v[90:91], v[90:91], v[18:19] op_sel_hi:[1,0]
  v_pk_mul_f32 v[92:93], v[92:93], v[18:19] op_sel_hi:[1,0]
  v_pk_mul_f32 v[94:95], v[94:95], v[18:19] op_sel_hi:[1,0]
  v_cvt_pk_bf16_f32 v88, v88, v89
  v_cvt_pk_bf16_f32 v89, v90, v91
  v_cvt_pk_bf16_f32 v90, v92, v93
  v_cvt_pk_bf16_f32 v91, v94, v95
  buffer_store_dwordx4 v[88:91], v4, s[24:27], s66 offen offset:2304 sc1
  s_branch f_kernel_me44
f_kernel_mv42:
  s_cmp_eq_u32 s3, 7
  s_cbranch_scc1 f_kernel_m743
  s_cmp_eq_u32 s43, 0
  s_cbranch_scc1 f_kernel_ns46
  v_cvt_pk_bf16_f32 v120, v64, v65
  v_cvt_pk_bf16_f32 v121, v66, v67
  v_cvt_pk_bf16_f32 v122, v68, v69
  v_cvt_pk_bf16_f32 v123, v70, v71
  v_pk_fma_f32 v[64:65], v[72:73], v[56:57], v[64:65] op_sel_hi:[1,0,1] neg_lo:[0,0,1] neg_hi:[0,0,1]
  v_pk_fma_f32 v[66:67], v[74:75], v[56:57], v[66:67] op_sel_hi:[1,0,1] neg_lo:[0,0,1] neg_hi:[0,0,1]
  v_pk_fma_f32 v[68:69], v[76:77], v[56:57], v[68:69] op_sel_hi:[1,0,1] neg_lo:[0,0,1] neg_hi:[0,0,1]
  v_pk_fma_f32 v[70:71], v[78:79], v[56:57], v[70:71] op_sel_hi:[1,0,1] neg_lo:[0,0,1] neg_hi:[0,0,1]
  v_cvt_pk_bf16_f32 v124, v72, v73
  v_cvt_pk_bf16_f32 v125, v74, v75
  v_cvt_pk_bf16_f32 v126, v76, v77
  v_cvt_pk_bf16_f32 v127, v78, v79
  v_pk_fma_f32 v[72:73], v[64:65], v[56:57], v[72:73] op_sel_hi:[1,0,1] neg_lo:[0,0,1] neg_hi:[0,0,1]
  v_pk_fma_f32 v[74:75], v[66:67], v[56:57], v[74:75] op_sel_hi:[1,0,1] neg_lo:[0,0,1] neg_hi:[0,0,1]
  v_pk_fma_f32 v[76:77], v[68:69], v[56:57], v[76:77] op_sel_hi:[1,0,1] neg_lo:[0,0,1] neg_hi:[0,0,1]
  v_pk_fma_f32 v[78:79], v[70:71], v[56:57], v[78:79] op_sel_hi:[1,0,1] neg_lo:[0,0,1] neg_hi:[0,0,1]
  v_cvt_pk_bf16_f32 v128, v64, v65
  v_cvt_pk_bf16_f32 v129, v66, v67
  v_cvt_pk_bf16_f32 v130, v68, v69
  v_cvt_pk_bf16_f32 v131, v70, v71
  v_pk_fma_f32 v[64:65], v[72:73], v[56:57], v[64:65] op_sel_hi:[1,0,1] neg_lo:[0,0,1] neg_hi:[0,0,1]
  v_pk_fma_f32 v[66:67], v[74:75], v[56:57], v[66:67] op_sel_hi:[1,0,1] neg_lo:[0,0,1] neg_hi:[0,0,1]
  v_pk_fma_f32 v[68:69], v[76:77], v[56:57], v[68:69] op_sel_hi:[1,0,1] neg_lo:[0,0,1] neg_hi:[0,0,1]
  v_pk_fma_f32 v[70:71], v[78:79], v[56:57], v[70:71] op_sel_hi:[1,0,1] neg_lo:[0,0,1] neg_hi:[0,0,1]
  v_cvt_pk_bf16_f32 v132, v72, v73
  v_cvt_pk_bf16_f32 v133, v74, v75
  v_cvt_pk_bf16_f32 v134, v76, v77
  v_cvt_pk_bf16_f32 v135, v78, v79
  v_pk_fma_f32 v[72:73], v[64:65], v[56:57], v[72:73] op_sel_hi:[1,0,1] neg_lo:[0,0,1] neg_hi:[0,0,1]
  v_pk_fma_f32 v[74:75], v[66:67], v[56:57], v[74:75] op_sel_hi:[1,0,1] neg_lo:[0,0,1] neg_hi:[0,0,1]
  v_pk_fma_f32 v[76:77], v[68:69], v[56:57], v[76:77] op_sel_hi:[1,0,1] neg_lo:[0,0,1] neg_hi:[0,0,1]
  v_pk_fma_f32 v[78:79], v[70:71], v[56:57], v[78:79] op_sel_hi:[1,0,1] neg_lo:[0,0,1] neg_hi:[0,0,1]
  v_cvt_pk_bf16_f32 v136, v64, v65
  v_cvt_pk_bf16_f32 v137, v66, v67
  v_cvt_pk_bf16_f32 v138, v68, v69
  v_cvt_pk_bf16_f32 v139, v70, v71
  v_pk_fma_f32 v[64:65], v[72:73], v[56:57], v[64:65] op_sel_hi:[1,0,1] neg_lo:[0,0,1] neg_hi:[0,0,1]
  v_pk_fma_f32 v[66:67], v[74:75], v[56:57], v[66:67] op_sel_hi:[1,0,1] neg_lo:[0,0,1] neg_hi:[0,0,1]
  v_pk_fma_f32 v[68:69], v[76:77], v[56:57], v[68:69] op_sel_hi:[1,0,1] neg_lo:[0,0,1] neg_hi:[0,0,1]
  v_pk_fma_f32 v[70:71], v[78:79], v[56:57], v[70:71] op_sel_hi:[1,0,1] neg_lo:[0,0,1] neg_hi:[0,0,1]
  v_cvt_pk_bf16_f32 v140, v72, v73
  v_cvt_pk_bf16_f32 v141, v74, v75
  v_cvt_pk_bf16_f32 v142, v76, v77
  v_cvt_pk_bf16_f32 v143, v78, v79
  v_pk_fma_f32 v[72:73], v[64:65], v[56:57], v[72:73] op_sel_hi:[1,0,1] neg_lo:[0,0,1] neg_hi:[0,0,1]
  v_pk_fma_f32 v[74:75], v[66:67], v[56:57], v[74:75] op_sel_hi:[1,0,1] neg_lo:[0,0,1] neg_hi:[0,0,1]
  v_pk_fma_f32 v[76:77], v[68:69], v[56:57], v[76:77] op_sel_hi:[1,0,1] neg_lo:[0,0,1] neg_hi:[0,0,1]
  v_pk_fma_f32 v[78:79], v[70:71], v[56:57], v[78:79] op_sel_hi:[1,0,1] neg_lo:[0,0,1] neg_hi:[0,0,1]
f_kernel_ns46:
  s_waitcnt vmcnt(3)
  s_barrier
  ds_read_b128 v[16:19], v5 offset:0
  ds_read_b128 v[20:23], v5 offset:512
  ds_read_b128 v[24:27], v5 offset:2048
  ds_read_b128 v[28:31], v5 offset:2560
  ds_read_b128 v[32:35], v5 offset:4096
  ds_read_b128 v[36:39], v5 offset:4608
  s_waitcnt lgkmcnt(4)
  v_swap_b32 v18, v20
  v_swap_b32 v19, v21
  s_cmp_eq_u32 s43, 0
  s_cbranch_scc1 f_kernel_ns47
  v_cvt_pk_bf16_f32 v160, v64, v65
  v_cvt_pk_bf16_f32 v161, v66, v67
  v_cvt_pk_bf16_f32 v162, v68, v69
  v_cvt_pk_bf16_f32 v163, v70, v71
  v_fma_f32 v64, v72, v56, -v64
  v_fma_f32 v65, v73, v56, -v65
  v_fma_f32 v66, v74, v56, -v66
  v_fma_f32 v67, v75, v56, -v67
  v_fma_f32 v68, v76, v56, -v68
  v_fma_f32 v69, v77, v56, -v69
  v_fma_f32 v70, v78, v56, -v70
  v_fma_f32 v71, v79, v56, -v71
  v_cvt_pk_bf16_f32 v164, v72, v73
  v_cvt_pk_bf16_f32 v165, v74, v75
  v_cvt_pk_bf16_f32 v166, v76, v77
  v_cvt_pk_bf16_f32 v167, v78, v79
  v_fma_f32 v72, v64, v56, -v72
  v_fma_f32 v73, v65, v56, -v73
  v_fma_f32 v74, v66, v56, -v74
  v_fma_f32 v75, v67, v56, -v75
  v_fma_f32 v76, v68, v56, -v76
  v_fma_f32 v77, v69, v56, -v77
  v_fma_f32 v78, v70, v56, -v78
  v_fma_f32 v79, v71, v56, -v79
  v_cvt_pk_bf16_f32 v168, v64, v65
  v_cvt_pk_bf16_f32 v169, v66, v67
  v_cvt_pk_bf16_f32 v170, v68, v69
  v_cvt_pk_bf16_f32 v171, v70, v71
  v_fma_f32 v64, v72, v56, -v64
  v_fma_f32 v65, v73, v56, -v65
  v_fma_f32 v66, v74, v56, -v66
  v_fma_f32 v67, v75, v56, -v67
  v_fma_f32 v68, v76, v56, -v68
  v_fma_f32 v69, v77, v56, -v69
  v_fma_f32 v70, v78, v56, -v70
  v_fma_f32 v71, v79, v56, -v71
  v_cvt_pk_bf16_f32 v172, v72, v73
  v_cvt_pk_bf16_f32 v173, v74, v75
  v_cvt_pk_bf16_f32 v174, v76, v77
  v_cvt_pk_bf16_f32 v175, v78, v79
  v_fma_f32 v72, v64, v56, -v72
  v_fma_f32 v73, v65, v56, -v73
  v_fma_f32 v74, v66, v56, -v74
  v_fma_f32 v75, v67, v56, -v75
  v_fma_f32 v76, v68, v56, -v76
  v_fma_f32 v77, v69, v56, -v77
  v_fma_f32 v78, v70, v56, -v78
  v_fma_f32 v79, v71, v56, -v79
  v_cvt_pk_bf16_f32 v176, v64, v65
  v_cvt_pk_bf16_f32 v177, v66, v67
  v_cvt_pk_bf16_f32 v178, v68, v69
  v_cvt_pk_bf16_f32 v179, v70, v71
  v_mul_f32 v57, 0x3f3504f3, v78
  v_cndmask_b32 v78, v78, v57, s[68:69]
  v_mov_b32 v57, 0x3f3504f3
  v_cndmask_b32 v79, v79, v57, s[68:69]
  v_cvt_pk_bf16_f32 v180, v72, v73
  v_cvt_pk_bf16_f32 v181, v74, v75
  v_cvt_pk_bf16_f32 v182, v76, v77
  v_cvt_pk_bf16_f32 v183, v78, v79
f_kernel_ns47:
  v_mfma_f32_32x32x16_bf16 v[64:79], v[16:19], v[192:195], 0
  ds_read_b128 v[40:43], v5 offset:6144
  ds_read_b128 v[44:47], v5 offset:6656
  v_mfma_f32_32x32x16_bf16 v[80:95], v[20:23], v[192:195], 0
  s_add_u32 m0, s62, 49152
  s_add_u32 s64, s64, 262144
  buffer_load_dwordx4 v7, s[24:27], s64 offen sc1 lds
  s_waitcnt lgkmcnt(4)
  v_swap_b32 v26, v28
  v_swap_b32 v27, v29
  s_nop 1
  v_mfma_f32_32x32x16_bf16 v[64:79], v[24:27], v[196:199], v[64:79]
  ds_read_b128 v[16:19], v5 offset:8192
  ds_read_b128 v[20:23], v5 offset:8704
  v_mfma_f32_32x32x16_bf16 v[80:95], v[28:31], v[196:199], v[80:95]
  s_add_u32 m0, s62, 57344
  s_add_u32 s64, s64, 262144
  buffer_load_dwordx4 v7, s[24:27], s64 offen sc1 lds
  s_waitcnt lgkmcnt(4)
  v_swap_b32 v34, v36
  v_swap_b32 v35, v37
  s_nop 1
  v_mfma_f32_32x32x16_bf16 v[64:79], v[32:35], v[200:203], v[64:79]
  ds_read_b128 v[24:27], v5 offset:10240
  ds_read_b128 v[28:31], v5 offset:10752
  v_mfma_f32_32x32x16_bf16 v[80:95], v[36:39], v[200:203], v[80:95]
  s_add_u32 m0, s62, 65536
  s_add_u32 s64, s64, 262144
  buffer_load_dwordx4 v7, s[24:27], s64 offen sc1 lds
  s_waitcnt lgkmcnt(4)
  v_swap_b32 v42, v44
  v_swap_b32 v43, v45
  s_nop 1
  v_mfma_f32_32x32x16_bf16 v[64:79], v[40:43], v[204:207], v[64:79]
  ds_read_b128 v[32:35], v5 offset:12288
  ds_read_b128 v[36:39], v5 offset:12800
  v_mfma_f32_32x32x16_bf16 v[80:95], v[44:47], v[204:207], v[80:95]
  buffer_load_dwordx4 v[192:195], v4, s[24:27], s70 offen offset:0 sc1
  s_waitcnt lgkmcnt(4)
  v_swap_b32 v18, v20
  v_swap_b32 v19, v21
  s_nop 1
  v_mfma_f32_32x32x16_bf16 v[64:79], v[16:19], v[208:211], v[64:79]
  ds_read_b128 v[40:43], v5 offset:14336
  ds_read_b128 v[44:47], v5 offset:14848
  v_mfma_f32_32x32x16_bf16 v[80:95], v[20:23], v[208:211], v[80:95]
  buffer_load_dwordx4 v[196:199], v4, s[24:27], s70 offen offset:1024 sc1
  s_waitcnt lgkmcnt(4)
  v_swap_b32 v26, v28
  v_swap_b32 v27, v29
  s_nop 1
  v_mfma_f32_32x32x16_bf16 v[64:79], v[24:27], v[212:215], v[64:79]
  ds_read_b128 v[16:19], v5 offset:16384
  ds_read_b128 v[20:23], v5 offset:16896
  v_mfma_f32_32x32x16_bf16 v[80:95], v[28:31], v[212:215], v[80:95]
  buffer_load_dwordx4 v[200:203], v4, s[24:27], s70 offen offset:2048 sc1
  s_waitcnt lgkmcnt(4)
  v_swap_b32 v34, v36
  v_swap_b32 v35, v37
  s_nop 1
  v_mfma_f32_32x32x16_bf16 v[64:79], v[32:35], v[216:219], v[64:79]
  ds_read_b128 v[24:27], v5 offset:18432
  ds_read_b128 v[28:31], v5 offset:18944
  v_mfma_f32_32x32x16_bf16 v[80:95], v[36:39], v[216:219], v[80:95]
  buffer_load_dwordx4 v[204:207], v4, s[24:27], s70 offen offset:3072 sc1
  s_add_u32 s70, s70, 4096
  s_waitcnt lgkmcnt(4)
  v_swap_b32 v42, v44
  v_swap_b32 v43, v45
  s_nop 1
  v_mfma_f32_32x32x16_bf16 v[64:79], v[40:43], v[220:223], v[64:79]
  ds_read_b128 v[32:35], v5 offset:20480
  ds_read_b128 v[36:39], v5 offset:20992
  v_mfma_f32_32x32x16_bf16 v[80:95], v[44:47], v[220:223], v[80:95]
  buffer_load_dwordx4 v[208:211], v4, s[24:27], s70 offen offset:0 sc1
  s_waitcnt lgkmcnt(4)
  v_swap_b32 v18, v20
  v_swap_b32 v19, v21
  s_nop 1
  v_mfma_f32_32x32x16_bf16 v[64:79], v[16:19], v[224:227], v[64:79]
  ds_read_b128 v[40:43], v5 offset:22528
  ds_read_b128 v[44:47], v5 offset:23040
  v_mfma_f32_32x32x16_bf16 v[80:95], v[20:23], v[224:227], v[80:95]
  buffer_load_dwordx4 v[212:215], v4, s[24:27], s70 offen offset:1024 sc1
  s_waitcnt lgkmcnt(4)
  v_swap_b32 v26, v28
  v_swap_b32 v27, v29
  s_waitcnt vmcnt(9)
  s_barrier
  v_mfma_f32_32x32x16_bf16 v[64:79], v[24:27], v[228:231], v[64:79]
  ds_read_b128 v[16:19], v5 offset:24576
  ds_read_b128 v[20:23], v5 offset:25088
  v_mfma_f32_32x32x16_bf16 v[80:95], v[28:31], v[228:231], v[80:95]
  buffer_load_dwordx4 v[216:219], v4, s[24:27], s70 offen offset:2048 sc1
  s_waitcnt lgkmcnt(4)
  v_swap_b32 v34, v36
  v_swap_b32 v35, v37
  s_nop 1
  v_mfma_f32_32x32x16_bf16 v[64:79], v[32:35], v[232:235], v[64:79]
  ds_read_b128 v[24:27], v5 offset:26624
  ds_read_b128 v[28:31], v5 offset:27136
  v_mfma_f32_32x32x16_bf16 v[80:95], v[36:39], v[232:235], v[80:95]
  buffer_load_dwordx4 v[220:223], v4, s[24:27], s70 offen offset:3072 sc1
  s_add_u32 s70, s70, 4096
  s_waitcnt lgkmcnt(4)
  v_swap_b32 v42, v44
  v_swap_b32 v43, v45
  s_nop 1
  v_mfma_f32_32x32x16_bf16 v[64:79], v[40:43], v[236:239], v[64:79]
  ds_read_b128 v[32:35], v5 offset:28672
  ds_read_b128 v[36:39], v5 offset:29184
  v_mfma_f32_32x32x16_bf16 v[80:95], v[44:47], v[236:239], v[80:95]
  buffer_load_dwordx4 v[224:227], v4, s[24:27], s70 offen offset:0 sc1
  s_waitcnt lgkmcnt(4)
  v_swap_b32 v18, v20
  v_swap_b32 v19, v21
  s_nop 1
  v_mfma_f32_32x32x16_bf16 v[64:79], v[16:19], v[240:243], v[64:79]
  ds_read_b128 v[40:43], v5 offset:30720
  ds_read_b128 v[44:47], v5 offset:31232
  v_mfma_f32_32x32x16_bf16 v[80:95], v[20:23], v[240:243], v[80:95]
  buffer_load_dwordx4 v[228:231], v4, s[24:27], s70 offen offset:1024 sc1
  s_waitcnt lgkmcnt(4)
  v_swap_b32 v26, v28
  v_swap_b32 v27, v29
  s_nop 1
  v_mfma_f32_32x32x16_bf16 v[64:79], v[24:27], v[244:247], v[64:79]
  ds_read_b128 v[16:19], v5 offset:32768
  ds_read_b128 v[20:23], v5 offset:33280
  v_mfma_f32_32x32x16_bf16 v[80:95], v[28:31], v[244:247], v[80:95]
  buffer_load_dwordx4 v[232:235], v4, s[24:27], s70 offen offset:2048 sc1
  s_waitcnt lgkmcnt(4)
  v_swap_b32 v34, v36
  v_swap_b32 v35, v37
  s_nop 1
  v_mfma_f32_32x32x16_bf16 v[64:79], v[32:35], v[248:251], v[64:79]
  ds_read_b128 v[24:27], v5 offset:34816
  ds_read_b128 v[28:31], v5 offset:35328
  v_mfma_f32_32x32x16_bf16 v[80:95], v[36:39], v[248:251], v[80:95]
  buffer_load_dwordx4 v[236:239], v4, s[24:27], s70 offen offset:3072 sc1
  s_add_u32 s70, s70, 4096
  s_waitcnt lgkmcnt(4)
  v_swap_b32 v42, v44
  v_swap_b32 v43, v45
  s_nop 1
  v_mfma_f32_32x32x16_bf16 v[64:79], v[40:43], v[188:191], v[64:79]
  ds_read_b128 v[32:35], v5 offset:36864
  ds_read_b128 v[36:39], v5 offset:37376
  v_mfma_f32_32x32x16_bf16 v[80:95], v[44:47], v[188:191], v[80:95]
  buffer_load_dwordx4 v[240:243], v4, s[24:27], s70 offen offset:0 sc1
  s_waitcnt lgkmcnt(4)
  v_swap_b32 v18, v20
  v_swap_b32 v19, v21
  s_waitcnt vmcnt(12)
  s_nop 0
  v_mfma_f32_32x32x16_bf16 v[64:79], v[16:19], v[192:195], v[64:79]
  ds_read_b128 v[40:43], v5 offset:38912
  ds_read_b128 v[44:47], v5 offset:39424
  v_mfma_f32_32x32x16_bf16 v[80:95], v[20:23], v[192:195], v[80:95]
  buffer_load_dwordx4 v[244:247], v4, s[24:27], s70 offen offset:1024 sc1
  s_waitcnt lgkmcnt(4)
  v_swap_b32 v26, v28
  v_swap_b32 v27, v29
  s_waitcnt vmcnt(12)
  s_nop 0
  v_mfma_f32_32x32x16_bf16 v[64:79], v[24:27], v[196:199], v[64:79]
  ds_read_b128 v[16:19], v5 offset:40960
  ds_read_b128 v[20:23], v5 offset:41472
  v_mfma_f32_32x32x16_bf16 v[80:95], v[28:31], v[196:199], v[80:95]
  buffer_load_dwordx4 v[248:251], v4, s[24:27], s70 offen offset:2048 sc1
  s_waitcnt lgkmcnt(4)
  v_swap_b32 v34, v36
  v_swap_b32 v35, v37
  s_waitcnt vmcnt(12)
  s_nop 0
  v_mfma_f32_32x32x16_bf16 v[64:79], v[32:35], v[200:203], v[64:79]
  ds_read_b128 v[24:27], v5 offset:43008
  ds_read_b128 v[28:31], v5 offset:43520
  v_mfma_f32_32x32x16_bf16 v[80:95], v[36:39], v[200:203], v[80:95]
  buffer_load_dwordx4 v[188:191], v4, s[24:27], s70 offen offset:3072 sc1
  s_add_u32 s70, s70, 4096
  s_waitcnt lgkmcnt(4)
  v_swap_b32 v42, v44
  v_swap_b32 v43, v45
  s_waitcnt vmcnt(12)
  s_nop 0
  v_mfma_f32_32x32x16_bf16 v[64:79], v[40:43], v[204:207], v[64:79]
  ds_read_b128 v[32:35], v5 offset:45056
  ds_read_b128 v[36:39], v5 offset:45568
  v_mfma_f32_32x32x16_bf16 v[80:95], v[44:47], v[204:207], v[80:95]
  buffer_load_dwordx4 v[192:195], v4, s[24:27], s70 offen offset:0 sc1
  s_waitcnt lgkmcnt(4)
  v_swap_b32 v18, v20
  v_swap_b32 v19, v21
  s_waitcnt vmcnt(12)
  s_nop 0
  v_mfma_f32_32x32x16_bf16 v[64:79], v[16:19], v[208:211], v[64:79]
  ds_read_b128 v[40:43], v5 offset:47104
  ds_read_b128 v[44:47], v5 offset:47616
  v_mfma_f32_32x32x16_bf16 v[80:95], v[20:23], v[208:211], v[80:95]
  buffer_load_dwordx4 v[196:199], v4, s[24:27], s70 offen offset:1024 sc1
  s_waitcnt lgkmcnt(4)
  v_swap_b32 v26, v28
  v_swap_b32 v27, v29
  s_waitcnt vmcnt(18)
  s_barrier
  s_waitcnt vmcnt(12)
  v_mfma_f32_32x32x16_bf16 v[64:79], v[24:27], v[212:215], v[64:79]
  ds_read_b128 v[16:19], v5 offset:49152
  ds_read_b128 v[20:23], v5 offset:49664
  v_mfma_f32_32x32x16_bf16 v[80:95], v[28:31], v[212:215], v[80:95]
  buffer_load_dwordx4 v[200:203], v4, s[24:27], s70 offen offset:2048 sc1
  s_waitcnt lgkmcnt(4)
  v_swap_b32 v34, v36
  v_swap_b32 v35, v37
  s_waitcnt vmcnt(12)
  s_nop 0
  v_mfma_f32_32x32x16_bf16 v[64:79], v[32:35], v[216:219], v[64:79]
  ds_read_b128 v[24:27], v5 offset:51200
  ds_read_b128 v[28:31], v5 offset:51712
  v_mfma_f32_32x32x16_bf16 v[80:95], v[36:39], v[216:219], v[80:95]
  buffer_load_dwordx4 v[204:207], v4, s[24:27], s70 offen offset:3072 sc1
  s_waitcnt lgkmcnt(4)
  v_swap_b32 v42, v44
  v_swap_b32 v43, v45
  s_waitcnt vmcnt(12)
  s_nop 0
  v_mfma_f32_32x32x16_bf16 v[64:79], v[40:43], v[220:223], v[64:79]
  ds_read_b128 v[32:35], v5 offset:53248
  ds_read_b128 v[36:39], v5 offset:53760
  v_mfma_f32_32x32x16_bf16 v[80:95], v[44:47], v[220:223], v[80:95]
  s_waitcnt lgkmcnt(4)
  v_swap_b32 v18, v20
  v_swap_b32 v19, v21
  s_waitcnt vmcnt(11)
  s_nop 0
  v_mfma_f32_32x32x16_bf16 v[64:79], v[16:19], v[224:227], v[64:79]
  ds_read_b128 v[40:43], v5 offset:55296
  ds_read_b128 v[44:47], v5 offset:55808
  v_mfma_f32_32x32x16_bf16 v[80:95], v[20:23], v[224:227], v[80:95]
  s_waitcnt lgkmcnt(4)
  v_swap_b32 v26, v28
  v_swap_b32 v27, v29
  s_waitcnt vmcnt(10)
  s_nop 0
  v_mfma_f32_32x32x16_bf16 v[64:79], v[24:27], v[228:231], v[64:79]
  ds_read_b128 v[16:19], v5 offset:57344
  ds_read_b128 v[20:23], v5 offset:57856
  v_mfma_f32_32x32x16_bf16 v[80:95], v[28:31], v[228:231], v[80:95]
  s_waitcnt lgkmcnt(4)
  v_swap_b32 v34, v36
  v_swap_b32 v35, v37
  s_waitcnt vmcnt(9)
  s_nop 0
  v_mfma_f32_32x32x16_bf16 v[64:79], v[32:35], v[232:235], v[64:79]
  ds_read_b128 v[24:27], v5 offset:59392
  ds_read_b128 v[28:31], v5 offset:59904
  v_mfma_f32_32x32x16_bf16 v[80:95], v[36:39], v[232:235], v[80:95]
  s_waitcnt lgkmcnt(4)
  v_swap_b32 v42, v44
  v_swap_b32 v43, v45
  s_waitcnt vmcnt(8)
  s_nop 0
  v_mfma_f32_32x32x16_bf16 v[64:79], v[40:43], v[236:239], v[64:79]
  ds_read_b128 v[32:35], v5 offset:61440
  ds_read_b128 v[36:39], v5 offset:61952
  v_mfma_f32_32x32x16_bf16 v[80:95], v[44:47], v[236:239], v[80:95]
  s_waitcnt lgkmcnt(4)
  v_swap_b32 v18, v20
  v_swap_b32 v19, v21
  s_waitcnt vmcnt(7)
  s_nop 0
  v_mfma_f32_32x32x16_bf16 v[64:79], v[16:19], v[240:243], v[64:79]
  ds_read_b128 v[40:43], v5 offset:63488
  ds_read_b128 v[44:47], v5 offset:64000
  v_mfma_f32_32x32x16_bf16 v[80:95], v[20:23], v[240:243], v[80:95]
  s_waitcnt lgkmcnt(4)
  v_swap_b32 v26, v28
  v_swap_b32 v27, v29
  s_waitcnt vmcnt(6)
  s_nop 0
  v_mfma_f32_32x32x16_bf16 v[64:79], v[24:27], v[244:247], v[64:79]
  ds_read_b128 v[16:19], v6 offset:0
  ds_read_b128 v[20:23], v6 offset:512
  v_mfma_f32_32x32x16_bf16 v[80:95], v[28:31], v[244:247], v[80:95]
  s_waitcnt lgkmcnt(4)
  v_swap_b32 v34, v36
  v_swap_b32 v35, v37
  s_waitcnt vmcnt(5)
  s_nop 0
  v_mfma_f32_32x32x16_bf16 v[64:79], v[32:35], v[248:251], v[64:79]
  ds_read_b128 v[24:27], v6 offset:2048
  ds_read_b128 v[28:31], v6 offset:2560
  v_mfma_f32_32x32x16_bf16 v[80:95], v[36:39], v[248:251], v[80:95]
  s_waitcnt lgkmcnt(4)
  v_swap_b32 v42, v44
  v_swap_b32 v43, v45
  s_waitcnt vmcnt(4)
  s_nop 0
  v_mfma_f32_32x32x16_bf16 v[64:79], v[40:43], v[188:191], v[64:79]
  ds_read_b128 v[32:35], v6 offset:4096
  ds_read_b128 v[36:39], v6 offset:4608
  v_mfma_f32_32x32x16_bf16 v[80:95], v[44:47], v[188:191], v[80:95]
  s_waitcnt lgkmcnt(4)
  v_swap_b32 v18, v20
  v_swap_b32 v19, v21
  s_waitcnt vmcnt(3)
  s_nop 0
  v_mfma_f32_32x32x16_bf16 v[64:79], v[16:19], v[192:195], v[64:79]
  ds_read_b128 v[40:43], v6 offset:6144
  ds_read_b128 v[44:47], v6 offset:6656
  v_mfma_f32_32x32x16_bf16 v[80:95], v[20:23], v[192:195], v[80:95]
  s_waitcnt lgkmcnt(4)
  v_swap_b32 v26, v28
  v_swap_b32 v27, v29
  s_waitcnt vmcnt(2)
  s_nop 0
  v_mfma_f32_32x32x16_bf16 v[64:79], v[24:27], v[196:199], v[64:79]
  v_mfma_f32_32x32x16_bf16 v[80:95], v[28:31], v[196:199], v[80:95]
  s_waitcnt lgkmcnt(2)
  v_swap_b32 v34, v36
  v_swap_b32 v35, v37
  s_waitcnt vmcnt(1)
  s_nop 0
  v_mfma_f32_32x32x16_bf16 v[64:79], v[32:35], v[200:203], v[64:79]
  v_mfma_f32_32x32x16_bf16 v[80:95], v[36:39], v[200:203], v[80:95]
  s_waitcnt lgkmcnt(0)
  v_swap_b32 v42, v44
  v_swap_b32 v43, v45
  s_waitcnt vmcnt(0)
  s_nop 0
  v_mfma_f32_32x32x16_bf16 v[64:79], v[40:43], v[204:207], v[64:79]
  v_mfma_f32_32x32x16_bf16 v[80:95], v[44:47], v[204:207], v[80:95]
  s_barrier
  ds_read_b128 v[16:19], v9 offset:0
  ds_read_b128 v[20:23], v9 offset:32
  ds_read_b128 v[24:27], v9 offset:64
  ds_read_b128 v[28:31], v9 offset:96
  ds_read_b128 v[32:35], v9 offset:128
  ds_read_b128 v[36:39], v9 offset:160
  ds_read_b128 v[40:43], v9 offset:192
  ds_read_b128 v[44:47], v9 offset:224
  s_waitcnt lgkmcnt(7)
  s_nop 0
  v_pk_mul_f32 v[64:65], v[64:65], v[16:17]
  v_pk_mul_f32 v[66:67], v[66:67], v[18:19]
  s_waitcnt lgkmcnt(6)
  v_pk_mul_f32 v[68:69], v[68:69], v[20:21]
  v_pk_mul_f32 v[70:71], v[70:71], v[22:23]
  v_cvt_pk_bf16_f32 v64, v64, v65
  v_cvt_pk_bf16_f32 v65, v66, v67
  v_cvt_pk_bf16_f32 v66, v68, v69
  v_cvt_pk_bf16_f32 v67, v70, v71
  buffer_store_dwordx4 v[64:67], v8, s[24:27], s65 offen offset:0 sc1
  s_waitcnt lgkmcnt(5)
  v_pk_mul_f32 v[72:73], v[72:73], v[24:25]
  v_pk_mul_f32 v[74:75], v[74:75], v[26:27]
  s_waitcnt lgkmcnt(4)
  v_pk_mul_f32 v[76:77], v[76:77], v[28:29]
  v_pk_mul_f32 v[78:79], v[78:79], v[30:31]
  v_cvt_pk_bf16_f32 v72, v72, v73
  v_cvt_pk_bf16_f32 v73, v74, v75
  v_cvt_pk_bf16_f32 v74, v76, v77
  v_cvt_pk_bf16_f32 v75, v78, v79
  buffer_store_dwordx4 v[72:75], v8, s[24:27], s65 offen offset:640 sc1
  s_waitcnt lgkmcnt(3)
  v_pk_mul_f32 v[80:81], v[80:81], v[32:33]
  v_pk_mul_f32 v[82:83], v[82:83], v[34:35]
  s_waitcnt lgkmcnt(2)
  v_pk_mul_f32 v[84:85], v[84:85], v[36:37]
  v_pk_mul_f32 v[86:87], v[86:87], v[38:39]
  v_cvt_pk_bf16_f32 v80, v80, v81
  v_cvt_pk_bf16_f32 v81, v82, v83
  v_cvt_pk_bf16_f32 v82, v84, v85
  v_cvt_pk_bf16_f32 v83, v86, v87
  buffer_store_dwordx4 v[80:83], v8, s[24:27], s65 offen offset:2304 sc1
  s_waitcnt lgkmcnt(1)
  v_pk_mul_f32 v[88:89], v[88:89], v[40:41]
  v_pk_mul_f32 v[90:91], v[90:91], v[42:43]
  s_waitcnt lgkmcnt(0)
  v_pk_mul_f32 v[92:93], v[92:93], v[44:45]
  v_pk_mul_f32 v[94:95], v[94:95], v[46:47]
  v_cvt_pk_bf16_f32 v88, v88, v89
  v_cvt_pk_bf16_f32 v89, v90, v91
  v_cvt_pk_bf16_f32 v90, v92, v93
  v_cvt_pk_bf16_f32 v91, v94, v95
  buffer_store_dwordx4 v[88:91], v8, s[24:27], s65 offen offset:2944 sc1
  s_branch f_kernel_me44
f_kernel_m743:
  s_cmp_eq_u32 s43, 0
  s_cbranch_scc1 f_kernel_ns48
  s_mul_i32 s71, s45, 144
  s_add_u32 s63, s71, 128
  v_add_u32 v58, s63, v2
  v_cvt_f32_u32 v59, v58
  v_mul_f32 v59, s59, v59
  s_lshl_b32 s63, s3, 5
  s_add_u32 s63, s63, 1
  v_lshl_add_u32 v60, v3, 2, s63
  v_mul_u32_u24 v66, v58, v60
  v_cvt_f32_u32 v64, v66
  v_mul_f32 v65, s59, v64
  v_floor_f32 v65, v65
  v_fma_f32 v64, v65, s58, v64
  v_mul_f32 v64, s59, v64
  v_fmamk_f32 v66, v59, 0x3f800000, v64
  v_fmamk_f32 v68, v59, 0x40000000, v64
  v_fmamk_f32 v70, v59, 0x40400000, v64
  v_sin_f32_e64 v65, -v64
  v_cos_f32 v64, v64
  v_sin_f32_e64 v67, -v66
  v_cos_f32 v66, v66
  v_sin_f32_e64 v69, -v68
  v_cos_f32 v68, v68
  v_sin_f32_e64 v71, -v70
  v_cos_f32 v70, v70
  v_add_u32 v60, 16, v60
  v_mul_u32_u24 v74, v58, v60
  v_cvt_f32_u32 v72, v74
  v_mul_f32 v73, s59, v72
  v_floor_f32 v73, v73
  v_fma_f32 v72, v73, s58, v72
  v_mul_f32 v72, s59, v72
  v_fmamk_f32 v74, v59, 0x3f800000, v72
  v_fmamk_f32 v76, v59, 0x40000000, v72
  v_fmamk_f32 v78, v59, 0x40400000, v72
  v_sin_f32_e64 v73, -v72
  v_cos_f32 v72, v72
  v_sin_f32_e64 v75, -v74
  v_cos_f32 v74, v74
  v_sin_f32_e64 v77, -v76
  v_cos_f32 v76, v76
  v_sin_f32_e64 v79, -v78
  v_cos_f32 v78, v78
  v_cvt_pk_bf16_f32 v184, v64, v65
  v_cvt_pk_bf16_f32 v185, v66, v67
  v_cvt_pk_bf16_f32 v186, v68, v69
  v_cvt_pk_bf16_f32 v187, v70, v71
  v_cvt_pk_bf16_f32 v48, v72, v73
  v_cvt_pk_bf16_f32 v49, v74, v75
  v_cvt_pk_bf16_f32 v50, v76, v77
  v_cvt_pk_bf16_f32 v51, v78, v79
  s_cmp_ge_u32 s3, 2
  s_cbranch_scc1 f_kernel_n349
  s_lshl_b32 s63, s3, 4
  s_add_u32 s63, s63, 257
  v_lshl_add_u32 v60, v3, 2, s63
  v_mul_u32_u24 v66, v58, v60
  v_cvt_f32_u32 v64, v66
  v_mul_f32 v65, s59, v64
  v_floor_f32 v65, v65
  v_fma_f32 v64, v65, s58, v64
  v_mul_f32 v64, s59, v64
  v_fmamk_f32 v66, v59, 0x3f800000, v64
  v_fmamk_f32 v68, v59, 0x40000000, v64
  v_fmamk_f32 v70, v59, 0x40400000, v64
  v_sin_f32_e64 v65, -v64
  v_cos_f32 v64, v64
  v_sin_f32_e64 v67, -v66
  v_cos_f32 v66, v66
  v_sin_f32_e64 v69, -v68
  v_cos_f32 v68, v68
  v_sin_f32_e64 v71, -v70
  v_cos_f32 v70, v70
  s_cmp_eq_u32 s3, 0
  s_cbranch_scc1 f_kernel_n450
  v_mul_f32 v57, 0x3f3504f3, v70
  v_cndmask_b32 v70, v70, v57, s[68:69]
  v_mov_b32 v57, 0x3f3504f3
  v_cndmask_b32 v71, v71, v57, s[68:69]
f_kernel_n450:
  v_cvt_pk_bf16_f32 v52, v64, v65
  v_cvt_pk_bf16_f32 v53, v66, v67
  v_cvt_pk_bf16_f32 v54, v68, v69
  v_cvt_pk_bf16_f32 v55, v70, v71
f_kernel_n349:
  s_lshl_b32 s63, s3, 4
  s_add_u32 s63, s63, s71
  v_add_u32 v58, s63, v2
  v_cvt_f32_u32 v59, v58
  v_mul_f32 v59, s59, v59
  v_lshlrev_b32 v60, 4, v58
  v_cvt_f32_u32 v56, v60
  v_mul_f32 v57, s59, v56
  v_floor_f32 v57, v57
  v_fma_f32 v56, v57, s58, v56
  v_mul_f32 v56, s59, v56
  v_cos_f32 v56, v56
  v_lshl_add_u32 v60, v3, 2, 1
  v_mul_u32_u24 v66, v58, v60
  v_cvt_f32_u32 v64, v66
  v_mul_f32 v65, s59, v64
  v_floor_f32 v65, v65
  v_fma_f32 v64, v65, s58, v64
  v_mul_f32 v64, s59, v64
  v_fmamk_f32 v66, v59, 0x3f800000, v64
  v_fmamk_f32 v68, v59, 0x40000000, v64
  v_fmamk_f32 v70, v59, 0x40400000, v64
  v_sin_f32_e64 v65, -v64
  v_cos_f32 v64, v64
  v_sin_f32_e64 v67, -v66
  v_cos_f32 v66, v66
  v_sin_f32_e64 v69, -v68
  v_cos_f32 v68, v68
  v_sin_f32_e64 v71, -v70
  v_cos_f32 v70, v70
  v_add_f32 v56, v56, v56
  v_add_u32 v60, 16, v60
  v_mul_u32_u24 v74, v58, v60
  v_cvt_f32_u32 v72, v74
  v_mul_f32 v73, s59, v72
  v_floor_f32 v73, v73
  v_fma_f32 v72, v73, s58, v72
  v_mul_f32 v72, s59, v72
  v_fmamk_f32 v74, v59, 0x3f800000, v72
  v_fmamk_f32 v76, v59, 0x40000000, v72
  v_fmamk_f32 v78, v59, 0x40400000, v72
  v_sin_f32_e64 v73, -v72
  v_cos_f32 v72, v72
  v_sin_f32_e64 v75, -v74
  v_cos_f32 v74, v74
  v_sin_f32_e64 v77, -v76
  v_cos_f32 v76, v76
  v_sin_f32_e64 v79, -v78
  v_cos_f32 v78, v78
f_kernel_ns48:
  s_waitcnt vmcnt(3)
  s_barrier
  ds_read_b128 v[16:19], v5 offset:0
  ds_read_b128 v[20:23], v5 offset:512
  ds_read_b128 v[24:27], v5 offset:2048
  ds_read_b128 v[28:31], v5 offset:2560
  ds_read_b128 v[32:35], v5 offset:4096
  ds_read_b128 v[36:39], v5 offset:4608
  v_lshlrev_b32 v12, 12, v1
  v_mov_b32 v13, s42
  s_mov_b64 exec, 0xff
  buffer_store_dword v13, v12, s[24:27], s55 offen sc1
  s_mov_b64 exec, -1
  v_mov_b32 v80, 0
  v_mov_b32 v81, 0
  v_cmp_lt_u32 vcc, 31, v1
  v_mov_b32 v82, 0xffff
  s_nop 0
  v_cndmask_b32 v82, -1, v82, vcc
  ds_read_b128 v[40:43], v5 offset:6144
  ds_read_b128 v[44:47], v5 offset:6656
  s_add_u32 m0, s62, 49152
  s_add_u32 s64, s64, 262144
  buffer_load_dwordx4 v7, s[24:27], s64 offen sc1 lds
  s_add_u32 m0, s62, 57344
  s_add_u32 s64, s64, 262144
  buffer_load_dwordx4 v7, s[24:27], s64 offen sc1 lds
  s_add_u32 m0, s62, 65536
  s_add_u32 s64, s64, 262144
  buffer_load_dwordx4 v7, s[24:27], s64 offen sc1 lds
  s_cmp_eq_u32 s43, 0
  s_cbranch_scc1 f_kernel_ns51
  v_cvt_pk_bf16_f32 v96, v64, v65
  v_cvt_pk_bf16_f32 v97, v66, v67
  v_cvt_pk_bf16_f32 v98, v68, v69
  v_cvt_pk_bf16_f32 v99, v70, v71
  v_fma_f32 v64, v72, v56, -v64
  v_fma_f32 v65, v73, v56, -v65
  v_fma_f32 v66, v74, v56, -v66
  v_fma_f32 v67, v75, v56, -v67
  v_fma_f32 v68, v76, v56, -v68
  v_fma_f32 v69, v77, v56, -v69
  v_fma_f32 v70, v78, v56, -v70
  v_fma_f32 v71, v79, v56, -v71
  v_cvt_pk_bf16_f32 v100, v72, v73
  v_cvt_pk_bf16_f32 v101, v74, v75
  v_cvt_pk_bf16_f32 v102, v76, v77
  v_cvt_pk_bf16_f32 v103, v78, v79
  v_fma_f32 v72, v64, v56, -v72
  v_fma_f32 v73, v65, v56, -v73
  v_fma_f32 v74, v66, v56, -v74
  v_fma_f32 v75, v67, v56, -v75
  v_fma_f32 v76, v68, v56, -v76
  v_fma_f32 v77, v69, v56, -v77
  v_fma_f32 v78, v70, v56, -v78
  v_fma_f32 v79, v71, v56, -v79
  v_cvt_pk_bf16_f32 v104, v64, v65
  v_cvt_pk_bf16_f32 v105, v66, v67
  v_cvt_pk_bf16_f32 v106, v68, v69
  v_cvt_pk_bf16_f32 v107, v70, v71
  v_fma_f32 v64, v72, v56, -v64
  v_fma_f32 v65, v73, v56, -v65
  v_fma_f32 v66, v74, v56, -v66
  v_fma_f32 v67, v75, v56, -v67
  v_fma_f32 v68, v76, v56, -v68
  v_fma_f32 v69, v77, v56, -v69
  v_fma_f32 v70, v78, v56, -v70
  v_fma_f32 v71, v79, v56, -v71
  v_cvt_pk_bf16_f32 v108, v72, v73
  v_cvt_pk_bf16_f32 v109, v74, v75
  v_cvt_pk_bf16_f32 v110, v76, v77
  v_cvt_pk_bf16_f32 v111, v78, v79
  v_fma_f32 v72, v64, v56, -v72
  v_fma_f32 v73, v65, v56, -v73
  v_fma_f32 v74, v66, v56, -v74
  v_fma_f32 v75, v67, v56, -v75
  v_fma_f32 v76, v68, v56, -v76
  v_fma_f32 v77, v69, v56, -v77
  v_fma_f32 v78, v70, v56, -v78
  v_fma_f32 v79, v71, v56, -v79
  v_cvt_pk_bf16_f32 v112, v64, v65
  v_cvt_pk_bf16_f32 v113, v66, v67
  v_cvt_pk_bf16_f32 v114, v68, v69
  v_cvt_pk_bf16_f32 v115, v70, v71
  v_fma_f32 v64, v72, v56, -v64
  v_fma_f32 v65, v73, v56, -v65
  v_fma_f32 v66, v74, v56, -v66
  v_fma_f32 v67, v75, v56, -v67
  v_fma_f32 v68, v76, v56, -v68
  v_fma_f32 v69, v77, v56, -v69
  v_fma_f32 v70, v78, v56, -v70
  v_fma_f32 v71, v79, v56, -v71
f_kernel_ns51:
  s_waitcnt lgkmcnt(7)
  v_dot2c_f32_bf16 v80, v16, v16
  v_dot2c_f32_bf16 v81, v18, v18
  v_dot2c_f32_bf16 v80, v17, v17
  v_dot2c_f32_bf16 v81, v19, v19
  s_waitcnt lgkmcnt(6)
  v_dot2c_f32_bf16 v80, v20, v20
  v_dot2c_f32_bf16 v81, v22, v22
  v_dot2c_f32_bf16 v80, v21, v21
  v_dot2c_f32_bf16 v81, v23, v23
  ds_read_b128 v[16:19], v5 offset:8192
  ds_read_b128 v[20:23], v5 offset:8704
  s_waitcnt lgkmcnt(7)
  v_dot2c_f32_bf16 v80, v24, v24
  v_dot2c_f32_bf16 v81, v26, v26
  v_dot2c_f32_bf16 v80, v25, v25
  v_dot2c_f32_bf16 v81, v27, v27
  s_waitcnt lgkmcnt(6)
  v_dot2c_f32_bf16 v80, v28, v28
  v_dot2c_f32_bf16 v81, v30, v30
  v_dot2c_f32_bf16 v80, v29, v29
  v_dot2c_f32_bf16 v81, v31, v31
  ds_read_b128 v[24:27], v5 offset:10240
  ds_read_b128 v[28:31], v5 offset:10752
  s_waitcnt lgkmcnt(7)
  v_dot2c_f32_bf16 v80, v32, v32
  v_dot2c_f32_bf16 v81, v34, v34
  v_dot2c_f32_bf16 v80, v33, v33
  v_dot2c_f32_bf16 v81, v35, v35
  s_waitcnt lgkmcnt(6)
  v_dot2c_f32_bf16 v80, v36, v36
  v_dot2c_f32_bf16 v81, v38, v38
  v_dot2c_f32_bf16 v80, v37, v37
  v_dot2c_f32_bf16 v81, v39, v39
  ds_read_b128 v[32:35], v5 offset:12288
  ds_read_b128 v[36:39], v5 offset:12800
  s_waitcnt lgkmcnt(7)
  v_dot2c_f32_bf16 v80, v40, v40
  v_dot2c_f32_bf16 v81, v42, v42
  v_dot2c_f32_bf16 v80, v41, v41
  v_dot2c_f32_bf16 v81, v43, v43
  s_waitcnt lgkmcnt(6)
  v_dot2c_f32_bf16 v80, v44, v44
  v_dot2c_f32_bf16 v81, v46, v46
  v_dot2c_f32_bf16 v80, v45, v45
  v_dot2c_f32_bf16 v81, v47, v47
  ds_read_b128 v[40:43], v5 offset:14336
  ds_read_b128 v[44:47], v5 offset:14848
  s_waitcnt lgkmcnt(7)
  v_dot2c_f32_bf16 v80, v16, v16
  v_dot2c_f32_bf16 v81, v18, v18
  v_dot2c_f32_bf16 v80, v17, v17
  v_dot2c_f32_bf16 v81, v19, v19
  s_waitcnt lgkmcnt(6)
  v_dot2c_f32_bf16 v80, v20, v20
  v_dot2c_f32_bf16 v81, v22, v22
  v_dot2c_f32_bf16 v80, v21, v21
  v_dot2c_f32_bf16 v81, v23, v23
  ds_read_b128 v[16:19], v5 offset:16384
  ds_read_b128 v[20:23], v5 offset:16896
  s_waitcnt lgkmcnt(7)
  v_dot2c_f32_bf16 v80, v24, v24
  v_dot2c_f32_bf16 v81, v26, v26
  v_dot2c_f32_bf16 v80, v25, v25
  v_dot2c_f32_bf16 v81, v27, v27
  s_waitcnt lgkmcnt(6)
  v_dot2c_f32_bf16 v80, v28, v28
  v_dot2c_f32_bf16 v81, v30, v30
  v_dot2c_f32_bf16 v80, v29, v29
  v_dot2c_f32_bf16 v81, v31, v31
  ds_read_b128 v[24:27], v5 offset:18432
  ds_read_b128 v[28:31], v5 offset:18944
  s_waitcnt lgkmcnt(7)
  v_dot2c_f32_bf16 v80, v32, v32
  v_dot2c_f32_bf16 v81, v34, v34
  v_dot2c_f32_bf16 v80, v33, v33
  v_dot2c_f32_bf16 v81, v35, v35
  s_waitcnt lgkmcnt(6)
  v_dot2c_f32_bf16 v80, v36, v36
  v_dot2c_f32_bf16 v81, v38, v38
  v_dot2c_f32_bf16 v80, v37, v37
  v_dot2c_f32_bf16 v81, v39, v39
  ds_read_b128 v[32:35], v5 offset:20480
  ds_read_b128 v[36:39], v5 offset:20992
  s_waitcnt lgkmcnt(7)
  v_dot2c_f32_bf16 v80, v40, v40
  v_dot2c_f32_bf16 v81, v42, v42
  v_dot2c_f32_bf16 v80, v41, v41
  v_dot2c_f32_bf16 v81, v43, v43
  s_waitcnt lgkmcnt(6)
  v_dot2c_f32_bf16 v80, v44, v44
  v_dot2c_f32_bf16 v81, v46, v46
  v_dot2c_f32_bf16 v80, v45, v45
  v_dot2c_f32_bf16 v81, v47, v47
  ds_read_b128 v[40:43], v5 offset:22528
  ds_read_b128 v[44:47], v5 offset:23040
  s_waitcnt lgkmcnt(7)
  v_dot2c_f32_bf16 v80, v16, v16
  v_dot2c_f32_bf16 v81, v18, v18
  v_dot2c_f32_bf16 v80, v17, v17
  v_dot2c_f32_bf16 v81, v19, v19
  s_waitcnt lgkmcnt(6)
  v_dot2c_f32_bf16 v80, v20, v20
  v_dot2c_f32_bf16 v81, v22, v22
  v_dot2c_f32_bf16 v80, v21, v21
  v_dot2c_f32_bf16 v81, v23, v23
  s_waitcnt vmcnt(3)
  s_barrier
  ds_read_b128 v[16:19], v5 offset:24576
  ds_read_b128 v[20:23], v5 offset:25088
  s_cmp_eq_u32 s43, 0
  s_cbranch_scc1 f_kernel_ns52
  v_cvt_pk_bf16_f32 v116, v72, v73
  v_cvt_pk_bf16_f32 v117, v74, v75
  v_cvt_pk_bf16_f32 v118, v76, v77
  v_cvt_pk_bf16_f32 v119, v78, v79
  v_fma_f32 v72, v64, v56, -v72
  v_fma_f32 v73, v65, v56, -v73
  v_fma_f32 v74, v66, v56, -v74
  v_fma_f32 v75, v67, v56, -v75
  v_fma_f32 v76, v68, v56, -v76
  v_fma_f32 v77, v69, v56, -v77
  v_fma_f32 v78, v70, v56, -v78
  v_fma_f32 v79, v71, v56, -v79
  v_cvt_pk_bf16_f32 v120, v64, v65
  v_cvt_pk_bf16_f32 v121, v66, v67
  v_cvt_pk_bf16_f32 v122, v68, v69
  v_cvt_pk_bf16_f32 v123, v70, v71
  v_fma_f32 v64, v72, v56, -v64
  v_fma_f32 v65, v73, v56, -v65
  v_fma_f32 v66, v74, v56, -v66
  v_fma_f32 v67, v75, v56, -v67
  v_fma_f32 v68, v76, v56, -v68
  v_fma_f32 v69, v77, v56, -v69
  v_fma_f32 v70, v78, v56, -v70
  v_fma_f32 v71, v79, v56, -v71
  v_cvt_pk_bf16_f32 v124, v72, v73
  v_cvt_pk_bf16_f32 v125, v74, v75
  v_cvt_pk_bf16_f32 v126, v76, v77
  v_cvt_pk_bf16_f32 v127, v78, v79
  v_fma_f32 v72, v64, v56, -v72
  v_fma_f32 v73, v65, v56, -v73
  v_fma_f32 v74, v66, v56, -v74
  v_fma_f32 v75, v67, v56, -v75
  v_fma_f32 v76, v68, v56, -v76
  v_fma_f32 v77, v69, v56, -v77
  v_fma_f32 v78, v70, v56, -v78
  v_fma_f32 v79, v71, v56, -v79
  v_cvt_pk_bf16_f32 v128, v64, v65
  v_cvt_pk_bf16_f32 v129, v66, v67
  v_cvt_pk_bf16_f32 v130, v68, v69
  v_cvt_pk_bf16_f32 v131, v70, v71
  v_fma_f32 v64, v72, v56, -v64
  v_fma_f32 v65, v73, v56, -v65
  v_fma_f32 v66, v74, v56, -v66
  v_fma_f32 v67, v75, v56, -v67
  v_fma_f32 v68, v76, v56, -v68
  v_fma_f32 v69, v77, v56, -v69
  v_fma_f32 v70, v78, v56, -v70
  v_fma_f32 v71, v79, v56, -v71
  v_cvt_pk_bf16_f32 v132, v72, v73
  v_cvt_pk_bf16_f32 v133, v74, v75
  v_cvt_pk_bf16_f32 v134, v76, v77
  v_cvt_pk_bf16_f32 v135, v78, v79
  v_fma_f32 v72, v64, v56, -v72
  v_fma_f32 v73, v65, v56, -v73
  v_fma_f32 v74, v66, v56, -v74
  v_fma_f32 v75, v67, v56, -v75
  v_fma_f32 v76, v68, v56, -v76
  v_fma_f32 v77, v69, v56, -v77
  v_fma_f32 v78, v70, v56, -v78
  v_fma_f32 v79, v71, v56, -v79
  v_cvt_pk_bf16_f32 v136, v64, v65
  v_cvt_pk_bf16_f32 v137, v66, v67
  v_cvt_pk_bf16_f32 v138, v68, v69
  v_cvt_pk_bf16_f32 v139, v70, v71
  v_fma_f32 v64, v72, v56, -v64
  v_fma_f32 v65, v73, v56, -v65
  v_fma_f32 v66, v74, v56, -v66
  v_fma_f32 v67, v75, v56, -v67
  v_fma_f32 v68, v76, v56, -v68
  v_fma_f32 v69, v77, v56, -v69
  v_fma_f32 v70, v78, v56, -v70
  v_fma_f32 v71, v79, v56, -v71
f_kernel_ns52:
  s_waitcnt lgkmcnt(7)
  v_dot2c_f32_bf16 v80, v24, v24
  v_dot2c_f32_bf16 v81, v26, v26
  v_dot2c_f32_bf16 v80, v25, v25
  v_dot2c_f32_bf16 v81, v27, v27
  s_waitcnt lgkmcnt(6)
  v_dot2c_f32_bf16 v80, v28, v28
  v_dot2c_f32_bf16 v81, v30, v30
  v_dot2c_f32_bf16 v80, v29, v29
  v_dot2c_f32_bf16 v81, v31, v31
  ds_read_b128 v[24:27], v5 offset:26624
  ds_read_b128 v[28:31], v5 offset:27136
  s_waitcnt lgkmcnt(7)
  v_dot2c_f32_bf16 v80, v32, v32
  v_dot2c_f32_bf16 v81, v34, v34
  v_dot2c_f32_bf16 v80, v33, v33
  v_dot2c_f32_bf16 v81, v35, v35
  s_waitcnt lgkmcnt(6)
  v_dot2c_f32_bf16 v80, v36, v36
  v_dot2c_f32_bf16 v81, v38, v38
  v_dot2c_f32_bf16 v80, v37, v37
  v_dot2c_f32_bf16 v81, v39, v39
  ds_read_b128 v[32:35], v5 offset:28672
  ds_read_b128 v[36:39], v5 offset:29184
  s_waitcnt lgkmcnt(7)
  v_dot2c_f32_bf16 v80, v40, v40
  v_dot2c_f32_bf16 v81, v42, v42
  v_dot2c_f32_bf16 v80, v41, v41
  v_dot2c_f32_bf16 v81, v43, v43
  s_waitcnt lgkmcnt(6)
  v_dot2c_f32_bf16 v80, v44, v44
  v_dot2c_f32_bf16 v81, v46, v46
  v_dot2c_f32_bf16 v80, v45, v45
  v_dot2c_f32_bf16 v81, v47, v47
  ds_read_b128 v[40:43], v5 offset:30720
  ds_read_b128 v[44:47], v5 offset:31232
  s_waitcnt lgkmcnt(7)
  v_dot2c_f32_bf16 v80, v16, v16
  v_dot2c_f32_bf16 v81, v18, v18
  v_dot2c_f32_bf16 v80, v17, v17
  v_dot2c_f32_bf16 v81, v19, v19
  s_waitcnt lgkmcnt(6)
  v_dot2c_f32_bf16 v80, v20, v20
  v_dot2c_f32_bf16 v81, v22, v22
  v_dot2c_f32_bf16 v80, v21, v21
  v_dot2c_f32_bf16 v81, v23, v23
  ds_read_b128 v[16:19], v5 offset:32768
  ds_read_b128 v[20:23], v5 offset:33280
  s_waitcnt lgkmcnt(7)
  v_dot2c_f32_bf16 v80, v24, v24
  v_dot2c_f32_bf16 v81, v26, v26
  v_dot2c_f32_bf16 v80, v25, v25
  v_dot2c_f32_bf16 v81, v27, v27
  s_waitcnt lgkmcnt(6)
  v_dot2c_f32_bf16 v80, v28, v28
  v_dot2c_f32_bf16 v81, v30, v30
  v_dot2c_f32_bf16 v80, v29, v29
  v_dot2c_f32_bf16 v81, v31, v31
  ds_read_b128 v[24:27], v5 offset:34816
  ds_read_b128 v[28:31], v5 offset:35328
  s_waitcnt lgkmcnt(7)
  v_dot2c_f32_bf16 v80, v32, v32
  v_dot2c_f32_bf16 v81, v34, v34
  v_dot2c_f32_bf16 v80, v33, v33
  v_dot2c_f32_bf16 v81, v35, v35
  s_waitcnt lgkmcnt(6)
  v_dot2c_f32_bf16 v80, v36, v36
  v_dot2c_f32_bf16 v81, v38, v38
  v_dot2c_f32_bf16 v80, v37, v37
  v_dot2c_f32_bf16 v81, v39, v39
  ds_read_b128 v[32:35], v5 offset:36864
  ds_read_b128 v[36:39], v5 offset:37376
  s_waitcnt lgkmcnt(7)
  v_dot2c_f32_bf16 v80, v40, v40
  v_dot2c_f32_bf16 v81, v42, v42
  v_dot2c_f32_bf16 v80, v41, v41
  v_dot2c_f32_bf16 v81, v43, v43
  s_waitcnt lgkmcnt(6)
  v_dot2c_f32_bf16 v80, v44, v44
  v_dot2c_f32_bf16 v81, v46, v46
  v_dot2c_f32_bf16 v80, v45, v45
  v_dot2c_f32_bf16 v81, v47, v47
  ds_read_b128 v[40:43], v5 offset:38912
  ds_read_b128 v[44:47], v5 offset:39424
  s_waitcnt lgkmcnt(7)
  v_dot2c_f32_bf16 v80, v16, v16
  v_dot2c_f32_bf16 v81, v18, v18
  v_dot2c_f32_bf16 v80, v17, v17
  v_dot2c_f32_bf16 v81, v19, v19
  s_waitcnt lgkmcnt(6)
  v_dot2c_f32_bf16 v80, v20, v20
  v_dot2c_f32_bf16 v81, v22, v22
  v_dot2c_f32_bf16 v80, v21, v21
  v_dot2c_f32_bf16 v81, v23, v23
  ds_read_b128 v[16:19], v5 offset:40960
  ds_read_b128 v[20:23], v5 offset:41472
  s_waitcnt lgkmcnt(7)
  v_dot2c_f32_bf16 v80, v24, v24
  v_dot2c_f32_bf16 v81, v26, v26
  v_dot2c_f32_bf16 v80, v25, v25
  v_dot2c_f32_bf16 v81, v27, v27
  s_waitcnt lgkmcnt(6)
  v_dot2c_f32_bf16 v80, v28, v28
  v_dot2c_f32_bf16 v81, v30, v30
  v_dot2c_f32_bf16 v80, v29, v29
  v_dot2c_f32_bf16 v81, v31, v31
  ds_read_b128 v[24:27], v5 offset:43008
  ds_read_b128 v[28:31], v5 offset:43520
  s_waitcnt lgkmcnt(7)
  v_dot2c_f32_bf16 v80, v32, v32
  v_dot2c_f32_bf16 v81, v34, v34
  v_dot2c_f32_bf16 v80, v33, v33
  v_dot2c_f32_bf16 v81, v35, v35
  s_waitcnt lgkmcnt(6)
  v_dot2c_f32_bf16 v80, v36, v36
  v_dot2c_f32_bf16 v81, v38, v38
  v_dot2c_f32_bf16 v80, v37, v37
  v_dot2c_f32_bf16 v81, v39, v39
  ds_read_b128 v[32:35], v5 offset:45056
  ds_read_b128 v[36:39], v5 offset:45568
  s_waitcnt lgkmcnt(7)
  v_dot2c_f32_bf16 v80, v40, v40
  v_dot2c_f32_bf16 v81, v42, v42
  v_dot2c_f32_bf16 v80, v41, v41
  v_dot2c_f32_bf16 v81, v43, v43
  s_waitcnt lgkmcnt(6)
  v_dot2c_f32_bf16 v80, v44, v44
  v_dot2c_f32_bf16 v81, v46, v46
  v_dot2c_f32_bf16 v80, v45, v45
  v_dot2c_f32_bf16 v81, v47, v47
  ds_read_b128 v[40:43], v5 offset:47104
  ds_read_b128 v[44:47], v5 offset:47616
  s_waitcnt lgkmcnt(7)
  v_dot2c_f32_bf16 v80, v16, v16
  v_dot2c_f32_bf16 v81, v18, v18
  v_dot2c_f32_bf16 v80, v17, v17
  v_dot2c_f32_bf16 v81, v19, v19
  s_waitcnt lgkmcnt(6)
  v_dot2c_f32_bf16 v80, v20, v20
  v_dot2c_f32_bf16 v81, v22, v22
  v_dot2c_f32_bf16 v80, v21, v21
  v_dot2c_f32_bf16 v81, v23, v23
  s_waitcnt vmcnt(0)
  s_barrier
  ds_read_b128 v[16:19], v5 offset:49152
  ds_read_b128 v[20:23], v5 offset:49664
  s_cmp_eq_u32 s43, 0
  s_cbranch_scc1 f_kernel_ns53
  v_cvt_pk_bf16_f32 v140, v72, v73
  v_cvt_pk_bf16_f32 v141, v74, v75
  v_cvt_pk_bf16_f32 v142, v76, v77
  v_cvt_pk_bf16_f32 v143, v78, v79
  v_fma_f32 v72, v64, v56, -v72
  v_fma_f32 v73, v65, v56, -v73
  v_fma_f32 v74, v66, v56, -v74
  v_fma_f32 v75, v67, v56, -v75
  v_fma_f32 v76, v68, v56, -v76
  v_fma_f32 v77, v69, v56, -v77
  v_fma_f32 v78, v70, v56, -v78
  v_fma_f32 v79, v71, v56, -v79
  v_cvt_pk_bf16_f32 v160, v64, v65
  v_cvt_pk_bf16_f32 v161, v66, v67
  v_cvt_pk_bf16_f32 v162, v68, v69
  v_cvt_pk_bf16_f32 v163, v70, v71
  v_fma_f32 v64, v72, v56, -v64
  v_fma_f32 v65, v73, v56, -v65
  v_fma_f32 v66, v74, v56, -v66
  v_fma_f32 v67, v75, v56, -v67
  v_fma_f32 v68, v76, v56, -v68
  v_fma_f32 v69, v77, v56, -v69
  v_fma_f32 v70, v78, v56, -v70
  v_fma_f32 v71, v79, v56, -v71
  v_cvt_pk_bf16_f32 v164, v72, v73
  v_cvt_pk_bf16_f32 v165, v74, v75
  v_cvt_pk_bf16_f32 v166, v76, v77
  v_cvt_pk_bf16_f32 v167, v78, v79
  v_fma_f32 v72, v64, v56, -v72
  v_fma_f32 v73, v65, v56, -v73
  v_fma_f32 v74, v66, v56, -v74
  v_fma_f32 v75, v67, v56, -v75
  v_fma_f32 v76, v68, v56, -v76
  v_fma_f32 v77, v69, v56, -v77
  v_fma_f32 v78, v70, v56, -v78
  v_fma_f32 v79, v71, v56, -v79
  v_cvt_pk_bf16_f32 v168, v64, v65
  v_cvt_pk_bf16_f32 v169, v66, v67
  v_cvt_pk_bf16_f32 v170, v68, v69
  v_cvt_pk_bf16_f32 v171, v70, v71
  v_fma_f32 v64, v72, v56, -v64
  v_fma_f32 v65, v73, v56, -v65
  v_fma_f32 v66, v74, v56, -v66
  v_fma_f32 v67, v75, v56, -v67
  v_fma_f32 v68, v76, v56, -v68
  v_fma_f32 v69, v77, v56, -v69
  v_fma_f32 v70, v78, v56, -v70
  v_fma_f32 v71, v79, v56, -v71
  v_cvt_pk_bf16_f32 v172, v72, v73
  v_cvt_pk_bf16_f32 v173, v74, v75
  v_cvt_pk_bf16_f32 v174, v76, v77
  v_cvt_pk_bf16_f32 v175, v78, v79
  v_fma_f32 v72, v64, v56, -v72
  v_fma_f32 v73, v65, v56, -v73
  v_fma_f32 v74, v66, v56, -v74
  v_fma_f32 v75, v67, v56, -v75
  v_fma_f32 v76, v68, v56, -v76
  v_fma_f32 v77, v69, v56, -v77
  v_fma_f32 v78, v70, v56, -v78
  v_fma_f32 v79, v71, v56, -v79
  v_cvt_pk_bf16_f32 v176, v64, v65
  v_cvt_pk_bf16_f32 v177, v66, v67
  v_cvt_pk_bf16_f32 v178, v68, v69
  v_cvt_pk_bf16_f32 v179, v70, v71
  v_mul_f32 v57, 0x3f3504f3, v78
  v_cndmask_b32 v78, v78, v57, s[68:69]
  v_mov_b32 v57, 0x3f3504f3
  v_cndmask_b32 v79, v79, v57, s[68:69]
  v_cvt_pk_bf16_f32 v180, v72, v73
  v_cvt_pk_bf16_f32 v181, v74, v75
  v_cvt_pk_bf16_f32 v182, v76, v77
  v_cvt_pk_bf16_f32 v183, v78, v79
f_kernel_ns53:
  s_waitcnt lgkmcnt(7)
  v_dot2c_f32_bf16 v80, v24, v24
  v_dot2c_f32_bf16 v81, v26, v26
  v_dot2c_f32_bf16 v80, v25, v25
  v_dot2c_f32_bf16 v81, v27, v27
  s_waitcnt lgkmcnt(6)
  v_dot2c_f32_bf16 v80, v28, v28
  v_dot2c_f32_bf16 v81, v30, v30
  v_dot2c_f32_bf16 v80, v29, v29
  v_dot2c_f32_bf16 v81, v31, v31
  ds_read_b128 v[24:27], v5 offset:51200
  ds_read_b128 v[28:31], v5 offset:51712
  s_waitcnt lgkmcnt(7)
  v_dot2c_f32_bf16 v80, v32, v32
  v_dot2c_f32_bf16 v81, v34, v34
  v_dot2c_f32_bf16 v80, v33, v33
  v_dot2c_f32_bf16 v81, v35, v35
  s_waitcnt lgkmcnt(6)
  v_dot2c_f32_bf16 v80, v36, v36
  v_dot2c_f32_bf16 v81, v38, v38
  v_dot2c_f32_bf16 v80, v37, v37
  v_dot2c_f32_bf16 v81, v39, v39
  ds_read_b128 v[32:35], v5 offset:53248
  ds_read_b128 v[36:39], v5 offset:53760
  s_waitcnt lgkmcnt(7)
  v_dot2c_f32_bf16 v80, v40, v40
  v_dot2c_f32_bf16 v81, v42, v42
  v_dot2c_f32_bf16 v80, v41, v41
  v_dot2c_f32_bf16 v81, v43, v43
  s_waitcnt lgkmcnt(6)
  v_dot2c_f32_bf16 v80, v44, v44
  v_dot2c_f32_bf16 v81, v46, v46
  v_dot2c_f32_bf16 v80, v45, v45
  v_dot2c_f32_bf16 v81, v47, v47
  ds_read_b128 v[40:43], v5 offset:55296
  ds_read_b128 v[44:47], v5 offset:55808
  s_waitcnt lgkmcnt(7)
  v_dot2c_f32_bf16 v80, v16, v16
  v_dot2c_f32_bf16 v81, v18, v18
  v_dot2c_f32_bf16 v80, v17, v17
  v_dot2c_f32_bf16 v81, v19, v19
  s_waitcnt lgkmcnt(6)
  v_dot2c_f32_bf16 v80, v20, v20
  v_dot2c_f32_bf16 v81, v22, v22
  v_dot2c_f32_bf16 v80, v21, v21
  v_dot2c_f32_bf16 v81, v23, v23
  ds_read_b128 v[16:19], v5 offset:57344
  ds_read_b128 v[20:23], v5 offset:57856
  s_waitcnt lgkmcnt(7)
  v_dot2c_f32_bf16 v80, v24, v24
  v_dot2c_f32_bf16 v81, v26, v26
  v_dot2c_f32_bf16 v80, v25, v25
  v_dot2c_f32_bf16 v81, v27, v27
  s_waitcnt lgkmcnt(6)
  v_dot2c_f32_bf16 v80, v28, v28
  v_dot2c_f32_bf16 v81, v30, v30
  v_dot2c_f32_bf16 v80, v29, v29
  v_dot2c_f32_bf16 v81, v31, v31
  ds_read_b128 v[24:27], v5 offset:59392
  ds_read_b128 v[28:31], v5 offset:59904
  s_waitcnt lgkmcnt(7)
  v_dot2c_f32_bf16 v80, v32, v32
  v_dot2c_f32_bf16 v81, v34, v34
  v_dot2c_f32_bf16 v80, v33, v33
  v_dot2c_f32_bf16 v81, v35, v35
  s_waitcnt lgkmcnt(6)
  v_dot2c_f32_bf16 v80, v36, v36
  v_dot2c_f32_bf16 v81, v38, v38
  v_dot2c_f32_bf16 v80, v37, v37
  v_dot2c_f32_bf16 v81, v39, v39
  ds_read_b128 v[32:35], v5 offset:61440
  ds_read_b128 v[36:39], v5 offset:61952
  s_waitcnt lgkmcnt(7)
  v_dot2c_f32_bf16 v80, v40, v40
  v_dot2c_f32_bf16 v81, v42, v42
  v_dot2c_f32_bf16 v80, v41, v41
  v_dot2c_f32_bf16 v81, v43, v43
  s_waitcnt lgkmcnt(6)
  v_dot2c_f32_bf16 v80, v44, v44
  v_dot2c_f32_bf16 v81, v46, v46
  v_dot2c_f32_bf16 v80, v45, v45
  v_dot2c_f32_bf16 v81, v47, v47
  ds_read_b128 v[40:43], v5 offset:63488
  ds_read_b128 v[44:47], v5 offset:64000
  s_waitcnt lgkmcnt(7)
  v_dot2c_f32_bf16 v80, v16, v16
  v_dot2c_f32_bf16 v81, v18, v18
  v_dot2c_f32_bf16 v80, v17, v17
  v_dot2c_f32_bf16 v81, v19, v19
  s_waitcnt lgkmcnt(6)
  v_dot2c_f32_bf16 v80, v20, v20
  v_dot2c_f32_bf16 v81, v22, v22
  v_dot2c_f32_bf16 v80, v21, v21
  v_dot2c_f32_bf16 v81, v23, v23
  ds_read_b128 v[16:19], v6 offset:0
  ds_read_b128 v[20:23], v6 offset:512
  s_waitcnt lgkmcnt(7)
  v_dot2c_f32_bf16 v80, v24, v24
  v_dot2c_f32_bf16 v81, v26, v26
  v_dot2c_f32_bf16 v80, v25, v25
  v_dot2c_f32_bf16 v81, v27, v27
  s_waitcnt lgkmcnt(6)
  v_dot2c_f32_bf16 v80, v28, v28
  v_dot2c_f32_bf16 v81, v30, v30
  v_dot2c_f32_bf16 v80, v29, v29
  v_dot2c_f32_bf16 v81, v31, v31
  ds_read_b128 v[24:27], v6 offset:2048
  ds_read_b128 v[28:31], v6 offset:2560
  s_waitcnt lgkmcnt(7)
  v_dot2c_f32_bf16 v80, v32, v32
  v_dot2c_f32_bf16 v81, v34, v34
  v_dot2c_f32_bf16 v80, v33, v33
  v_dot2c_f32_bf16 v81, v35, v35
  s_waitcnt lgkmcnt(6)
  v_dot2c_f32_bf16 v80, v36, v36
  v_dot2c_f32_bf16 v81, v38, v38
  v_dot2c_f32_bf16 v80, v37, v37
  v_dot2c_f32_bf16 v81, v39, v39
  ds_read_b128 v[32:35], v6 offset:4096
  ds_read_b128 v[36:39], v6 offset:4608
  s_waitcnt lgkmcnt(7)
  v_dot2c_f32_bf16 v80, v40, v40
  v_dot2c_f32_bf16 v81, v42, v42
  v_dot2c_f32_bf16 v80, v41, v41
  v_dot2c_f32_bf16 v81, v43, v43
  s_waitcnt lgkmcnt(6)
  v_dot2c_f32_bf16 v80, v44, v44
  v_dot2c_f32_bf16 v81, v46, v46
  v_dot2c_f32_bf16 v80, v45, v45
  v_dot2c_f32_bf16 v81, v47, v47
  ds_read_b128 v[40:43], v6 offset:6144
  ds_read_b128 v[44:47], v6 offset:6656
  s_waitcnt lgkmcnt(7)
  v_dot2c_f32_bf16 v80, v16, v16
  v_dot2c_f32_bf16 v81, v18, v18
  v_dot2c_f32_bf16 v80, v17, v17
  v_dot2c_f32_bf16 v81, v19, v19
  s_waitcnt lgkmcnt(6)
  v_dot2c_f32_bf16 v80, v20, v20
  v_dot2c_f32_bf16 v81, v22, v22
  v_dot2c_f32_bf16 v80, v21, v21
  v_dot2c_f32_bf16 v81, v23, v23
  s_waitcnt lgkmcnt(5)
  v_dot2c_f32_bf16 v80, v24, v24
  v_dot2c_f32_bf16 v81, v26, v26
  v_dot2c_f32_bf16 v80, v25, v25
  v_dot2c_f32_bf16 v81, v27, v27
  s_waitcnt lgkmcnt(4)
  v_dot2c_f32_bf16 v80, v28, v28
  v_dot2c_f32_bf16 v81, v30, v30
  v_dot2c_f32_bf16 v80, v29, v29
  v_dot2c_f32_bf16 v81, v31, v31
  s_waitcnt lgkmcnt(3)
  v_dot2c_f32_bf16 v80, v32, v32
  v_dot2c_f32_bf16 v81, v34, v34
  v_dot2c_f32_bf16 v80, v33, v33
  v_dot2c_f32_bf16 v81, v35, v35
  s_waitcnt lgkmcnt(2)
  v_dot2c_f32_bf16 v80, v36, v36
  v_dot2c_f32_bf16 v81, v38, v38
  v_dot2c_f32_bf16 v80, v37, v37
  v_dot2c_f32_bf16 v81, v39, v39
  s_waitcnt lgkmcnt(0)
  v_and_b32 v45, v82, v45
  v_and_b32 v47, v82, v47
  v_dot2c_f32_bf16 v80, v40, v40
  v_dot2c_f32_bf16 v81, v42, v42
  v_dot2c_f32_bf16 v80, v41, v41
  v_dot2c_f32_bf16 v81, v43, v43
  v_dot2c_f32_bf16 v80, v44, v44
  v_dot2c_f32_bf16 v81, v46, v46
  v_dot2c_f32_bf16 v80, v45, v45
  v_dot2c_f32_bf16 v81, v47, v47
  s_nop 2
  v_permlane32_swap_b32 v80, v81
  v_add_f32 v80, v80, v81
  v_mov_b32 v81, 0x3727c5ac
  v_fmac_f32 v81, s59, v80
  v_rsq_f32 v81, v81
  v_lshlrev_b32 v80, 2, v1
  v_add_u32 v80, 73728, v80
  ds_write_b32 v80, v81
  s_waitcnt lgkmcnt(0)
  s_barrier
f_kernel_me44:
  s_cmp_lg_u32 s43, 0
  s_cbranch_scc1 f_kernel_p954
  s_mul_i32 s62, s45, 18432
  s_and_b32 s63, s44, 1
  s_lshl_b32 s63, s63, 8
  s_add_u32 s62, s62, s63
  s_lshl_b32 s63, s3, 11
  s_add_u32 s63, s63, s62
  s_add_u32 s62, s62, 16384
  s_cmp_eq_u32 s3, 0
  s_cselect_b32 s62, s62, 0x100000
  v_lshlrev_b32 v5, 4, v2
  v_lshl_add_u32 v5, v3, 9, v5
  v_add_u32 v6, s62, v5
  v_add_u32 v5, s63, v5
  ds_read_b128 v[16:19], v5
  ds_read_b128 v[20:23], v6
  s_waitcnt lgkmcnt(1)
  v_lshlrev_b32 v144, 16, v16
  v_and_b32 v145, s60, v16
  v_lshlrev_b32 v146, 16, v17
  v_and_b32 v147, s60, v17
  v_lshlrev_b32 v148, 16, v18
  v_and_b32 v149, s60, v18
  v_lshlrev_b32 v150, 16, v19
  v_and_b32 v151, s60, v19
  s_waitcnt lgkmcnt(0)
  v_lshlrev_b32 v152, 16, v20
  v_and_b32 v153, s60, v20
  v_lshlrev_b32 v154, 16, v21
  v_and_b32 v155, s60, v21
  v_lshlrev_b32 v156, 16, v22
  v_and_b32 v157, s60, v22
  v_lshlrev_b32 v158, 16, v23
  v_and_b32 v159, s60, v23
  s_waitcnt vmcnt(0)
  s_barrier
  s_cmp_lg_u32 s3, 7
  s_cbranch_scc1 f_kernel_sig58
  s_add_u32 s62, s50, s54
  v_lshlrev_b32 v12, 12, v1
  v_mov_b32 v13, s42
  s_add_u32 s62, s62, 196608
  s_mov_b64 exec, 1
  buffer_store_dword v13, v12, s[24:27], s62 offen sc1
  s_mov_b64 exec, -1
f_kernel_sig58:
  s_branch f_kernel_p9j55
f_kernel_p954:
  s_and_b32 s63, s44, 1
  s_lshl_b32 s63, s63, 8
  v_lshl_add_u32 v5, v2, 4, s63
  v_lshl_add_u32 v5, v3, 10, v5
  ds_read_b128 v[188:191], v5 offset:0
  ds_read_b128 v[192:195], v5 offset:512
  ds_read_b128 v[196:199], v5 offset:4096
  ds_read_b128 v[200:203], v5 offset:4608
  ds_read_b128 v[204:207], v5 offset:8192
  ds_read_b128 v[208:211], v5 offset:8704
  ds_read_b128 v[212:215], v5 offset:12288
  ds_read_b128 v[216:219], v5 offset:12800
  ds_read_b128 v[220:223], v5 offset:16384
  ds_read_b128 v[224:227], v5 offset:16896
  ds_read_b128 v[228:231], v5 offset:20480
  ds_read_b128 v[232:235], v5 offset:20992
  v_add_u32 v6, 0x10000, v5
  s_lshl_b32 s62, s3, 13
  v_add_u32 v7, s62, v5
  s_and_b32 s62, s3, 1
  s_lshl_b32 s62, s62, 12
  v_add_u32 v9, s62, v6
  s_waitcnt lgkmcnt(10)
  v_swap_b32 v190, v192
  v_swap_b32 v191, v193
  s_nop 1
  v_mfma_f32_16x16x32_bf16 v[144:147], v[96:99], v[188:191], 0
  ds_read_b128 v[236:239], v5 offset:24576
  v_mfma_f32_16x16x32_bf16 v[148:151], v[96:99], v[192:195], 0
  ds_read_b128 v[240:243], v5 offset:25088
  s_waitcnt lgkmcnt(10)
  v_swap_b32 v198, v200
  v_swap_b32 v199, v201
  s_nop 1
  v_mfma_f32_16x16x32_bf16 v[144:147], v[100:103], v[196:199], v[144:147]
  ds_read_b128 v[244:247], v5 offset:28672
  v_mfma_f32_16x16x32_bf16 v[148:151], v[100:103], v[200:203], v[148:151]
  ds_read_b128 v[248:251], v5 offset:29184
  s_waitcnt lgkmcnt(10)
  v_swap_b32 v206, v208
  v_swap_b32 v207, v209
  s_nop 1
  v_mfma_f32_16x16x32_bf16 v[144:147], v[104:107], v[204:207], v[144:147]
  ds_read_b128 v[188:191], v5 offset:32768
  v_mfma_f32_16x16x32_bf16 v[148:151], v[104:107], v[208:211], v[148:151]
  ds_read_b128 v[192:195], v5 offset:33280
  s_waitcnt lgkmcnt(10)
  v_swap_b32 v214, v216
  v_swap_b32 v215, v217
  s_nop 1
  v_mfma_f32_16x16x32_bf16 v[144:147], v[108:111], v[212:215], v[144:147]
  ds_read_b128 v[196:199], v5 offset:36864
  v_mfma_f32_16x16x32_bf16 v[148:151], v[108:111], v[216:219], v[148:151]
  ds_read_b128 v[200:203], v5 offset:37376
  s_waitcnt lgkmcnt(10)
  v_swap_b32 v222, v224
  v_swap_b32 v223, v225
  s_nop 1
  v_mfma_f32_16x16x32_bf16 v[144:147], v[112:115], v[220:223], v[144:147]
  ds_read_b128 v[204:207], v5 offset:40960
  v_mfma_f32_16x16x32_bf16 v[148:151], v[112:115], v[224:227], v[148:151]
  ds_read_b128 v[208:211], v5 offset:41472
  s_waitcnt lgkmcnt(10)
  v_swap_b32 v230, v232
  v_swap_b32 v231, v233
  s_nop 1
  v_mfma_f32_16x16x32_bf16 v[144:147], v[116:119], v[228:231], v[144:147]
  ds_read_b128 v[212:215], v5 offset:45056
  v_mfma_f32_16x16x32_bf16 v[148:151], v[116:119], v[232:235], v[148:151]
  ds_read_b128 v[216:219], v5 offset:45568
  s_waitcnt lgkmcnt(10)
  v_swap_b32 v238, v240
  v_swap_b32 v239, v241
  s_nop 1
  v_mfma_f32_16x16x32_bf16 v[144:147], v[120:123], v[236:239], v[144:147]
  ds_read_b128 v[220:223], v5 offset:49152
  v_mfma_f32_16x16x32_bf16 v[148:151], v[120:123], v[240:243], v[148:151]
  ds_read_b128 v[224:227], v5 offset:49664
  s_waitcnt lgkmcnt(10)
  v_swap_b32 v246, v248
  v_swap_b32 v247, v249
  s_nop 1
  v_mfma_f32_16x16x32_bf16 v[144:147], v[124:127], v[244:247], v[144:147]
  ds_read_b128 v[228:231], v5 offset:53248
  v_mfma_f32_16x16x32_bf16 v[148:151], v[124:127], v[248:251], v[148:151]
  ds_read_b128 v[232:235], v5 offset:53760
  s_waitcnt lgkmcnt(10)
  v_swap_b32 v190, v192
  v_swap_b32 v191, v193
  s_nop 1
  v_mfma_f32_16x16x32_bf16 v[144:147], v[128:131], v[188:191], v[144:147]
  ds_read_b128 v[236:239], v5 offset:57344
  v_mfma_f32_16x16x32_bf16 v[148:151], v[128:131], v[192:195], v[148:151]
  ds_read_b128 v[240:243], v5 offset:57856
  s_waitcnt lgkmcnt(10)
  v_swap_b32 v198, v200
  v_swap_b32 v199, v201
  s_nop 1
  v_mfma_f32_16x16x32_bf16 v[144:147], v[132:135], v[196:199], v[144:147]
  ds_read_b128 v[244:247], v5 offset:61440
  v_mfma_f32_16x16x32_bf16 v[148:151], v[132:135], v[200:203], v[148:151]
  ds_read_b128 v[248:251], v5 offset:61952
  s_waitcnt lgkmcnt(10)
  v_swap_b32 v206, v208
  v_swap_b32 v207, v209
  s_waitcnt vmcnt(0)
  s_waitcnt lgkmcnt(0)
  s_barrier
  s_cmp_lg_u32 s3, 7
  s_cbranch_scc1 f_kernel_sig60
  s_add_u32 s62, s50, s54
  v_lshlrev_b32 v12, 12, v1
  v_mov_b32 v13, s42
  s_add_u32 s62, s62, 196608
  s_mov_b64 exec, 1
  buffer_store_dword v13, v12, s[24:27], s62 offen sc1
  s_mov_b64 exec, -1
f_kernel_sig60:
  v_mfma_f32_16x16x32_bf16 v[144:147], v[136:139], v[204:207], v[144:147]
  ds_read_b128 v[188:191], v6 offset:0
  v_mfma_f32_16x16x32_bf16 v[148:151], v[136:139], v[208:211], v[148:151]
  ds_read_b128 v[192:195], v6 offset:512
  v_swap_b32 v214, v216
  v_swap_b32 v215, v217
  s_nop 1
  v_mfma_f32_16x16x32_bf16 v[144:147], v[140:143], v[212:215], v[144:147]
  ds_read_b128 v[196:199], v6 offset:4096
  v_mfma_f32_16x16x32_bf16 v[148:151], v[140:143], v[216:219], v[148:151]
  ds_read_b128 v[200:203], v6 offset:4608
  v_swap_b32 v222, v224
  v_swap_b32 v223, v225
  s_nop 1
  v_mfma_f32_16x16x32_bf16 v[144:147], v[160:163], v[220:223], v[144:147]
  ds_read_b128 v[16:19], v7 offset:0
  v_mfma_f32_16x16x32_bf16 v[148:151], v[160:163], v[224:227], v[148:151]
  ds_read_b128 v[20:23], v7 offset:512
  v_swap_b32 v230, v232
  v_swap_b32 v231, v233
  s_nop 1
  v_mfma_f32_16x16x32_bf16 v[144:147], v[164:167], v[228:231], v[144:147]
  ds_read_b128 v[24:27], v7 offset:4096
  v_mfma_f32_16x16x32_bf16 v[148:151], v[164:167], v[232:235], v[148:151]
  ds_read_b128 v[28:31], v7 offset:4608
  v_swap_b32 v238, v240
  v_swap_b32 v239, v241
  s_nop 1
  v_mfma_f32_16x16x32_bf16 v[144:147], v[168:171], v[236:239], v[144:147]
  ds_read_b128 v[32:35], v9 offset:0
  v_mfma_f32_16x16x32_bf16 v[148:151], v[168:171], v[240:243], v[148:151]
  ds_read_b128 v[36:39], v9 offset:512
  v_swap_b32 v246, v248
  v_swap_b32 v247, v249
  s_nop 1
  v_mfma_f32_16x16x32_bf16 v[144:147], v[172:175], v[244:247], v[144:147]
  v_mfma_f32_16x16x32_bf16 v[148:151], v[172:175], v[248:251], v[148:151]
  s_waitcnt lgkmcnt(8)
  v_swap_b32 v190, v192
  v_swap_b32 v191, v193
  s_nop 1
  v_mfma_f32_16x16x32_bf16 v[144:147], v[176:179], v[188:191], v[144:147]
  v_mfma_f32_16x16x32_bf16 v[148:151], v[176:179], v[192:195], v[148:151]
  s_waitcnt lgkmcnt(6)
  v_swap_b32 v198, v200
  v_swap_b32 v199, v201
  s_nop 1
  v_mfma_f32_16x16x32_bf16 v[144:147], v[180:183], v[196:199], v[144:147]
  v_mfma_f32_16x16x32_bf16 v[148:151], v[180:183], v[200:203], v[148:151]
  s_waitcnt lgkmcnt(4)
  v_swap_b32 v18, v20
  v_swap_b32 v19, v21
  s_nop 1
  v_mfma_f32_16x16x32_bf16 v[152:155], v[184:187], v[16:19], 0
  v_mfma_f32_16x16x32_bf16 v[156:159], v[184:187], v[20:23], 0
  s_waitcnt lgkmcnt(2)
  v_swap_b32 v26, v28
  v_swap_b32 v27, v29
  s_nop 1
  v_mfma_f32_16x16x32_bf16 v[152:155], v[48:51], v[24:27], v[152:155]
  v_mfma_f32_16x16x32_bf16 v[156:159], v[48:51], v[28:31], v[156:159]
  s_waitcnt lgkmcnt(0)
  v_swap_b32 v34, v36
  v_swap_b32 v35, v37
  s_cmp_ge_u32 s3, 2
  s_cbranch_scc1 f_kernel_n359
  v_mfma_f32_16x16x32_bf16 v[152:155], v[52:55], v[32:35], v[152:155]
  v_mfma_f32_16x16x32_bf16 v[156:159], v[52:55], v[36:39], v[156:159]
f_kernel_n359:
f_kernel_p9j55:
  s_lshl_b32 s62, s40, 2
  s_lshr_b32 s63, s41, 3
  s_add_u32 s62, s62, s63
  s_and_b32 s63, s41, 7
  s_lshl_b32 s63, s63, 3
  s_and_b32 s64, s3, 3
  s_lshr_b32 s65, s3, 2
  s_lshl_b32 s66, s64, 1
  s_add_u32 s63, s63, s66
  s_add_u32 s63, s63, s65
  s_mul_i32 s66, s62, 147456
  s_add_u32 s66, s66, s49
  s_add_u32 s70, s66, 22020096
  s_add_u32 s66, s66, 16777216
  s_mul_i32 s68, s63, 2304
  s_xor_b32 s69, s63, 1
  s_mul_i32 s69, s69, 2304
  s_add_u32 s68, s68, s66
  s_add_u32 s69, s69, s66
  s_lshr_b32 s66, s41, 3
  s_mul_i32 s66, s66, 147424
  s_sub_u32 s86, s68, s66
  s_sub_u32 s87, s69, s66
  s_mov_b32 s84, 0x3ffff
  s_mov_b32 s85, 0x3ffff
  s_mul_i32 s71, s65, 73728
  s_lshl_b32 s72, s64, 10
  s_add_u32 s72, s72, s71
  s_lshl_b32 s73, s63, 15
  s_lshl_b32 s66, s62, 10
  s_add_u32 s73, s73, s66
  s_add_u32 s73, s73, s49
  s_add_u32 s73, s73, 27262976
  s_lshl_b32 s74, s62, 13
  s_lshl_b32 s66, s63, 7
  s_add_u32 s74, s74, s66
  s_add_u32 s74, s74, s49
  s_add_u32 s74, s74, 29360128
  s_lshl_b32 s62, s43, 20
  s_mul_i32 s63, s45, 165888
  s_add_u32 s62, s62, s63
  s_add_u32 s62, s62, 12582912
  s_mul_i32 s79, s3, 18432
  s_add_u32 s79, s79, s62
  s_add_u32 s62, s62, 147456
  s_lshl_b32 s63, s3, 11
  s_add_u32 s80, s62, s63
  s_lshl_b32 s63, s3, 10
  s_add_u32 s62, s62, s63
  s_add_u32 s62, s62, 16384
  s_cmp_lt_u32 s3, 2
  s_cselect_b32 s81, s62, 1073741824
  v_and_b32 v5, 31, v1
  v_lshrrev_b32 v6, 5, v1
  v_add_u32 v131, s71, v4
  v_lshrrev_b32 v7, 4, v5
  v_mul_u32_u24 v7, 640, v7
  v_and_b32 v8, 8, v5
  v_and_b32 v9, 3, v5
  v_lshl_add_u32 v8, v9, 1, v8
  v_lshl_add_u32 v8, v6, 4, v8
  s_movk_i32 s62, 1024
  v_add3_u32 v7, v7, v8, s62
  v_bfe_u32 v8, v5, 2, 1
  v_lshl_add_u32 v136, v8, 7, v7
  v_lshl_add_u32 v7, v8, 6, v7
  s_add_u32 s62, s71, 544
  v_add_u32 v132, s62, v7
  v_mul_u32_u24 v7, 20, v6
  v_xor_b32 v7, v7, v5
  v_lshl_add_u32 v8, v6, 2, v5
  v_add_u32 v8, 16, v8
  v_cmp_gt_u32 vcc, 16, v5
  s_nop 1
  v_cndmask_b32 v7, v8, v7, vcc
  s_add_u32 s62, s71, 1024
  v_lshl_add_u32 v133, v7, 4, s62
  v_and_b32 v7, 27, v5
  v_cmp_eq_u32 vcc, 18, v7
  v_mov_b32 v7, 0x3f803f80
  s_nop 0
  v_cndmask_b32 v140, 0, v7, vcc
  v_mov_b32 v40, v140
  v_mov_b32 v41, v140
  v_mov_b32 v42, v140
  v_mov_b32 v43, v140
  v_mov_b32 v44, v140
  v_mov_b32 v45, v140
  v_mov_b32 v46, v140
  v_mov_b32 v47, v140
  v_mov_b32 v48, v140
  v_mov_b32 v49, v140
  v_mov_b32 v50, v140
  v_mov_b32 v51, v140
  v_lshlrev_b32 v7, 2, v5
  v_or_b32 v8, v6, v9
  v_cmp_eq_u32 vcc, 0, v8
  v_mov_b32 v8, 1073741824
  s_nop 0
  v_cndmask_b32 v137, v8, v7, vcc
  s_mul_i32 s62, s3, 3072
  v_add_u32 v138, s62, v4
  s_xor_b32 s62, s3, 4
  s_mul_i32 s62, s62, 3072
  v_add_u32 v139, s62, v4
  v_mov_b32 v37, 0x3f803f80
  v_mov_b32 v39, 0x3f803f80
  s_mov_b32 s75, 0
  s_mov_b32 s76, 0
  v_add_u32 v141, s70, v4
  s_cmp_eq_u32 s43, 0
  s_cselect_b32 s62, 1.0, 0x3d715bef
  v_mul_f32 v144, s62, v144
  v_mul_f32 v145, s62, v145
  v_mul_f32 v146, s62, v146
  v_mul_f32 v147, s62, v147
  v_mul_f32 v148, s62, v148
  v_mul_f32 v149, s62, v149
  v_mul_f32 v150, s62, v150
  v_mul_f32 v151, s62, v151
  v_mul_f32 v152, s62, v152
  v_mul_f32 v153, s62, v153
  v_mul_f32 v154, s62, v154
  v_mul_f32 v155, s62, v155
  v_mul_f32 v156, s62, v156
  v_mul_f32 v157, s62, v157
  v_mul_f32 v158, s62, v158
  v_mul_f32 v159, s62, v159
  s_cmp_lg_u32 s3, 7
  s_cbranch_scc1 f_kernel_wsk61
  s_add_u32 s62, s50, s57
  s_add_u32 s62, s62, 196608
  v_lshlrev_b32 v11, 6, v1
  s_sub_u32 s63, s56, s57
  s_add_u32 s63, s63, 196096
  v_add_u32 v12, s63, v11
  v_cmp_lt_u32 vcc, 7, v1
  s_nop 1
  v_cndmask_b32 v11, v11, v12, vcc
  s_cmp_eq_u32 s43, 0
  s_mov_b64 exec, 0xff
  s_cmov_b32 exec_lo, 0x3ffffff
  s_mov_b32 s63, 0
f_kernel_wlp62:
  s_add_u32 s63, s63, 1
  buffer_load_dwordx4 v[12:15], v11, s[24:27], s62 offen sc1
  s_waitcnt vmcnt(0)
  v_xor_b32 v12, s42, v12
  v_xor_b32 v13, s42, v13
  v_xor_b32 v14, s42, v14
  v_xor_b32 v15, s42, v15
  v_or3_b32 v12, v12, v13, v14
  v_or_b32 v12, v12, v15
  v_cmp_ne_u32 vcc, 0, v12
  s_nop 4
  s_cbranch_vccz f_kernel_wdn63
  s_cmp_lt_u32 s63, 20000
  s_cbranch_scc1 f_kernel_wlp62
f_kernel_wdn63:
  s_mov_b64 exec, -1
f_kernel_wsk61:
  s_barrier
  buffer_load_dwordx4 v[16:19], v4, s[24:27], s68 offen sc1
  buffer_load_dwordx4 v[20:23], v4, s[24:27], s69 offen sc1
  buffer_load_dwordx4 v[28:31], v131, s[24:27], s70 offen sc1
  buffer_load_ushort v24, v136, s[24:27], s86 offen sc1
  buffer_load_ushort v26, v136, s[24:27], s87 offen sc1
  buffer_load_ushort v36, v132, s[24:27], s70 offen sc1
  s_mov_b32 m0, s72
  s_nop 0
  buffer_load_dwordx4 v141, s[24:27], m0 offen sc1 lds
  s_add_u32 m0, s72, 4096
  s_nop 0
  buffer_load_dwordx4 v141, s[24:27], m0 offen sc1 lds
  s_add_u32 m0, s72, 8192
  s_nop 0
  buffer_load_dwordx4 v141, s[24:27], m0 offen sc1 lds
  s_add_u32 m0, s72, 12288
  s_nop 0
  buffer_load_dwordx4 v141, s[24:27], m0 offen sc1 lds
  v_mov_b32 v96, 0
  v_mov_b32 v97, 0
  v_mov_b32 v98, 0
  v_mov_b32 v99, 0
  v_mov_b32 v100, 0
  v_mov_b32 v101, 0
  v_mov_b32 v102, 0
  v_mov_b32 v103, 0
  v_mov_b32 v104, 0
  v_mov_b32 v105, 0
  v_mov_b32 v106, 0
  v_mov_b32 v107, 0
  v_mov_b32 v108, 0
  v_mov_b32 v109, 0
  v_mov_b32 v110, 0
  v_mov_b32 v111, 0
  v_mov_b32 v112, 0
  v_mov_b32 v113, 0
  v_mov_b32 v114, 0
  v_mov_b32 v115, 0
  v_mov_b32 v116, 0
  v_mov_b32 v117, 0
  v_mov_b32 v118, 0
  v_mov_b32 v119, 0
  v_mov_b32 v120, 0
  v_mov_b32 v121, 0
  v_mov_b32 v122, 0
  v_mov_b32 v123, 0
  v_mov_b32 v124, 0
  v_mov_b32 v125, 0
  v_mov_b32 v126, 0
  v_mov_b32 v127, 0
  v_mov_b32 v60, 0
  v_mov_b32 v52, v140
  v_mov_b32 v61, 0
  v_mov_b32 v53, v140
  v_mov_b32 v62, 0
  v_mov_b32 v54, v140
  v_mov_b32 v63, 0
  v_mov_b32 v55, v140
  v_mov_b32 v25, 0
  v_mov_b32 v134, 0xff800000
  v_mov_b32 v27, 0
  v_mov_b32 v135, 0xff800000
  v_add_u32 v128, 36864, v131
  v_add_u32 v129, 36864, v132
  v_add_u32 v130, 36864, v133
  s_waitcnt vmcnt(7)
  v_mfma_f32_32x32x16_bf16 v[64:79], v[28:31], v[16:19], 0
  v_mfma_f32_32x32x16_bf16 v[80:95], v[28:31], v[20:23], 0
  s_waitcnt vmcnt(4)
  v_mfma_f32_32x32x8bf16_1k v[64:79], v[36:37], v[24:25], v[64:79]
  v_mfma_f32_32x32x8bf16_1k v[80:95], v[36:37], v[26:27], v[80:95]
  s_nop 10
  v_max3_f32 v134, v64, v65, v134
  v_max3_f32 v134, v66, v67, v134
  v_max3_f32 v134, v68, v69, v134
  v_max3_f32 v134, v70, v71, v134
  v_max3_f32 v134, v72, v73, v134
  v_max3_f32 v134, v74, v75, v134
  v_max3_f32 v134, v76, v77, v134
  v_max3_f32 v134, v78, v79, v134
  v_max3_f32 v135, v80, v81, v135
  v_max3_f32 v135, v82, v83, v135
  v_max3_f32 v135, v84, v85, v135
  v_max3_f32 v135, v86, v87, v135
  v_max3_f32 v135, v88, v89, v135
  v_max3_f32 v135, v90, v91, v135
  v_max3_f32 v135, v92, v93, v135
  v_max3_f32 v135, v94, v95, v135
  s_nop 1
  v_permlane32_swap_b32 v134, v135
  v_max_f32 v134, v134, v135
  v_xor_b32 v56, 0x80000000, v134
  v_and_b32 v57, s60, v56
  v_sub_f32 v56, v56, v57
  v_and_b32 v58, s60, v56
  v_sub_f32 v56, v56, v58
  v_lshrrev_b32 v57, 16, v57
  v_or_b32 v25, v57, v58
  v_lshrrev_b32 v27, 16, v56
  v_mov_b32 v135, v134
  s_nop 0
  v_permlane32_swap_b32 v25, v27
  v_permlane32_swap_b32 v134, v135
  v_mfma_f32_32x32x16_bf16 v[64:79], v[28:31], v[16:19], 0
  v_mfma_f32_32x32x8bf16_1k v[64:79], v[36:37], v[24:25], v[64:79]
  v_mov_b32 v94, 0
  v_mov_b32 v95, 0
  s_waitcnt vmcnt(2)
  s_barrier
  s_mov_b64 exec, s[84:85]
  ds_read_b128 v[40:43], v133 offset:0
  ds_read_b128 v[44:47], v133 offset:640
  s_mov_b64 exec, -1
  ds_read_b128 v[32:35], v131 offset:2304
  ds_read_u16 v38, v132 offset:2304
  s_setprio 3
  s_nop 0
  v_exp_f32 v64, v64
  v_exp_f32 v65, v65
  v_cvt_pk_bf16_f32 v63, v94, v95
  v_exp_f32 v66, v66
  v_mfma_f32_32x32x16_bf16 v[80:95], v[28:31], v[20:23], 0
  v_exp_f32 v67, v67
  v_cvt_pk_bf16_f32 v56, v64, v65
  v_exp_f32 v68, v68
  v_mfma_f32_32x32x16_bf16 v[112:127], v[52:55], v[60:63], v[112:127]
  s_add_u32 m0, s72, 16384
  s_nop 0
  buffer_load_dwordx4 v141, s[24:27], m0 offen sc1 lds
  v_exp_f32 v69, v69
  v_cvt_pk_bf16_f32 v57, v66, v67
  v_exp_f32 v70, v70
  v_exp_f32 v71, v71
  v_cvt_pk_bf16_f32 v58, v68, v69
  v_exp_f32 v72, v72
  v_mfma_f32_32x32x8bf16_1k v[80:95], v[36:37], v[26:27], v[80:95]
  s_mov_b64 exec, s[84:85]
  ds_read_b128 v[48:51], v133 offset:2304
  ds_read_b128 v[52:55], v133 offset:2944
  s_mov_b64 exec, -1
  v_exp_f32 v73, v73
  v_cvt_pk_bf16_f32 v59, v70, v71
  v_exp_f32 v74, v74
  v_exp_f32 v75, v75
  v_cvt_pk_bf16_f32 v60, v72, v73
  v_exp_f32 v76, v76
  s_waitcnt lgkmcnt(5)
  v_mfma_f32_32x32x16_bf16 v[96:111], v[40:43], v[56:59], v[96:111]
  s_waitcnt lgkmcnt(2)
  v_exp_f32 v77, v77
  v_cvt_pk_bf16_f32 v61, v74, v75
  v_exp_f32 v78, v78
  v_exp_f32 v79, v79
  v_cvt_pk_bf16_f32 v62, v76, v77
  v_exp_f32 v80, v80
  v_exp_f32 v81, v81
  v_cvt_pk_bf16_f32 v63, v78, v79
  v_exp_f32 v82, v82
  v_mfma_f32_32x32x16_bf16 v[64:79], v[32:35], v[16:19], 0
  ds_read_b128 v[28:31], v131 offset:4608
  v_exp_f32 v83, v83
  v_cvt_pk_bf16_f32 v56, v80, v81
  v_exp_f32 v84, v84
  v_mfma_f32_32x32x16_bf16 v[96:111], v[44:47], v[60:63], v[96:111]
  s_add_u32 m0, s72, 20480
  s_nop 0
  buffer_load_dwordx4 v141, s[24:27], m0 offen sc1 lds
  v_exp_f32 v85, v85
  v_cvt_pk_bf16_f32 v57, v82, v83
  v_exp_f32 v86, v86
  v_exp_f32 v87, v87
  v_cvt_pk_bf16_f32 v58, v84, v85
  v_exp_f32 v88, v88
  v_mfma_f32_32x32x8bf16_1k v[64:79], v[38:39], v[24:25], v[64:79]
  ds_read_u16 v36, v132 offset:4608
  v_exp_f32 v89, v89
  v_cvt_pk_bf16_f32 v59, v86, v87
  v_exp_f32 v90, v90
  v_exp_f32 v91, v91
  v_cvt_pk_bf16_f32 v60, v88, v89
  v_exp_f32 v92, v92
  v_mfma_f32_32x32x16_bf16 v[112:127], v[40:43], v[56:59], v[112:127]
  s_waitcnt lgkmcnt(2)
  v_exp_f32 v93, v93
  v_cvt_pk_bf16_f32 v61, v90, v91
  v_exp_f32 v94, v94
  v_exp_f32 v95, v95
  v_cvt_pk_bf16_f32 v62, v92, v93
  s_setprio 2
  v_exp_f32 v64, v64
  v_exp_f32 v65, v65
  v_cvt_pk_bf16_f32 v63, v94, v95
  v_exp_f32 v66, v66
  v_mfma_f32_32x32x16_bf16 v[80:95], v[32:35], v[20:23], 0
  v_exp_f32 v67, v67
  v_cvt_pk_bf16_f32 v56, v64, v65
  v_exp_f32 v68, v68
  v_mfma_f32_32x32x16_bf16 v[112:127], v[44:47], v[60:63], v[112:127]
  s_add_u32 m0, s72, 24576
  s_nop 0
  buffer_load_dwordx4 v141, s[24:27], m0 offen sc1 lds
  v_exp_f32 v69, v69
  v_cvt_pk_bf16_f32 v57, v66, v67
  v_exp_f32 v70, v70
  v_exp_f32 v71, v71
  v_cvt_pk_bf16_f32 v58, v68, v69
  v_exp_f32 v72, v72
  v_mfma_f32_32x32x8bf16_1k v[80:95], v[38:39], v[26:27], v[80:95]
  s_mov_b64 exec, s[84:85]
  ds_read_b128 v[40:43], v133 offset:4608
  ds_read_b128 v[44:47], v133 offset:5248
  s_mov_b64 exec, -1
  v_exp_f32 v73, v73
  v_cvt_pk_bf16_f32 v59, v70, v71
  v_exp_f32 v74, v74
  v_exp_f32 v75, v75
  v_cvt_pk_bf16_f32 v60, v72, v73
  v_exp_f32 v76, v76
  v_mfma_f32_32x32x16_bf16 v[96:111], v[48:51], v[56:59], v[96:111]
  s_waitcnt lgkmcnt(2)
  v_exp_f32 v77, v77
  v_cvt_pk_bf16_f32 v61, v74, v75
  v_exp_f32 v78, v78
  v_exp_f32 v79, v79
  v_cvt_pk_bf16_f32 v62, v76, v77
  s_waitcnt vmcnt(3)
  s_barrier
  s_setprio 3
  v_exp_f32 v80, v80
  v_exp_f32 v81, v81
  v_cvt_pk_bf16_f32 v63, v78, v79
  v_exp_f32 v82, v82
  v_mfma_f32_32x32x16_bf16 v[64:79], v[28:31], v[16:19], 0
  ds_read_b128 v[32:35], v131 offset:6912
  v_exp_f32 v83, v83
  v_cvt_pk_bf16_f32 v56, v80, v81
  v_exp_f32 v84, v84
  v_mfma_f32_32x32x16_bf16 v[96:111], v[52:55], v[60:63], v[96:111]
  s_add_u32 m0, s72, 28672
  s_nop 0
  buffer_load_dwordx4 v141, s[24:27], m0 offen sc1 lds
  v_exp_f32 v85, v85
  v_cvt_pk_bf16_f32 v57, v82, v83
  v_exp_f32 v86, v86
  v_exp_f32 v87, v87
  v_cvt_pk_bf16_f32 v58, v84, v85
  v_exp_f32 v88, v88
  v_mfma_f32_32x32x8bf16_1k v[64:79], v[36:37], v[24:25], v[64:79]
  ds_read_u16 v38, v132 offset:6912
  v_exp_f32 v89, v89
  v_cvt_pk_bf16_f32 v59, v86, v87
  v_exp_f32 v90, v90
  v_exp_f32 v91, v91
  v_cvt_pk_bf16_f32 v60, v88, v89
  v_exp_f32 v92, v92
  v_mfma_f32_32x32x16_bf16 v[112:127], v[48:51], v[56:59], v[112:127]
  s_waitcnt lgkmcnt(2)
  v_exp_f32 v93, v93
  v_cvt_pk_bf16_f32 v61, v90, v91
  v_exp_f32 v94, v94
  v_exp_f32 v95, v95
  v_cvt_pk_bf16_f32 v62, v92, v93
  v_exp_f32 v64, v64
  v_exp_f32 v65, v65
  v_cvt_pk_bf16_f32 v63, v94, v95
  v_exp_f32 v66, v66
  v_mfma_f32_32x32x16_bf16 v[80:95], v[28:31], v[20:23], 0
  v_exp_f32 v67, v67
  v_cvt_pk_bf16_f32 v56, v64, v65
  v_exp_f32 v68, v68
  v_mfma_f32_32x32x16_bf16 v[112:127], v[52:55], v[60:63], v[112:127]
  s_add_u32 m0, s72, 32768
  s_nop 0
  buffer_load_dwordx4 v141, s[24:27], m0 offen sc1 lds
  v_exp_f32 v69, v69
  v_cvt_pk_bf16_f32 v57, v66, v67
  v_exp_f32 v70, v70
  v_exp_f32 v71, v71
  v_cvt_pk_bf16_f32 v58, v68, v69
  v_exp_f32 v72, v72
  v_mfma_f32_32x32x8bf16_1k v[80:95], v[36:37], v[26:27], v[80:95]
  s_mov_b64 exec, s[84:85]
  ds_read_b128 v[48:51], v133 offset:6912
  ds_read_b128 v[52:55], v133 offset:7552
  s_mov_b64 exec, -1
  v_exp_f32 v73, v73
  v_cvt_pk_bf16_f32 v59, v70, v71
  v_exp_f32 v74, v74
  v_exp_f32 v75, v75
  v_cvt_pk_bf16_f32 v60, v72, v73
  v_exp_f32 v76, v76
  v_mfma_f32_32x32x16_bf16 v[96:111], v[40:43], v[56:59], v[96:111]
  s_waitcnt lgkmcnt(2)
  v_exp_f32 v77, v77
  v_cvt_pk_bf16_f32 v61, v74, v75
  v_exp_f32 v78, v78
  v_exp_f32 v79, v79
  v_cvt_pk_bf16_f32 v62, v76, v77
  v_exp_f32 v80, v80
  v_exp_f32 v81, v81
  v_cvt_pk_bf16_f32 v63, v78, v79
  v_exp_f32 v82, v82
  v_mfma_f32_32x32x16_bf16 v[64:79], v[32:35], v[16:19], 0
  ds_read_b128 v[28:31], v131 offset:9216
  v_exp_f32 v83, v83
  v_cvt_pk_bf16_f32 v56, v80, v81
  v_exp_f32 v84, v84
  v_mfma_f32_32x32x16_bf16 v[96:111], v[44:47], v[60:63], v[96:111]
  s_add_u32 m0, s72, 36864
  s_nop 0
  buffer_load_dwordx4 v141, s[24:27], m0 offen sc1 lds
  v_exp_f32 v85, v85
  v_cvt_pk_bf16_f32 v57, v82, v83
  v_exp_f32 v86, v86
  v_exp_f32 v87, v87
  v_cvt_pk_bf16_f32 v58, v84, v85
  v_exp_f32 v88, v88
  v_mfma_f32_32x32x8bf16_1k v[64:79], v[38:39], v[24:25], v[64:79]
  ds_read_u16 v36, v132 offset:9216
  v_exp_f32 v89, v89
  v_cvt_pk_bf16_f32 v59, v86, v87
  v_exp_f32 v90, v90
  v_exp_f32 v91, v91
  v_cvt_pk_bf16_f32 v60, v88, v89
  v_exp_f32 v92, v92
  v_mfma_f32_32x32x16_bf16 v[112:127], v[40:43], v[56:59], v[112:127]
  s_waitcnt lgkmcnt(2)
  v_exp_f32 v93, v93
  v_cvt_pk_bf16_f32 v61, v90, v91
  v_exp_f32 v94, v94
  v_exp_f32 v95, v95
  v_cvt_pk_bf16_f32 v62, v92, v93
  v_exp_f32 v64, v64
  v_exp_f32 v65, v65
  v_cvt_pk_bf16_f32 v63, v94, v95
  v_exp_f32 v66, v66
  v_mfma_f32_32x32x16_bf16 v[80:95], v[32:35], v[20:23], 0
  v_exp_f32 v67, v67
  v_cvt_pk_bf16_f32 v56, v64, v65
  v_exp_f32 v68, v68
  v_mfma_f32_32x32x16_bf16 v[112:127], v[44:47], v[60:63], v[112:127]
  s_add_u32 m0, s72, 40960
  s_nop 0
  buffer_load_dwordx4 v141, s[24:27], m0 offen sc1 lds
  v_exp_f32 v69, v69
  v_cvt_pk_bf16_f32 v57, v66, v67
  v_exp_f32 v70, v70
  v_exp_f32 v71, v71
  v_cvt_pk_bf16_f32 v58, v68, v69
  v_exp_f32 v72, v72
  v_mfma_f32_32x32x8bf16_1k v[80:95], v[38:39], v[26:27], v[80:95]
  s_mov_b64 exec, s[84:85]
  ds_read_b128 v[40:43], v133 offset:9216
  ds_read_b128 v[44:47], v133 offset:9856
  s_mov_b64 exec, -1
  v_exp_f32 v73, v73
  v_cvt_pk_bf16_f32 v59, v70, v71
  v_exp_f32 v74, v74
  v_exp_f32 v75, v75
  v_cvt_pk_bf16_f32 v60, v72, v73
  v_exp_f32 v76, v76
  v_mfma_f32_32x32x16_bf16 v[96:111], v[48:51], v[56:59], v[96:111]
  s_waitcnt lgkmcnt(2)
  v_exp_f32 v77, v77
  v_cvt_pk_bf16_f32 v61, v74, v75
  v_exp_f32 v78, v78
  v_exp_f32 v79, v79
  v_cvt_pk_bf16_f32 v62, v76, v77
  v_exp_f32 v80, v80
  v_exp_f32 v81, v81
  v_cvt_pk_bf16_f32 v63, v78, v79
  v_exp_f32 v82, v82
  v_mfma_f32_32x32x16_bf16 v[64:79], v[28:31], v[16:19], 0
  ds_read_b128 v[32:35], v131 offset:11520
  v_exp_f32 v83, v83
  v_cvt_pk_bf16_f32 v56, v80, v81
  v_exp_f32 v84, v84
  v_mfma_f32_32x32x16_bf16 v[96:111], v[52:55], v[60:63], v[96:111]
  s_add_u32 m0, s72, 45056
  s_nop 0
  buffer_load_dwordx4 v141, s[24:27], m0 offen sc1 lds
  v_exp_f32 v85, v85
  v_cvt_pk_bf16_f32 v57, v82, v83
  v_exp_f32 v86, v86
  v_exp_f32 v87, v87
  v_cvt_pk_bf16_f32 v58, v84, v85
  v_exp_f32 v88, v88
  v_mfma_f32_32x32x8bf16_1k v[64:79], v[36:37], v[24:25], v[64:79]
  ds_read_u16 v38, v132 offset:11520
  v_exp_f32 v89, v89
  v_cvt_pk_bf16_f32 v59, v86, v87
  v_exp_f32 v90, v90
  v_exp_f32 v91, v91
  v_cvt_pk_bf16_f32 v60, v88, v89
  v_exp_f32 v92, v92
  v_mfma_f32_32x32x16_bf16 v[112:127], v[48:51], v[56:59], v[112:127]
  s_waitcnt lgkmcnt(2)
  v_exp_f32 v93, v93
  v_cvt_pk_bf16_f32 v61, v90, v91
  v_exp_f32 v94, v94
  v_exp_f32 v95, v95
  v_cvt_pk_bf16_f32 v62, v92, v93
  s_setprio 2
  v_exp_f32 v64, v64
  v_exp_f32 v65, v65
  v_cvt_pk_bf16_f32 v63, v94, v95
  v_exp_f32 v66, v66
  v_mfma_f32_32x32x16_bf16 v[80:95], v[28:31], v[20:23], 0
  v_exp_f32 v67, v67
  v_cvt_pk_bf16_f32 v56, v64, v65
  v_exp_f32 v68, v68
  v_mfma_f32_32x32x16_bf16 v[112:127], v[52:55], v[60:63], v[112:127]
  s_add_u32 m0, s72, 49152
  s_nop 0
  buffer_load_dwordx4 v141, s[24:27], m0 offen sc1 lds
  v_exp_f32 v69, v69
  v_cvt_pk_bf16_f32 v57, v66, v67
  v_exp_f32 v70, v70
  v_exp_f32 v71, v71
  v_cvt_pk_bf16_f32 v58, v68, v69
  v_exp_f32 v72, v72
  v_mfma_f32_32x32x8bf16_1k v[80:95], v[36:37], v[26:27], v[80:95]
  s_mov_b64 exec, s[84:85]
  ds_read_b128 v[48:51], v133 offset:11520
  ds_read_b128 v[52:55], v133 offset:12160
  s_mov_b64 exec, -1
  v_exp_f32 v73, v73
  v_cvt_pk_bf16_f32 v59, v70, v71
  v_exp_f32 v74, v74
  v_exp_f32 v75, v75
  v_cvt_pk_bf16_f32 v60, v72, v73
  v_exp_f32 v76, v76
  v_mfma_f32_32x32x16_bf16 v[96:111], v[40:43], v[56:59], v[96:111]
  s_waitcnt lgkmcnt(2)
  v_exp_f32 v77, v77
  v_cvt_pk_bf16_f32 v61, v74, v75
  v_exp_f32 v78, v78
  v_exp_f32 v79, v79
  v_cvt_pk_bf16_f32 v62, v76, v77
  v_exp_f32 v80, v80
  v_exp_f32 v81, v81
  v_cvt_pk_bf16_f32 v63, v78, v79
  v_exp_f32 v82, v82
  v_mfma_f32_32x32x16_bf16 v[64:79], v[32:35], v[16:19], 0
  ds_read_b128 v[28:31], v131 offset:13824
  v_exp_f32 v83, v83
  v_cvt_pk_bf16_f32 v56, v80, v81
  v_exp_f32 v84, v84
  v_mfma_f32_32x32x16_bf16 v[96:111], v[44:47], v[60:63], v[96:111]
  s_add_u32 m0, s72, 53248
  s_nop 0
  buffer_load_dwordx4 v141, s[24:27], m0 offen sc1 lds
  v_exp_f32 v85, v85
  v_cvt_pk_bf16_f32 v57, v82, v83
  v_exp_f32 v86, v86
  v_exp_f32 v87, v87
  v_cvt_pk_bf16_f32 v58, v84, v85
  v_exp_f32 v88, v88
  v_mfma_f32_32x32x8bf16_1k v[64:79], v[38:39], v[24:25], v[64:79]
  ds_read_u16 v36, v132 offset:13824
  v_exp_f32 v89, v89
  v_cvt_pk_bf16_f32 v59, v86, v87
  v_exp_f32 v90, v90
  v_exp_f32 v91, v91
  v_cvt_pk_bf16_f32 v60, v88, v89
  v_exp_f32 v92, v92
  v_mfma_f32_32x32x16_bf16 v[112:127], v[40:43], v[56:59], v[112:127]
  s_waitcnt lgkmcnt(2)
  v_exp_f32 v93, v93
  v_cvt_pk_bf16_f32 v61, v90, v91
  v_exp_f32 v94, v94
  v_exp_f32 v95, v95
  v_cvt_pk_bf16_f32 v62, v92, v93
  s_setprio 1
  v_exp_f32 v64, v64
  v_exp_f32 v65, v65
  v_cvt_pk_bf16_f32 v63, v94, v95
  v_exp_f32 v66, v66
  v_mfma_f32_32x32x16_bf16 v[80:95], v[32:35], v[20:23], 0
  v_exp_f32 v67, v67
  v_cvt_pk_bf16_f32 v56, v64, v65
  v_exp_f32 v68, v68
  v_mfma_f32_32x32x16_bf16 v[112:127], v[44:47], v[60:63], v[112:127]
  s_add_u32 m0, s72, 57344
  s_nop 0
  buffer_load_dwordx4 v141, s[24:27], m0 offen sc1 lds
  v_exp_f32 v69, v69
  v_cvt_pk_bf16_f32 v57, v66, v67
  v_exp_f32 v70, v70
  v_exp_f32 v71, v71
  v_cvt_pk_bf16_f32 v58, v68, v69
  v_exp_f32 v72, v72
  v_mfma_f32_32x32x8bf16_1k v[80:95], v[38:39], v[26:27], v[80:95]
  s_mov_b64 exec, s[84:85]
  ds_read_b128 v[40:43], v133 offset:13824
  ds_read_b128 v[44:47], v133 offset:14464
  s_mov_b64 exec, -1
  v_exp_f32 v73, v73
  v_cvt_pk_bf16_f32 v59, v70, v71
  v_exp_f32 v74, v74
  v_exp_f32 v75, v75
  v_cvt_pk_bf16_f32 v60, v72, v73
  v_exp_f32 v76, v76
  v_mfma_f32_32x32x16_bf16 v[96:111], v[48:51], v[56:59], v[96:111]
  s_waitcnt lgkmcnt(2)
  v_exp_f32 v77, v77
  v_cvt_pk_bf16_f32 v61, v74, v75
  v_exp_f32 v78, v78
  v_exp_f32 v79, v79
  v_cvt_pk_bf16_f32 v62, v76, v77
  s_waitcnt vmcnt(5)
  s_barrier
  s_setprio 3
  v_exp_f32 v80, v80
  v_exp_f32 v81, v81
  v_cvt_pk_bf16_f32 v63, v78, v79
  v_exp_f32 v82, v82
  v_mfma_f32_32x32x16_bf16 v[64:79], v[28:31], v[16:19], 0
  ds_read_b128 v[32:35], v131 offset:16128
  v_exp_f32 v83, v83
  v_cvt_pk_bf16_f32 v56, v80, v81
  v_exp_f32 v84, v84
  v_mfma_f32_32x32x16_bf16 v[96:111], v[52:55], v[60:63], v[96:111]
  s_add_u32 m0, s72, 61440
  s_nop 0
  buffer_load_dwordx4 v141, s[24:27], m0 offen sc1 lds
  v_exp_f32 v85, v85
  v_cvt_pk_bf16_f32 v57, v82, v83
  v_exp_f32 v86, v86
  v_exp_f32 v87, v87
  v_cvt_pk_bf16_f32 v58, v84, v85
  v_exp_f32 v88, v88
  v_mfma_f32_32x32x8bf16_1k v[64:79], v[36:37], v[24:25], v[64:79]
  ds_read_u16 v38, v132 offset:16128
  v_exp_f32 v89, v89
  v_cvt_pk_bf16_f32 v59, v86, v87
  v_exp_f32 v90, v90
  v_exp_f32 v91, v91
  v_cvt_pk_bf16_f32 v60, v88, v89
  v_exp_f32 v92, v92
  v_mfma_f32_32x32x16_bf16 v[112:127], v[48:51], v[56:59], v[112:127]
  s_waitcnt lgkmcnt(2)
  v_exp_f32 v93, v93
  v_cvt_pk_bf16_f32 v61, v90, v91
  v_exp_f32 v94, v94
  v_exp_f32 v95, v95
  v_cvt_pk_bf16_f32 v62, v92, v93
  v_exp_f32 v64, v64
  v_exp_f32 v65, v65
  v_cvt_pk_bf16_f32 v63, v94, v95
  v_exp_f32 v66, v66
  v_mfma_f32_32x32x16_bf16 v[80:95], v[28:31], v[20:23], 0
  v_exp_f32 v67, v67
  v_cvt_pk_bf16_f32 v56, v64, v65
  v_exp_f32 v68, v68
  v_mfma_f32_32x32x16_bf16 v[112:127], v[52:55], v[60:63], v[112:127]
  s_add_u32 m0, s72, 65536
  s_nop 0
  buffer_load_dwordx4 v141, s[24:27], m0 offen sc1 lds
  v_exp_f32 v69, v69
  v_cvt_pk_bf16_f32 v57, v66, v67
  v_exp_f32 v70, v70
  v_exp_f32 v71, v71
  v_cvt_pk_bf16_f32 v58, v68, v69
  v_exp_f32 v72, v72
  v_mfma_f32_32x32x8bf16_1k v[80:95], v[36:37], v[26:27], v[80:95]
  s_mov_b64 exec, s[84:85]
  ds_read_b128 v[48:51], v133 offset:16128
  ds_read_b128 v[52:55], v133 offset:16768
  s_mov_b64 exec, -1
  v_exp_f32 v73, v73
  v_cvt_pk_bf16_f32 v59, v70, v71
  v_exp_f32 v74, v74
  v_exp_f32 v75, v75
  v_cvt_pk_bf16_f32 v60, v72, v73
  v_exp_f32 v76, v76
  v_mfma_f32_32x32x16_bf16 v[96:111], v[40:43], v[56:59], v[96:111]
  s_waitcnt lgkmcnt(2)
  v_exp_f32 v77, v77
  v_cvt_pk_bf16_f32 v61, v74, v75
  v_exp_f32 v78, v78
  v_exp_f32 v79, v79
  v_cvt_pk_bf16_f32 v62, v76, v77
  v_exp_f32 v80, v80
  v_exp_f32 v81, v81
  v_cvt_pk_bf16_f32 v63, v78, v79
  v_exp_f32 v82, v82
  v_mfma_f32_32x32x16_bf16 v[64:79], v[32:35], v[16:19], 0
  ds_read_b128 v[28:31], v131 offset:18432
  v_exp_f32 v83, v83
  v_cvt_pk_bf16_f32 v56, v80, v81
  v_exp_f32 v84, v84
  v_mfma_f32_32x32x16_bf16 v[96:111], v[44:47], v[60:63], v[96:111]
  s_add_u32 m0, s72, 69632
  s_nop 0
  buffer_load_dwordx4 v141, s[24:27], m0 offen sc1 lds
  v_exp_f32 v85, v85
  v_cvt_pk_bf16_f32 v57, v82, v83
  v_exp_f32 v86, v86
  v_exp_f32 v87, v87
  v_cvt_pk_bf16_f32 v58, v84, v85
  v_exp_f32 v88, v88
  v_mfma_f32_32x32x8bf16_1k v[64:79], v[38:39], v[24:25], v[64:79]
  ds_read_u16 v36, v132 offset:18432
  v_exp_f32 v89, v89
  v_cvt_pk_bf16_f32 v59, v86, v87
  v_exp_f32 v90, v90
  v_exp_f32 v91, v91
  v_cvt_pk_bf16_f32 v60, v88, v89
  v_exp_f32 v92, v92
  v_mfma_f32_32x32x16_bf16 v[112:127], v[40:43], v[56:59], v[112:127]
  s_waitcnt lgkmcnt(2)
  v_exp_f32 v93, v93
  v_cvt_pk_bf16_f32 v61, v90, v91
  v_exp_f32 v94, v94
  v_exp_f32 v95, v95
  v_cvt_pk_bf16_f32 v62, v92, v93
  v_exp_f32 v64, v64
  v_exp_f32 v65, v65
  v_cvt_pk_bf16_f32 v63, v94, v95
  v_exp_f32 v66, v66
  v_mfma_f32_32x32x16_bf16 v[80:95], v[32:35], v[20:23], 0
  v_exp_f32 v67, v67
  v_cvt_pk_bf16_f32 v56, v64, v65
  v_exp_f32 v68, v68
  v_mfma_f32_32x32x16_bf16 v[112:127], v[44:47], v[60:63], v[112:127]
  v_exp_f32 v69, v69
  v_cvt_pk_bf16_f32 v57, v66, v67
  v_exp_f32 v70, v70
  v_exp_f32 v71, v71
  v_cvt_pk_bf16_f32 v58, v68, v69
  v_exp_f32 v72, v72
  v_mfma_f32_32x32x8bf16_1k v[80:95], v[38:39], v[26:27], v[80:95]
  s_mov_b64 exec, s[84:85]
  ds_read_b128 v[40:43], v133 offset:18432
  ds_read_b128 v[44:47], v133 offset:19072
  s_mov_b64 exec, -1
  v_exp_f32 v73, v73
  v_cvt_pk_bf16_f32 v59, v70, v71
  v_exp_f32 v74, v74
  v_exp_f32 v75, v75
  v_cvt_pk_bf16_f32 v60, v72, v73
  v_exp_f32 v76, v76
  v_mfma_f32_32x32x16_bf16 v[96:111], v[48:51], v[56:59], v[96:111]
  s_waitcnt lgkmcnt(2)
  v_exp_f32 v77, v77
  v_cvt_pk_bf16_f32 v61, v74, v75
  v_exp_f32 v78, v78
  v_exp_f32 v79, v79
  v_cvt_pk_bf16_f32 v62, v76, v77
  v_exp_f32 v80, v80
  v_exp_f32 v81, v81
  v_cvt_pk_bf16_f32 v63, v78, v79
  v_exp_f32 v82, v82
  v_mfma_f32_32x32x16_bf16 v[64:79], v[28:31], v[16:19], 0
  ds_read_b128 v[32:35], v131 offset:20736
  v_exp_f32 v83, v83
  v_cvt_pk_bf16_f32 v56, v80, v81
  v_exp_f32 v84, v84
  v_mfma_f32_32x32x16_bf16 v[96:111], v[52:55], v[60:63], v[96:111]
  v_exp_f32 v85, v85
  v_cvt_pk_bf16_f32 v57, v82, v83
  v_exp_f32 v86, v86
  v_exp_f32 v87, v87
  v_cvt_pk_bf16_f32 v58, v84, v85
  v_exp_f32 v88, v88
  v_mfma_f32_32x32x8bf16_1k v[64:79], v[36:37], v[24:25], v[64:79]
  ds_read_u16 v38, v132 offset:20736
  v_exp_f32 v89, v89
  v_cvt_pk_bf16_f32 v59, v86, v87
  v_exp_f32 v90, v90
  v_exp_f32 v91, v91
  v_cvt_pk_bf16_f32 v60, v88, v89
  v_exp_f32 v92, v92
  v_mfma_f32_32x32x16_bf16 v[112:127], v[48:51], v[56:59], v[112:127]
  s_waitcnt lgkmcnt(2)
  v_exp_f32 v93, v93
  v_cvt_pk_bf16_f32 v61, v90, v91
  v_exp_f32 v94, v94
  v_exp_f32 v95, v95
  v_cvt_pk_bf16_f32 v62, v92, v93
  v_exp_f32 v64, v64
  v_exp_f32 v65, v65
  v_cvt_pk_bf16_f32 v63, v94, v95
  v_exp_f32 v66, v66
  v_mfma_f32_32x32x16_bf16 v[80:95], v[28:31], v[20:23], 0
  v_exp_f32 v67, v67
  v_cvt_pk_bf16_f32 v56, v64, v65
  v_exp_f32 v68, v68
  v_mfma_f32_32x32x16_bf16 v[112:127], v[52:55], v[60:63], v[112:127]
  v_exp_f32 v69, v69
  v_cvt_pk_bf16_f32 v57, v66, v67
  v_exp_f32 v70, v70
  v_exp_f32 v71, v71
  v_cvt_pk_bf16_f32 v58, v68, v69
  v_exp_f32 v72, v72
  v_mfma_f32_32x32x8bf16_1k v[80:95], v[36:37], v[26:27], v[80:95]
  s_mov_b64 exec, s[84:85]
  ds_read_b128 v[48:51], v133 offset:20736
  ds_read_b128 v[52:55], v133 offset:21376
  s_mov_b64 exec, -1
  v_exp_f32 v73, v73
  v_cvt_pk_bf16_f32 v59, v70, v71
  v_exp_f32 v74, v74
  v_exp_f32 v75, v75
  v_cvt_pk_bf16_f32 v60, v72, v73
  v_exp_f32 v76, v76
  v_mfma_f32_32x32x16_bf16 v[96:111], v[40:43], v[56:59], v[96:111]
  s_waitcnt lgkmcnt(2)
  v_exp_f32 v77, v77
  v_cvt_pk_bf16_f32 v61, v74, v75
  v_exp_f32 v78, v78
  v_exp_f32 v79, v79
  v_cvt_pk_bf16_f32 v62, v76, v77
  v_exp_f32 v80, v80
  v_exp_f32 v81, v81
  v_cvt_pk_bf16_f32 v63, v78, v79
  v_exp_f32 v82, v82
  v_mfma_f32_32x32x16_bf16 v[64:79], v[32:35], v[16:19], 0
  ds_read_b128 v[28:31], v131 offset:23040
  v_exp_f32 v83, v83
  v_cvt_pk_bf16_f32 v56, v80, v81
  v_exp_f32 v84, v84
  v_mfma_f32_32x32x16_bf16 v[96:111], v[44:47], v[60:63], v[96:111]
  v_exp_f32 v85, v85
  v_cvt_pk_bf16_f32 v57, v82, v83
  v_exp_f32 v86, v86
  v_exp_f32 v87, v87
  v_cvt_pk_bf16_f32 v58, v84, v85
  v_exp_f32 v88, v88
  v_mfma_f32_32x32x8bf16_1k v[64:79], v[38:39], v[24:25], v[64:79]
  ds_read_u16 v36, v132 offset:23040
  v_exp_f32 v89, v89
  v_cvt_pk_bf16_f32 v59, v86, v87
  v_exp_f32 v90, v90
  v_exp_f32 v91, v91
  v_cvt_pk_bf16_f32 v60, v88, v89
  v_exp_f32 v92, v92
  v_mfma_f32_32x32x16_bf16 v[112:127], v[40:43], v[56:59], v[112:127]
  s_waitcnt lgkmcnt(2)
  v_exp_f32 v93, v93
  v_cvt_pk_bf16_f32 v61, v90, v91
  v_exp_f32 v94, v94
  v_exp_f32 v95, v95
  v_cvt_pk_bf16_f32 v62, v92, v93
  v_exp_f32 v64, v64
  v_exp_f32 v65, v65
  v_cvt_pk_bf16_f32 v63, v94, v95
  v_exp_f32 v66, v66
  v_mfma_f32_32x32x16_bf16 v[80:95], v[32:35], v[20:23], 0
  v_exp_f32 v67, v67
  v_cvt_pk_bf16_f32 v56, v64, v65
  v_exp_f32 v68, v68
  v_mfma_f32_32x32x16_bf16 v[112:127], v[44:47], v[60:63], v[112:127]
  v_exp_f32 v69, v69
  v_cvt_pk_bf16_f32 v57, v66, v67
  v_exp_f32 v70, v70
  v_exp_f32 v71, v71
  v_cvt_pk_bf16_f32 v58, v68, v69
  v_exp_f32 v72, v72
  v_mfma_f32_32x32x8bf16_1k v[80:95], v[38:39], v[26:27], v[80:95]
  s_mov_b64 exec, s[84:85]
  ds_read_b128 v[40:43], v133 offset:23040
  ds_read_b128 v[44:47], v133 offset:23680
  s_mov_b64 exec, -1
  v_exp_f32 v73, v73
  v_cvt_pk_bf16_f32 v59, v70, v71
  v_exp_f32 v74, v74
  v_exp_f32 v75, v75
  v_cvt_pk_bf16_f32 v60, v72, v73
  v_exp_f32 v76, v76
  v_mfma_f32_32x32x16_bf16 v[96:111], v[48:51], v[56:59], v[96:111]
  s_waitcnt lgkmcnt(2)
  v_exp_f32 v77, v77
  v_cvt_pk_bf16_f32 v61, v74, v75
  v_exp_f32 v78, v78
  v_exp_f32 v79, v79
  v_cvt_pk_bf16_f32 v62, v76, v77
  v_exp_f32 v80, v80
  v_exp_f32 v81, v81
  v_cvt_pk_bf16_f32 v63, v78, v79
  v_exp_f32 v82, v82
  v_mfma_f32_32x32x16_bf16 v[64:79], v[28:31], v[16:19], 0
  ds_read_b128 v[32:35], v131 offset:25344
  v_exp_f32 v83, v83
  v_cvt_pk_bf16_f32 v56, v80, v81
  v_exp_f32 v84, v84
  v_mfma_f32_32x32x16_bf16 v[96:111], v[52:55], v[60:63], v[96:111]
  v_exp_f32 v85, v85
  v_cvt_pk_bf16_f32 v57, v82, v83
  v_exp_f32 v86, v86
  v_exp_f32 v87, v87
  v_cvt_pk_bf16_f32 v58, v84, v85
  v_exp_f32 v88, v88
  v_mfma_f32_32x32x8bf16_1k v[64:79], v[36:37], v[24:25], v[64:79]
  ds_read_u16 v38, v132 offset:25344
  v_exp_f32 v89, v89
  v_cvt_pk_bf16_f32 v59, v86, v87
  v_exp_f32 v90, v90
  v_exp_f32 v91, v91
  v_cvt_pk_bf16_f32 v60, v88, v89
  v_exp_f32 v92, v92
  v_mfma_f32_32x32x16_bf16 v[112:127], v[48:51], v[56:59], v[112:127]
  s_waitcnt lgkmcnt(2)
  v_exp_f32 v93, v93
  v_cvt_pk_bf16_f32 v61, v90, v91
  v_exp_f32 v94, v94
  v_exp_f32 v95, v95
  v_cvt_pk_bf16_f32 v62, v92, v93
  v_exp_f32 v64, v64
  v_exp_f32 v65, v65
  v_cvt_pk_bf16_f32 v63, v94, v95
  v_exp_f32 v66, v66
  v_mfma_f32_32x32x16_bf16 v[80:95], v[28:31], v[20:23], 0
  v_exp_f32 v67, v67
  v_cvt_pk_bf16_f32 v56, v64, v65
  v_exp_f32 v68, v68
  v_mfma_f32_32x32x16_bf16 v[112:127], v[52:55], v[60:63], v[112:127]
  buffer_load_dwordx4 v[160:163], v4, s[24:27], s79 offen offset:0 sc1
  v_exp_f32 v69, v69
  v_cvt_pk_bf16_f32 v57, v66, v67
  v_exp_f32 v70, v70
  v_exp_f32 v71, v71
  v_cvt_pk_bf16_f32 v58, v68, v69
  v_exp_f32 v72, v72
  v_mfma_f32_32x32x8bf16_1k v[80:95], v[36:37], v[26:27], v[80:95]
  s_mov_b64 exec, s[84:85]
  ds_read_b128 v[48:51], v133 offset:25344
  ds_read_b128 v[52:55], v133 offset:25984
  s_mov_b64 exec, -1
  v_exp_f32 v73, v73
  v_cvt_pk_bf16_f32 v59, v70, v71
  v_exp_f32 v74, v74
  v_exp_f32 v75, v75
  v_cvt_pk_bf16_f32 v60, v72, v73
  v_exp_f32 v76, v76
  v_mfma_f32_32x32x16_bf16 v[96:111], v[40:43], v[56:59], v[96:111]
  s_waitcnt lgkmcnt(2)
  v_exp_f32 v77, v77
  v_cvt_pk_bf16_f32 v61, v74, v75
  v_exp_f32 v78, v78
  v_exp_f32 v79, v79
  v_cvt_pk_bf16_f32 v62, v76, v77
  v_exp_f32 v80, v80
  v_exp_f32 v81, v81
  v_cvt_pk_bf16_f32 v63, v78, v79
  v_exp_f32 v82, v82
  v_mfma_f32_32x32x16_bf16 v[64:79], v[32:35], v[16:19], 0
  ds_read_b128 v[28:31], v131 offset:27648
  v_exp_f32 v83, v83
  v_cvt_pk_bf16_f32 v56, v80, v81
  v_exp_f32 v84, v84
  v_mfma_f32_32x32x16_bf16 v[96:111], v[44:47], v[60:63], v[96:111]
  v_exp_f32 v85, v85
  v_cvt_pk_bf16_f32 v57, v82, v83
  v_exp_f32 v86, v86
  v_exp_f32 v87, v87
  v_cvt_pk_bf16_f32 v58, v84, v85
  v_exp_f32 v88, v88
  v_mfma_f32_32x32x8bf16_1k v[64:79], v[38:39], v[24:25], v[64:79]
  ds_read_u16 v36, v132 offset:27648
  v_exp_f32 v89, v89
  v_cvt_pk_bf16_f32 v59, v86, v87
  v_exp_f32 v90, v90
  v_exp_f32 v91, v91
  v_cvt_pk_bf16_f32 v60, v88, v89
  v_exp_f32 v92, v92
  v_mfma_f32_32x32x16_bf16 v[112:127], v[40:43], v[56:59], v[112:127]
  s_waitcnt lgkmcnt(2)
  v_exp_f32 v93, v93
  v_cvt_pk_bf16_f32 v61, v90, v91
  v_exp_f32 v94, v94
  v_exp_f32 v95, v95
  v_cvt_pk_bf16_f32 v62, v92, v93
  s_setprio 2
  v_exp_f32 v64, v64
  v_exp_f32 v65, v65
  v_cvt_pk_bf16_f32 v63, v94, v95
  v_exp_f32 v66, v66
  v_mfma_f32_32x32x16_bf16 v[80:95], v[32:35], v[20:23], 0
  v_exp_f32 v67, v67
  v_cvt_pk_bf16_f32 v56, v64, v65
  v_exp_f32 v68, v68
  v_mfma_f32_32x32x16_bf16 v[112:127], v[44:47], v[60:63], v[112:127]
  buffer_load_dwordx4 v[164:167], v4, s[24:27], s79 offen offset:1024 sc1
  v_exp_f32 v69, v69
  v_cvt_pk_bf16_f32 v57, v66, v67
  v_exp_f32 v70, v70
  v_exp_f32 v71, v71
  v_cvt_pk_bf16_f32 v58, v68, v69
  v_exp_f32 v72, v72
  v_mfma_f32_32x32x8bf16_1k v[80:95], v[38:39], v[26:27], v[80:95]
  s_mov_b64 exec, s[84:85]
  ds_read_b128 v[40:43], v133 offset:27648
  ds_read_b128 v[44:47], v133 offset:28288
  s_mov_b64 exec, -1
  v_exp_f32 v73, v73
  v_cvt_pk_bf16_f32 v59, v70, v71
  v_exp_f32 v74, v74
  v_exp_f32 v75, v75
  v_cvt_pk_bf16_f32 v60, v72, v73
  v_exp_f32 v76, v76
  v_mfma_f32_32x32x16_bf16 v[96:111], v[48:51], v[56:59], v[96:111]
  s_waitcnt lgkmcnt(2)
  v_exp_f32 v77, v77
  v_cvt_pk_bf16_f32 v61, v74, v75
  v_exp_f32 v78, v78
  v_exp_f32 v79, v79
  v_cvt_pk_bf16_f32 v62, v76, v77
  v_exp_f32 v80, v80
  v_exp_f32 v81, v81
  v_cvt_pk_bf16_f32 v63, v78, v79
  v_exp_f32 v82, v82
  v_mfma_f32_32x32x16_bf16 v[64:79], v[28:31], v[16:19], 0
  ds_read_b128 v[32:35], v131 offset:29952
  v_exp_f32 v83, v83
  v_cvt_pk_bf16_f32 v56, v80, v81
  v_exp_f32 v84, v84
  v_mfma_f32_32x32x16_bf16 v[96:111], v[52:55], v[60:63], v[96:111]
  v_exp_f32 v85, v85
  v_cvt_pk_bf16_f32 v57, v82, v83
  v_exp_f32 v86, v86
  v_exp_f32 v87, v87
  v_cvt_pk_bf16_f32 v58, v84, v85
  v_exp_f32 v88, v88
  v_mfma_f32_32x32x8bf16_1k v[64:79], v[36:37], v[24:25], v[64:79]
  ds_read_u16 v38, v132 offset:29952
  v_exp_f32 v89, v89
  v_cvt_pk_bf16_f32 v59, v86, v87
  v_exp_f32 v90, v90
  v_exp_f32 v91, v91
  v_cvt_pk_bf16_f32 v60, v88, v89
  v_exp_f32 v92, v92
  v_mfma_f32_32x32x16_bf16 v[112:127], v[48:51], v[56:59], v[112:127]
  s_waitcnt lgkmcnt(2)
  v_exp_f32 v93, v93
  v_cvt_pk_bf16_f32 v61, v90, v91
  v_exp_f32 v94, v94
  v_exp_f32 v95, v95
  v_cvt_pk_bf16_f32 v62, v92, v93
  v_exp_f32 v64, v64
  v_exp_f32 v65, v65
  v_cvt_pk_bf16_f32 v63, v94, v95
  v_exp_f32 v66, v66
  v_mfma_f32_32x32x16_bf16 v[80:95], v[28:31], v[20:23], 0
  v_exp_f32 v67, v67
  v_cvt_pk_bf16_f32 v56, v64, v65
  v_exp_f32 v68, v68
  v_mfma_f32_32x32x16_bf16 v[112:127], v[52:55], v[60:63], v[112:127]
  buffer_load_dwordx4 v[168:171], v4, s[24:27], s79 offen offset:2048 sc1
  v_exp_f32 v69, v69
  v_cvt_pk_bf16_f32 v57, v66, v67
  v_exp_f32 v70, v70
  v_exp_f32 v71, v71
  v_cvt_pk_bf16_f32 v58, v68, v69
  v_exp_f32 v72, v72
  v_mfma_f32_32x32x8bf16_1k v[80:95], v[36:37], v[26:27], v[80:95]
  s_mov_b64 exec, s[84:85]
  ds_read_b128 v[48:51], v133 offset:29952
  ds_read_b128 v[52:55], v133 offset:30592
  s_mov_b64 exec, -1
  v_exp_f32 v73, v73
  v_cvt_pk_bf16_f32 v59, v70, v71
  v_exp_f32 v74, v74
  v_exp_f32 v75, v75
  v_cvt_pk_bf16_f32 v60, v72, v73
  v_exp_f32 v76, v76
  v_mfma_f32_32x32x16_bf16 v[96:111], v[40:43], v[56:59], v[96:111]
  s_waitcnt lgkmcnt(2)
  v_exp_f32 v77, v77
  v_cvt_pk_bf16_f32 v61, v74, v75
  v_exp_f32 v78, v78
  v_exp_f32 v79, v79
  v_cvt_pk_bf16_f32 v62, v76, v77
  v_exp_f32 v80, v80
  v_exp_f32 v81, v81
  v_cvt_pk_bf16_f32 v63, v78, v79
  v_exp_f32 v82, v82
  v_mfma_f32_32x32x16_bf16 v[64:79], v[32:35], v[16:19], 0
  ds_read_b128 v[28:31], v131 offset:32256
  v_exp_f32 v83, v83
  v_cvt_pk_bf16_f32 v56, v80, v81
  v_exp_f32 v84, v84
  v_mfma_f32_32x32x16_bf16 v[96:111], v[44:47], v[60:63], v[96:111]
  v_exp_f32 v85, v85
  v_cvt_pk_bf16_f32 v57, v82, v83
  v_exp_f32 v86, v86
  v_exp_f32 v87, v87
  v_cvt_pk_bf16_f32 v58, v84, v85
  v_exp_f32 v88, v88
  v_mfma_f32_32x32x8bf16_1k v[64:79], v[38:39], v[24:25], v[64:79]
  ds_read_u16 v36, v132 offset:32256
  v_exp_f32 v89, v89
  v_cvt_pk_bf16_f32 v59, v86, v87
  v_exp_f32 v90, v90
  v_exp_f32 v91, v91
  v_cvt_pk_bf16_f32 v60, v88, v89
  v_exp_f32 v92, v92
  v_mfma_f32_32x32x16_bf16 v[112:127], v[40:43], v[56:59], v[112:127]
  s_waitcnt lgkmcnt(2)
  v_exp_f32 v93, v93
  v_cvt_pk_bf16_f32 v61, v90, v91
  v_exp_f32 v94, v94
  v_exp_f32 v95, v95
  v_cvt_pk_bf16_f32 v62, v92, v93
  v_exp_f32 v64, v64
  v_exp_f32 v65, v65
  v_cvt_pk_bf16_f32 v63, v94, v95
  v_exp_f32 v66, v66
  v_mfma_f32_32x32x16_bf16 v[80:95], v[32:35], v[20:23], 0
  v_exp_f32 v67, v67
  v_cvt_pk_bf16_f32 v56, v64, v65
  v_exp_f32 v68, v68
  v_mfma_f32_32x32x16_bf16 v[112:127], v[44:47], v[60:63], v[112:127]
  buffer_load_dwordx4 v[172:175], v4, s[24:27], s79 offen offset:3072 sc1
  s_add_u32 s79, s79, 4096
  v_exp_f32 v69, v69
  v_cvt_pk_bf16_f32 v57, v66, v67
  v_exp_f32 v70, v70
  v_exp_f32 v71, v71
  v_cvt_pk_bf16_f32 v58, v68, v69
  v_exp_f32 v72, v72
  v_mfma_f32_32x32x8bf16_1k v[80:95], v[38:39], v[26:27], v[80:95]
  s_mov_b64 exec, s[84:85]
  ds_read_b128 v[40:43], v133 offset:32256
  ds_read_b128 v[44:47], v133 offset:32896
  s_mov_b64 exec, -1
  v_exp_f32 v73, v73
  v_cvt_pk_bf16_f32 v59, v70, v71
  v_exp_f32 v74, v74
  v_exp_f32 v75, v75
  v_cvt_pk_bf16_f32 v60, v72, v73
  v_exp_f32 v76, v76
  v_mfma_f32_32x32x16_bf16 v[96:111], v[48:51], v[56:59], v[96:111]
  s_waitcnt lgkmcnt(2)
  v_exp_f32 v77, v77
  v_cvt_pk_bf16_f32 v61, v74, v75
  v_exp_f32 v78, v78
  v_exp_f32 v79, v79
  v_cvt_pk_bf16_f32 v62, v76, v77
  s_setprio 1
  v_exp_f32 v80, v80
  v_exp_f32 v81, v81
  v_cvt_pk_bf16_f32 v63, v78, v79
  v_exp_f32 v82, v82
  v_mfma_f32_32x32x16_bf16 v[64:79], v[28:31], v[16:19], 0
  ds_read_b128 v[32:35], v131 offset:34560
  v_exp_f32 v83, v83
  v_cvt_pk_bf16_f32 v56, v80, v81
  v_exp_f32 v84, v84
  v_mfma_f32_32x32x16_bf16 v[96:111], v[52:55], v[60:63], v[96:111]
  v_exp_f32 v85, v85
  v_cvt_pk_bf16_f32 v57, v82, v83
  v_exp_f32 v86, v86
  v_exp_f32 v87, v87
  v_cvt_pk_bf16_f32 v58, v84, v85
  v_exp_f32 v88, v88
  v_mfma_f32_32x32x8bf16_1k v[64:79], v[36:37], v[24:25], v[64:79]
  ds_read_u16 v38, v132 offset:34560
  v_exp_f32 v89, v89
  v_cvt_pk_bf16_f32 v59, v86, v87
  v_exp_f32 v90, v90
  v_exp_f32 v91, v91
  v_cvt_pk_bf16_f32 v60, v88, v89
  v_exp_f32 v92, v92
  v_mfma_f32_32x32x16_bf16 v[112:127], v[48:51], v[56:59], v[112:127]
  s_waitcnt lgkmcnt(2)
  v_exp_f32 v93, v93
  v_cvt_pk_bf16_f32 v61, v90, v91
  v_exp_f32 v94, v94
  v_exp_f32 v95, v95
  v_cvt_pk_bf16_f32 v62, v92, v93
  v_exp_f32 v64, v64
  v_exp_f32 v65, v65
  v_cvt_pk_bf16_f32 v63, v94, v95
  v_exp_f32 v66, v66
  v_mfma_f32_32x32x16_bf16 v[80:95], v[28:31], v[20:23], 0
  v_exp_f32 v67, v67
  v_cvt_pk_bf16_f32 v56, v64, v65
  v_exp_f32 v68, v68
  v_mfma_f32_32x32x16_bf16 v[112:127], v[52:55], v[60:63], v[112:127]
  buffer_load_dwordx4 v[176:179], v4, s[24:27], s79 offen offset:0 sc1
  v_exp_f32 v69, v69
  v_cvt_pk_bf16_f32 v57, v66, v67
  v_exp_f32 v70, v70
  v_exp_f32 v71, v71
  v_cvt_pk_bf16_f32 v58, v68, v69
  v_exp_f32 v72, v72
  v_mfma_f32_32x32x8bf16_1k v[80:95], v[36:37], v[26:27], v[80:95]
  s_mov_b64 exec, s[84:85]
  ds_read_b128 v[48:51], v133 offset:34560
  ds_read_b128 v[52:55], v133 offset:35200
  s_mov_b64 exec, -1
  v_exp_f32 v73, v73
  v_cvt_pk_bf16_f32 v59, v70, v71
  v_exp_f32 v74, v74
  v_exp_f32 v75, v75
  v_cvt_pk_bf16_f32 v60, v72, v73
  v_exp_f32 v76, v76
  v_mfma_f32_32x32x16_bf16 v[96:111], v[40:43], v[56:59], v[96:111]
  s_waitcnt lgkmcnt(2)
  v_exp_f32 v77, v77
  v_cvt_pk_bf16_f32 v61, v74, v75
  v_exp_f32 v78, v78
  v_exp_f32 v79, v79
  v_cvt_pk_bf16_f32 v62, v76, v77
  v_exp_f32 v80, v80
  v_exp_f32 v81, v81
  v_cvt_pk_bf16_f32 v63, v78, v79
  v_exp_f32 v82, v82
  v_mfma_f32_32x32x16_bf16 v[64:79], v[32:35], v[16:19], 0
  ds_read_b128 v[28:31], v131 offset:36864
  v_exp_f32 v83, v83
  v_cvt_pk_bf16_f32 v56, v80, v81
  v_exp_f32 v84, v84
  v_mfma_f32_32x32x16_bf16 v[96:111], v[44:47], v[60:63], v[96:111]
  v_exp_f32 v85, v85
  v_cvt_pk_bf16_f32 v57, v82, v83
  v_exp_f32 v86, v86
  v_exp_f32 v87, v87
  v_cvt_pk_bf16_f32 v58, v84, v85
  v_exp_f32 v88, v88
  v_mfma_f32_32x32x8bf16_1k v[64:79], v[38:39], v[24:25], v[64:79]
  ds_read_u16 v36, v132 offset:36864
  v_exp_f32 v89, v89
  v_cvt_pk_bf16_f32 v59, v86, v87
  v_exp_f32 v90, v90
  v_exp_f32 v91, v91
  v_cvt_pk_bf16_f32 v60, v88, v89
  v_exp_f32 v92, v92
  v_mfma_f32_32x32x16_bf16 v[112:127], v[40:43], v[56:59], v[112:127]
  s_waitcnt lgkmcnt(2)
  v_exp_f32 v93, v93
  v_cvt_pk_bf16_f32 v61, v90, v91
  v_exp_f32 v94, v94
  v_exp_f32 v95, v95
  v_cvt_pk_bf16_f32 v62, v92, v93
  s_setprio 0
  v_exp_f32 v64, v64
  v_exp_f32 v65, v65
  v_cvt_pk_bf16_f32 v63, v94, v95
  v_exp_f32 v66, v66
  v_mfma_f32_32x32x16_bf16 v[80:95], v[32:35], v[20:23], 0
  v_exp_f32 v67, v67
  v_cvt_pk_bf16_f32 v56, v64, v65
  v_exp_f32 v68, v68
  v_mfma_f32_32x32x16_bf16 v[112:127], v[44:47], v[60:63], v[112:127]
  buffer_load_dwordx4 v[180:183], v4, s[24:27], s79 offen offset:1024 sc1
  v_exp_f32 v69, v69
  v_cvt_pk_bf16_f32 v57, v66, v67
  v_exp_f32 v70, v70
  v_exp_f32 v71, v71
  v_cvt_pk_bf16_f32 v58, v68, v69
  v_exp_f32 v72, v72
  v_mfma_f32_32x32x8bf16_1k v[80:95], v[38:39], v[26:27], v[80:95]
  s_mov_b64 exec, s[84:85]
  ds_read_b128 v[40:43], v133 offset:36864
  ds_read_b128 v[44:47], v133 offset:37504
  s_mov_b64 exec, -1
  v_exp_f32 v73, v73
  v_cvt_pk_bf16_f32 v59, v70, v71
  v_exp_f32 v74, v74
  v_exp_f32 v75, v75
  v_cvt_pk_bf16_f32 v60, v72, v73
  v_exp_f32 v76, v76
  v_mfma_f32_32x32x16_bf16 v[96:111], v[48:51], v[56:59], v[96:111]
  s_waitcnt lgkmcnt(2)
  v_exp_f32 v77, v77
  v_cvt_pk_bf16_f32 v61, v74, v75
  v_exp_f32 v78, v78
  v_exp_f32 v79, v79
  v_cvt_pk_bf16_f32 v62, v76, v77
  s_waitcnt vmcnt(6)
  s_barrier
  s_setprio 3
  v_exp_f32 v80, v80
  v_exp_f32 v81, v81
  v_cvt_pk_bf16_f32 v63, v78, v79
  v_exp_f32 v82, v82
  v_mfma_f32_32x32x16_bf16 v[64:79], v[28:31], v[16:19], 0
  ds_read_b128 v[32:35], v131 offset:39168
  v_exp_f32 v83, v83
  v_cvt_pk_bf16_f32 v56, v80, v81
  v_exp_f32 v84, v84
  v_mfma_f32_32x32x16_bf16 v[96:111], v[52:55], v[60:63], v[96:111]
  v_exp_f32 v85, v85
  v_cvt_pk_bf16_f32 v57, v82, v83
  v_exp_f32 v86, v86
  v_exp_f32 v87, v87
  v_cvt_pk_bf16_f32 v58, v84, v85
  v_exp_f32 v88, v88
  v_mfma_f32_32x32x8bf16_1k v[64:79], v[36:37], v[24:25], v[64:79]
  ds_read_u16 v38, v132 offset:39168
  v_exp_f32 v89, v89
  v_cvt_pk_bf16_f32 v59, v86, v87
  v_exp_f32 v90, v90
  v_exp_f32 v91, v91
  v_cvt_pk_bf16_f32 v60, v88, v89
  v_exp_f32 v92, v92
  v_mfma_f32_32x32x16_bf16 v[112:127], v[48:51], v[56:59], v[112:127]
  s_waitcnt lgkmcnt(2)
  v_exp_f32 v93, v93
  v_cvt_pk_bf16_f32 v61, v90, v91
  v_exp_f32 v94, v94
  v_exp_f32 v95, v95
  v_cvt_pk_bf16_f32 v62, v92, v93
  v_exp_f32 v64, v64
  v_exp_f32 v65, v65
  v_cvt_pk_bf16_f32 v63, v94, v95
  v_exp_f32 v66, v66
  v_mfma_f32_32x32x16_bf16 v[80:95], v[28:31], v[20:23], 0
  v_exp_f32 v67, v67
  v_cvt_pk_bf16_f32 v56, v64, v65
  v_exp_f32 v68, v68
  v_mfma_f32_32x32x16_bf16 v[112:127], v[52:55], v[60:63], v[112:127]
  buffer_load_dwordx4 v[184:187], v4, s[24:27], s79 offen offset:2048 sc1
  v_exp_f32 v69, v69
  v_cvt_pk_bf16_f32 v57, v66, v67
  v_exp_f32 v70, v70
  v_exp_f32 v71, v71
  v_cvt_pk_bf16_f32 v58, v68, v69
  v_exp_f32 v72, v72
  v_mfma_f32_32x32x8bf16_1k v[80:95], v[36:37], v[26:27], v[80:95]
  s_mov_b64 exec, s[84:85]
  ds_read_b128 v[48:51], v130 offset:2304
  ds_read_b128 v[52:55], v130 offset:2944
  s_mov_b64 exec, -1
  v_exp_f32 v73, v73
  v_cvt_pk_bf16_f32 v59, v70, v71
  v_exp_f32 v74, v74
  v_exp_f32 v75, v75
  v_cvt_pk_bf16_f32 v60, v72, v73
  v_exp_f32 v76, v76
  v_mfma_f32_32x32x16_bf16 v[96:111], v[40:43], v[56:59], v[96:111]
  s_waitcnt lgkmcnt(2)
  v_exp_f32 v77, v77
  v_cvt_pk_bf16_f32 v61, v74, v75
  v_exp_f32 v78, v78
  v_exp_f32 v79, v79
  v_cvt_pk_bf16_f32 v62, v76, v77
  v_exp_f32 v80, v80
  v_exp_f32 v81, v81
  v_cvt_pk_bf16_f32 v63, v78, v79
  v_exp_f32 v82, v82
  v_mfma_f32_32x32x16_bf16 v[64:79], v[32:35], v[16:19], 0
  ds_read_b128 v[28:31], v128 offset:4608
  v_exp_f32 v83, v83
  v_cvt_pk_bf16_f32 v56, v80, v81
  v_exp_f32 v84, v84
  v_mfma_f32_32x32x16_bf16 v[96:111], v[44:47], v[60:63], v[96:111]
  v_exp_f32 v85, v85
  v_cvt_pk_bf16_f32 v57, v82, v83
  v_exp_f32 v86, v86
  v_exp_f32 v87, v87
  v_cvt_pk_bf16_f32 v58, v84, v85
  v_exp_f32 v88, v88
  v_mfma_f32_32x32x8bf16_1k v[64:79], v[38:39], v[24:25], v[64:79]
  ds_read_u16 v36, v129 offset:4608
  v_exp_f32 v89, v89
  v_cvt_pk_bf16_f32 v59, v86, v87
  v_exp_f32 v90, v90
  v_exp_f32 v91, v91
  v_cvt_pk_bf16_f32 v60, v88, v89
  v_exp_f32 v92, v92
  v_mfma_f32_32x32x16_bf16 v[112:127], v[40:43], v[56:59], v[112:127]
  s_waitcnt lgkmcnt(2)
  v_exp_f32 v93, v93
  v_cvt_pk_bf16_f32 v61, v90, v91
  v_exp_f32 v94, v94
  v_exp_f32 v95, v95
  v_cvt_pk_bf16_f32 v62, v92, v93
  v_exp_f32 v64, v64
  v_exp_f32 v65, v65
  v_cvt_pk_bf16_f32 v63, v94, v95
  v_exp_f32 v66, v66
  v_mfma_f32_32x32x16_bf16 v[80:95], v[32:35], v[20:23], 0
  v_exp_f32 v67, v67
  v_cvt_pk_bf16_f32 v56, v64, v65
  v_exp_f32 v68, v68
  v_mfma_f32_32x32x16_bf16 v[112:127], v[44:47], v[60:63], v[112:127]
  buffer_load_dwordx4 v[188:191], v4, s[24:27], s79 offen offset:3072 sc1
  s_add_u32 s79, s79, 4096
  v_exp_f32 v69, v69
  v_cvt_pk_bf16_f32 v57, v66, v67
  v_exp_f32 v70, v70
  v_exp_f32 v71, v71
  v_cvt_pk_bf16_f32 v58, v68, v69
  v_exp_f32 v72, v72
  v_mfma_f32_32x32x8bf16_1k v[80:95], v[38:39], v[26:27], v[80:95]
  s_mov_b64 exec, s[84:85]
  ds_read_b128 v[40:43], v130 offset:4608
  ds_read_b128 v[44:47], v130 offset:5248
  s_mov_b64 exec, -1
  v_exp_f32 v73, v73
  v_cvt_pk_bf16_f32 v59, v70, v71
  v_exp_f32 v74, v74
  v_exp_f32 v75, v75
  v_cvt_pk_bf16_f32 v60, v72, v73
  v_exp_f32 v76, v76
  v_mfma_f32_32x32x16_bf16 v[96:111], v[48:51], v[56:59], v[96:111]
  s_waitcnt lgkmcnt(2)
  v_exp_f32 v77, v77
  v_cvt_pk_bf16_f32 v61, v74, v75
  v_exp_f32 v78, v78
  v_exp_f32 v79, v79
  v_cvt_pk_bf16_f32 v62, v76, v77
  v_exp_f32 v80, v80
  v_exp_f32 v81, v81
  v_cvt_pk_bf16_f32 v63, v78, v79
  v_exp_f32 v82, v82
  v_mfma_f32_32x32x16_bf16 v[64:79], v[28:31], v[16:19], 0
  ds_read_b128 v[32:35], v128 offset:6912
  v_exp_f32 v83, v83
  v_cvt_pk_bf16_f32 v56, v80, v81
  v_exp_f32 v84, v84
  v_mfma_f32_32x32x16_bf16 v[96:111], v[52:55], v[60:63], v[96:111]
  v_exp_f32 v85, v85
  v_cvt_pk_bf16_f32 v57, v82, v83
  v_exp_f32 v86, v86
  v_exp_f32 v87, v87
  v_cvt_pk_bf16_f32 v58, v84, v85
  v_exp_f32 v88, v88
  v_mfma_f32_32x32x8bf16_1k v[64:79], v[36:37], v[24:25], v[64:79]
  ds_read_u16 v38, v129 offset:6912
  v_exp_f32 v89, v89
  v_cvt_pk_bf16_f32 v59, v86, v87
  v_exp_f32 v90, v90
  v_exp_f32 v91, v91
  v_cvt_pk_bf16_f32 v60, v88, v89
  v_exp_f32 v92, v92
  v_mfma_f32_32x32x16_bf16 v[112:127], v[48:51], v[56:59], v[112:127]
  s_waitcnt lgkmcnt(2)
  v_exp_f32 v93, v93
  v_cvt_pk_bf16_f32 v61, v90, v91
  v_exp_f32 v94, v94
  v_exp_f32 v95, v95
  v_cvt_pk_bf16_f32 v62, v92, v93
  v_exp_f32 v64, v64
  v_exp_f32 v65, v65
  v_cvt_pk_bf16_f32 v63, v94, v95
  v_exp_f32 v66, v66
  v_mfma_f32_32x32x16_bf16 v[80:95], v[28:31], v[20:23], 0
  v_exp_f32 v67, v67
  v_cvt_pk_bf16_f32 v56, v64, v65
  v_exp_f32 v68, v68
  v_mfma_f32_32x32x16_bf16 v[112:127], v[52:55], v[60:63], v[112:127]
  buffer_load_dwordx4 v[192:195], v4, s[24:27], s79 offen offset:0 sc1
  v_exp_f32 v69, v69
  v_cvt_pk_bf16_f32 v57, v66, v67
  v_exp_f32 v70, v70
  v_exp_f32 v71, v71
  v_cvt_pk_bf16_f32 v58, v68, v69
  v_exp_f32 v72, v72
  v_mfma_f32_32x32x8bf16_1k v[80:95], v[36:37], v[26:27], v[80:95]
  s_mov_b64 exec, s[84:85]
  ds_read_b128 v[48:51], v130 offset:6912
  ds_read_b128 v[52:55], v130 offset:7552
  s_mov_b64 exec, -1
  v_exp_f32 v73, v73
  v_cvt_pk_bf16_f32 v59, v70, v71
  v_exp_f32 v74, v74
  v_exp_f32 v75, v75
  v_cvt_pk_bf16_f32 v60, v72, v73
  v_exp_f32 v76, v76
  v_mfma_f32_32x32x16_bf16 v[96:111], v[40:43], v[56:59], v[96:111]
  s_waitcnt lgkmcnt(2)
  v_exp_f32 v77, v77
  v_cvt_pk_bf16_f32 v61, v74, v75
  v_exp_f32 v78, v78
  v_exp_f32 v79, v79
  v_cvt_pk_bf16_f32 v62, v76, v77
  v_exp_f32 v80, v80
  v_exp_f32 v81, v81
  v_cvt_pk_bf16_f32 v63, v78, v79
  v_exp_f32 v82, v82
  v_mfma_f32_32x32x16_bf16 v[64:79], v[32:35], v[16:19], 0
  ds_read_b128 v[28:31], v128 offset:9216
  v_exp_f32 v83, v83
  v_cvt_pk_bf16_f32 v56, v80, v81
  v_exp_f32 v84, v84
  v_mfma_f32_32x32x16_bf16 v[96:111], v[44:47], v[60:63], v[96:111]
  v_exp_f32 v85, v85
  v_cvt_pk_bf16_f32 v57, v82, v83
  v_exp_f32 v86, v86
  v_exp_f32 v87, v87
  v_cvt_pk_bf16_f32 v58, v84, v85
  v_exp_f32 v88, v88
  v_mfma_f32_32x32x8bf16_1k v[64:79], v[38:39], v[24:25], v[64:79]
  ds_read_u16 v36, v129 offset:9216
  v_exp_f32 v89, v89
  v_cvt_pk_bf16_f32 v59, v86, v87
  v_exp_f32 v90, v90
  v_exp_f32 v91, v91
  v_cvt_pk_bf16_f32 v60, v88, v89
  v_exp_f32 v92, v92
  v_mfma_f32_32x32x16_bf16 v[112:127], v[40:43], v[56:59], v[112:127]
  s_waitcnt lgkmcnt(2)
  v_exp_f32 v93, v93
  v_cvt_pk_bf16_f32 v61, v90, v91
  v_exp_f32 v94, v94
  v_exp_f32 v95, v95
  v_cvt_pk_bf16_f32 v62, v92, v93
  v_exp_f32 v64, v64
  v_exp_f32 v65, v65
  v_cvt_pk_bf16_f32 v63, v94, v95
  v_exp_f32 v66, v66
  v_mfma_f32_32x32x16_bf16 v[80:95], v[32:35], v[20:23], 0
  v_exp_f32 v67, v67
  v_cvt_pk_bf16_f32 v56, v64, v65
  v_exp_f32 v68, v68
  v_mfma_f32_32x32x16_bf16 v[112:127], v[44:47], v[60:63], v[112:127]
  buffer_load_dwordx4 v[196:199], v4, s[24:27], s79 offen offset:1024 sc1
  v_exp_f32 v69, v69
  v_cvt_pk_bf16_f32 v57, v66, v67
  v_exp_f32 v70, v70
  v_exp_f32 v71, v71
  v_cvt_pk_bf16_f32 v58, v68, v69
  v_exp_f32 v72, v72
  v_mfma_f32_32x32x8bf16_1k v[80:95], v[38:39], v[26:27], v[80:95]
  s_mov_b64 exec, s[84:85]
  ds_read_b128 v[40:43], v130 offset:9216
  ds_read_b128 v[44:47], v130 offset:9856
  s_mov_b64 exec, -1
  v_exp_f32 v73, v73
  v_cvt_pk_bf16_f32 v59, v70, v71
  v_exp_f32 v74, v74
  v_exp_f32 v75, v75
  v_cvt_pk_bf16_f32 v60, v72, v73
  v_exp_f32 v76, v76
  v_mfma_f32_32x32x16_bf16 v[96:111], v[48:51], v[56:59], v[96:111]
  s_waitcnt lgkmcnt(2)
  v_exp_f32 v77, v77
  v_cvt_pk_bf16_f32 v61, v74, v75
  v_exp_f32 v78, v78
  v_exp_f32 v79, v79
  v_cvt_pk_bf16_f32 v62, v76, v77
  v_exp_f32 v80, v80
  v_exp_f32 v81, v81
  v_cvt_pk_bf16_f32 v63, v78, v79
  v_exp_f32 v82, v82
  v_mfma_f32_32x32x16_bf16 v[64:79], v[28:31], v[16:19], 0
  ds_read_b128 v[32:35], v128 offset:11520
  v_exp_f32 v83, v83
  v_cvt_pk_bf16_f32 v56, v80, v81
  v_exp_f32 v84, v84
  v_mfma_f32_32x32x16_bf16 v[96:111], v[52:55], v[60:63], v[96:111]
  v_exp_f32 v85, v85
  v_cvt_pk_bf16_f32 v57, v82, v83
  v_exp_f32 v86, v86
  v_exp_f32 v87, v87
  v_cvt_pk_bf16_f32 v58, v84, v85
  v_exp_f32 v88, v88
  v_mfma_f32_32x32x8bf16_1k v[64:79], v[36:37], v[24:25], v[64:79]
  ds_read_u16 v38, v129 offset:11520
  v_exp_f32 v89, v89
  v_cvt_pk_bf16_f32 v59, v86, v87
  v_exp_f32 v90, v90
  v_exp_f32 v91, v91
  v_cvt_pk_bf16_f32 v60, v88, v89
  v_exp_f32 v92, v92
  v_mfma_f32_32x32x16_bf16 v[112:127], v[48:51], v[56:59], v[112:127]
  s_waitcnt lgkmcnt(2)
  v_exp_f32 v93, v93
  v_cvt_pk_bf16_f32 v61, v90, v91
  v_exp_f32 v94, v94
  v_exp_f32 v95, v95
  v_cvt_pk_bf16_f32 v62, v92, v93
  v_exp_f32 v64, v64
  v_exp_f32 v65, v65
  v_cvt_pk_bf16_f32 v63, v94, v95
  v_exp_f32 v66, v66
  v_mfma_f32_32x32x16_bf16 v[80:95], v[28:31], v[20:23], 0
  v_exp_f32 v67, v67
  v_cvt_pk_bf16_f32 v56, v64, v65
  v_exp_f32 v68, v68
  v_mfma_f32_32x32x16_bf16 v[112:127], v[52:55], v[60:63], v[112:127]
  buffer_load_dwordx4 v[200:203], v4, s[24:27], s79 offen offset:2048 sc1
  v_exp_f32 v69, v69
  v_cvt_pk_bf16_f32 v57, v66, v67
  v_exp_f32 v70, v70
  v_exp_f32 v71, v71
  v_cvt_pk_bf16_f32 v58, v68, v69
  v_exp_f32 v72, v72
  v_mfma_f32_32x32x8bf16_1k v[80:95], v[36:37], v[26:27], v[80:95]
  s_mov_b64 exec, s[84:85]
  ds_read_b128 v[48:51], v130 offset:11520
  ds_read_b128 v[52:55], v130 offset:12160
  s_mov_b64 exec, -1
  v_exp_f32 v73, v73
  v_cvt_pk_bf16_f32 v59, v70, v71
  v_exp_f32 v74, v74
  v_exp_f32 v75, v75
  v_cvt_pk_bf16_f32 v60, v72, v73
  v_exp_f32 v76, v76
  v_mfma_f32_32x32x16_bf16 v[96:111], v[40:43], v[56:59], v[96:111]
  s_waitcnt lgkmcnt(2)
  v_exp_f32 v77, v77
  v_cvt_pk_bf16_f32 v61, v74, v75
  v_exp_f32 v78, v78
  v_exp_f32 v79, v79
  v_cvt_pk_bf16_f32 v62, v76, v77
  v_exp_f32 v80, v80
  v_exp_f32 v81, v81
  v_cvt_pk_bf16_f32 v63, v78, v79
  v_exp_f32 v82, v82
  v_mfma_f32_32x32x16_bf16 v[64:79], v[32:35], v[16:19], 0
  ds_read_b128 v[28:31], v128 offset:13824
  v_exp_f32 v83, v83
  v_cvt_pk_bf16_f32 v56, v80, v81
  v_exp_f32 v84, v84
  v_mfma_f32_32x32x16_bf16 v[96:111], v[44:47], v[60:63], v[96:111]
  v_exp_f32 v85, v85
  v_cvt_pk_bf16_f32 v57, v82, v83
  v_exp_f32 v86, v86
  v_exp_f32 v87, v87
  v_cvt_pk_bf16_f32 v58, v84, v85
  v_exp_f32 v88, v88
  v_mfma_f32_32x32x8bf16_1k v[64:79], v[38:39], v[24:25], v[64:79]
  ds_read_u16 v36, v129 offset:13824
  v_exp_f32 v89, v89
  v_cvt_pk_bf16_f32 v59, v86, v87
  v_exp_f32 v90, v90
  v_exp_f32 v91, v91
  v_cvt_pk_bf16_f32 v60, v88, v89
  v_exp_f32 v92, v92
  v_mfma_f32_32x32x16_bf16 v[112:127], v[40:43], v[56:59], v[112:127]
  s_waitcnt lgkmcnt(2)
  v_exp_f32 v93, v93
  v_cvt_pk_bf16_f32 v61, v90, v91
  v_exp_f32 v94, v94
  v_exp_f32 v95, v95
  v_cvt_pk_bf16_f32 v62, v92, v93
  v_exp_f32 v64, v64
  v_exp_f32 v65, v65
  v_cvt_pk_bf16_f32 v63, v94, v95
  v_exp_f32 v66, v66
  v_mfma_f32_32x32x16_bf16 v[80:95], v[32:35], v[20:23], 0
  v_exp_f32 v67, v67
  v_cvt_pk_bf16_f32 v56, v64, v65
  v_exp_f32 v68, v68
  v_mfma_f32_32x32x16_bf16 v[112:127], v[44:47], v[60:63], v[112:127]
  buffer_load_dwordx4 v[204:207], v4, s[24:27], s79 offen offset:3072 sc1
  s_add_u32 s79, s79, 4096
  v_exp_f32 v69, v69
  v_cvt_pk_bf16_f32 v57, v66, v67
  v_exp_f32 v70, v70
  v_exp_f32 v71, v71
  v_cvt_pk_bf16_f32 v58, v68, v69
  v_exp_f32 v72, v72
  v_mfma_f32_32x32x8bf16_1k v[80:95], v[38:39], v[26:27], v[80:95]
  s_mov_b64 exec, s[84:85]
  ds_read_b128 v[40:43], v130 offset:13824
  ds_read_b128 v[44:47], v130 offset:14464
  s_mov_b64 exec, -1
  v_exp_f32 v73, v73
  v_cvt_pk_bf16_f32 v59, v70, v71
  v_exp_f32 v74, v74
  v_exp_f32 v75, v75
  v_cvt_pk_bf16_f32 v60, v72, v73
  v_exp_f32 v76, v76
  v_mfma_f32_32x32x16_bf16 v[96:111], v[48:51], v[56:59], v[96:111]
  s_waitcnt lgkmcnt(2)
  v_exp_f32 v77, v77
  v_cvt_pk_bf16_f32 v61, v74, v75
  v_exp_f32 v78, v78
  v_exp_f32 v79, v79
  v_cvt_pk_bf16_f32 v62, v76, v77
  v_exp_f32 v80, v80
  v_exp_f32 v81, v81
  v_cvt_pk_bf16_f32 v63, v78, v79
  v_exp_f32 v82, v82
  v_mfma_f32_32x32x16_bf16 v[64:79], v[28:31], v[16:19], 0
  ds_read_b128 v[32:35], v128 offset:16128
  v_exp_f32 v83, v83
  v_cvt_pk_bf16_f32 v56, v80, v81
  v_exp_f32 v84, v84
  v_mfma_f32_32x32x16_bf16 v[96:111], v[52:55], v[60:63], v[96:111]
  v_exp_f32 v85, v85
  v_cvt_pk_bf16_f32 v57, v82, v83
  v_exp_f32 v86, v86
  v_exp_f32 v87, v87
  v_cvt_pk_bf16_f32 v58, v84, v85
  v_exp_f32 v88, v88
  v_mfma_f32_32x32x8bf16_1k v[64:79], v[36:37], v[24:25], v[64:79]
  ds_read_u16 v38, v129 offset:16128
  v_exp_f32 v89, v89
  v_cvt_pk_bf16_f32 v59, v86, v87
  v_exp_f32 v90, v90
  v_exp_f32 v91, v91
  v_cvt_pk_bf16_f32 v60, v88, v89
  v_exp_f32 v92, v92
  v_mfma_f32_32x32x16_bf16 v[112:127], v[48:51], v[56:59], v[112:127]
  s_waitcnt lgkmcnt(2)
  v_exp_f32 v93, v93
  v_cvt_pk_bf16_f32 v61, v90, v91
  v_exp_f32 v94, v94
  v_exp_f32 v95, v95
  v_cvt_pk_bf16_f32 v62, v92, v93
  v_exp_f32 v64, v64
  v_exp_f32 v65, v65
  v_cvt_pk_bf16_f32 v63, v94, v95
  v_exp_f32 v66, v66
  v_mfma_f32_32x32x16_bf16 v[80:95], v[28:31], v[20:23], 0
  v_exp_f32 v67, v67
  v_cvt_pk_bf16_f32 v56, v64, v65
  v_exp_f32 v68, v68
  v_mfma_f32_32x32x16_bf16 v[112:127], v[52:55], v[60:63], v[112:127]
  buffer_load_dwordx4 v[208:211], v4, s[24:27], s79 offen offset:0 sc1
  v_exp_f32 v69, v69
  v_cvt_pk_bf16_f32 v57, v66, v67
  v_exp_f32 v70, v70
  v_exp_f32 v71, v71
  v_cvt_pk_bf16_f32 v58, v68, v69
  v_exp_f32 v72, v72
  v_mfma_f32_32x32x8bf16_1k v[80:95], v[36:37], v[26:27], v[80:95]
  s_mov_b64 exec, s[84:85]
  ds_read_b128 v[48:51], v130 offset:16128
  ds_read_b128 v[52:55], v130 offset:16768
  s_mov_b64 exec, -1
  v_exp_f32 v73, v73
  v_cvt_pk_bf16_f32 v59, v70, v71
  v_exp_f32 v74, v74
  v_exp_f32 v75, v75
  v_cvt_pk_bf16_f32 v60, v72, v73
  v_exp_f32 v76, v76
  v_mfma_f32_32x32x16_bf16 v[96:111], v[40:43], v[56:59], v[96:111]
  s_waitcnt lgkmcnt(2)
  v_exp_f32 v77, v77
  v_cvt_pk_bf16_f32 v61, v74, v75
  v_exp_f32 v78, v78
  v_exp_f32 v79, v79
  v_cvt_pk_bf16_f32 v62, v76, v77
  v_exp_f32 v80, v80
  v_exp_f32 v81, v81
  v_cvt_pk_bf16_f32 v63, v78, v79
  v_exp_f32 v82, v82
  v_mfma_f32_32x32x16_bf16 v[64:79], v[32:35], v[16:19], 0
  ds_read_b128 v[28:31], v128 offset:18432
  v_exp_f32 v83, v83
  v_cvt_pk_bf16_f32 v56, v80, v81
  v_exp_f32 v84, v84
  v_mfma_f32_32x32x16_bf16 v[96:111], v[44:47], v[60:63], v[96:111]
  v_exp_f32 v85, v85
  v_cvt_pk_bf16_f32 v57, v82, v83
  v_exp_f32 v86, v86
  v_exp_f32 v87, v87
  v_cvt_pk_bf16_f32 v58, v84, v85
  v_exp_f32 v88, v88
  v_mfma_f32_32x32x8bf16_1k v[64:79], v[38:39], v[24:25], v[64:79]
  ds_read_u16 v36, v129 offset:18432
  v_exp_f32 v89, v89
  v_cvt_pk_bf16_f32 v59, v86, v87
  v_exp_f32 v90, v90
  v_exp_f32 v91, v91
  v_cvt_pk_bf16_f32 v60, v88, v89
  v_exp_f32 v92, v92
  v_mfma_f32_32x32x16_bf16 v[112:127], v[40:43], v[56:59], v[112:127]
  s_waitcnt lgkmcnt(2)
  v_exp_f32 v93, v93
  v_cvt_pk_bf16_f32 v61, v90, v91
  v_exp_f32 v94, v94
  v_exp_f32 v95, v95
  v_cvt_pk_bf16_f32 v62, v92, v93
  v_exp_f32 v64, v64
  v_exp_f32 v65, v65
  v_cvt_pk_bf16_f32 v63, v94, v95
  v_exp_f32 v66, v66
  v_mfma_f32_32x32x16_bf16 v[80:95], v[32:35], v[20:23], 0
  v_exp_f32 v67, v67
  v_cvt_pk_bf16_f32 v56, v64, v65
  v_exp_f32 v68, v68
  v_mfma_f32_32x32x16_bf16 v[112:127], v[44:47], v[60:63], v[112:127]
  buffer_load_dwordx4 v[212:215], v4, s[24:27], s79 offen offset:1024 sc1
  v_exp_f32 v69, v69
  v_cvt_pk_bf16_f32 v57, v66, v67
  v_exp_f32 v70, v70
  v_exp_f32 v71, v71
  v_cvt_pk_bf16_f32 v58, v68, v69
  v_exp_f32 v72, v72
  v_mfma_f32_32x32x8bf16_1k v[80:95], v[38:39], v[26:27], v[80:95]
  s_mov_b64 exec, s[84:85]
  ds_read_b128 v[40:43], v130 offset:18432
  ds_read_b128 v[44:47], v130 offset:19072
  s_mov_b64 exec, -1
  v_exp_f32 v73, v73
  v_cvt_pk_bf16_f32 v59, v70, v71
  v_exp_f32 v74, v74
  v_exp_f32 v75, v75
  v_cvt_pk_bf16_f32 v60, v72, v73
  v_exp_f32 v76, v76
  v_mfma_f32_32x32x16_bf16 v[96:111], v[48:51], v[56:59], v[96:111]
  s_waitcnt lgkmcnt(2)
  v_exp_f32 v77, v77
  v_cvt_pk_bf16_f32 v61, v74, v75
  v_exp_f32 v78, v78
  v_exp_f32 v79, v79
  v_cvt_pk_bf16_f32 v62, v76, v77
  v_exp_f32 v80, v80
  v_exp_f32 v81, v81
  v_cvt_pk_bf16_f32 v63, v78, v79
  v_exp_f32 v82, v82
  v_mfma_f32_32x32x16_bf16 v[64:79], v[28:31], v[16:19], 0
  ds_read_b128 v[32:35], v128 offset:20736
  v_exp_f32 v83, v83
  v_cvt_pk_bf16_f32 v56, v80, v81
  v_exp_f32 v84, v84
  v_mfma_f32_32x32x16_bf16 v[96:111], v[52:55], v[60:63], v[96:111]
  v_exp_f32 v85, v85
  v_cvt_pk_bf16_f32 v57, v82, v83
  v_exp_f32 v86, v86
  v_exp_f32 v87, v87
  v_cvt_pk_bf16_f32 v58, v84, v85
  v_exp_f32 v88, v88
  v_mfma_f32_32x32x8bf16_1k v[64:79], v[36:37], v[24:25], v[64:79]
  ds_read_u16 v38, v129 offset:20736
  v_exp_f32 v89, v89
  v_cvt_pk_bf16_f32 v59, v86, v87
  v_exp_f32 v90, v90
  v_exp_f32 v91, v91
  v_cvt_pk_bf16_f32 v60, v88, v89
  v_exp_f32 v92, v92
  v_mfma_f32_32x32x16_bf16 v[112:127], v[48:51], v[56:59], v[112:127]
  s_waitcnt lgkmcnt(2)
  v_exp_f32 v93, v93
  v_cvt_pk_bf16_f32 v61, v90, v91
  v_exp_f32 v94, v94
  v_exp_f32 v95, v95
  v_cvt_pk_bf16_f32 v62, v92, v93
  v_exp_f32 v64, v64
  v_exp_f32 v65, v65
  v_cvt_pk_bf16_f32 v63, v94, v95
  v_exp_f32 v66, v66
  v_mfma_f32_32x32x16_bf16 v[80:95], v[28:31], v[20:23], 0
  v_exp_f32 v67, v67
  v_cvt_pk_bf16_f32 v56, v64, v65
  v_exp_f32 v68, v68
  v_mfma_f32_32x32x16_bf16 v[112:127], v[52:55], v[60:63], v[112:127]
  buffer_load_dwordx4 v[216:219], v4, s[24:27], s79 offen offset:2048 sc1
  v_exp_f32 v69, v69
  v_cvt_pk_bf16_f32 v57, v66, v67
  v_exp_f32 v70, v70
  v_exp_f32 v71, v71
  v_cvt_pk_bf16_f32 v58, v68, v69
  v_exp_f32 v72, v72
  v_mfma_f32_32x32x8bf16_1k v[80:95], v[36:37], v[26:27], v[80:95]
  s_mov_b64 exec, s[84:85]
  ds_read_b128 v[48:51], v130 offset:20736
  ds_read_b128 v[52:55], v130 offset:21376
  s_mov_b64 exec, -1
  v_exp_f32 v73, v73
  v_cvt_pk_bf16_f32 v59, v70, v71
  v_exp_f32 v74, v74
  v_exp_f32 v75, v75
  v_cvt_pk_bf16_f32 v60, v72, v73
  v_exp_f32 v76, v76
  v_mfma_f32_32x32x16_bf16 v[96:111], v[40:43], v[56:59], v[96:111]
  s_waitcnt lgkmcnt(2)
  v_exp_f32 v77, v77
  v_cvt_pk_bf16_f32 v61, v74, v75
  v_exp_f32 v78, v78
  v_exp_f32 v79, v79
  v_cvt_pk_bf16_f32 v62, v76, v77
  v_exp_f32 v80, v80
  v_exp_f32 v81, v81
  v_cvt_pk_bf16_f32 v63, v78, v79
  v_exp_f32 v82, v82
  v_mfma_f32_32x32x16_bf16 v[64:79], v[32:35], v[16:19], 0
  ds_read_b128 v[28:31], v128 offset:23040
  v_exp_f32 v83, v83
  v_cvt_pk_bf16_f32 v56, v80, v81
  v_exp_f32 v84, v84
  v_mfma_f32_32x32x16_bf16 v[96:111], v[44:47], v[60:63], v[96:111]
  v_exp_f32 v85, v85
  v_cvt_pk_bf16_f32 v57, v82, v83
  v_exp_f32 v86, v86
  v_exp_f32 v87, v87
  v_cvt_pk_bf16_f32 v58, v84, v85
  v_exp_f32 v88, v88
  v_mfma_f32_32x32x8bf16_1k v[64:79], v[38:39], v[24:25], v[64:79]
  ds_read_u16 v36, v129 offset:23040
  v_exp_f32 v89, v89
  v_cvt_pk_bf16_f32 v59, v86, v87
  v_exp_f32 v90, v90
  v_exp_f32 v91, v91
  v_cvt_pk_bf16_f32 v60, v88, v89
  v_exp_f32 v92, v92
  v_mfma_f32_32x32x16_bf16 v[112:127], v[40:43], v[56:59], v[112:127]
  s_waitcnt lgkmcnt(2)
  v_exp_f32 v93, v93
  v_cvt_pk_bf16_f32 v61, v90, v91
  v_exp_f32 v94, v94
  v_exp_f32 v95, v95
  v_cvt_pk_bf16_f32 v62, v92, v93
  v_exp_f32 v64, v64
  v_exp_f32 v65, v65
  v_cvt_pk_bf16_f32 v63, v94, v95
  v_exp_f32 v66, v66
  v_mfma_f32_32x32x16_bf16 v[80:95], v[32:35], v[20:23], 0
  v_exp_f32 v67, v67
  v_cvt_pk_bf16_f32 v56, v64, v65
  v_exp_f32 v68, v68
  v_mfma_f32_32x32x16_bf16 v[112:127], v[44:47], v[60:63], v[112:127]
  buffer_load_dwordx4 v[220:223], v4, s[24:27], s79 offen offset:3072 sc1
  s_add_u32 s79, s79, 4096
  v_exp_f32 v69, v69
  v_cvt_pk_bf16_f32 v57, v66, v67
  v_exp_f32 v70, v70
  v_exp_f32 v71, v71
  v_cvt_pk_bf16_f32 v58, v68, v69
  v_exp_f32 v72, v72
  v_mfma_f32_32x32x8bf16_1k v[80:95], v[38:39], v[26:27], v[80:95]
  s_mov_b64 exec, s[84:85]
  ds_read_b128 v[40:43], v130 offset:23040
  ds_read_b128 v[44:47], v130 offset:23680
  s_mov_b64 exec, -1
  v_exp_f32 v73, v73
  v_cvt_pk_bf16_f32 v59, v70, v71
  v_exp_f32 v74, v74
  v_exp_f32 v75, v75
  v_cvt_pk_bf16_f32 v60, v72, v73
  v_exp_f32 v76, v76
  v_mfma_f32_32x32x16_bf16 v[96:111], v[48:51], v[56:59], v[96:111]
  s_waitcnt lgkmcnt(2)
  v_exp_f32 v77, v77
  v_cvt_pk_bf16_f32 v61, v74, v75
  v_exp_f32 v78, v78
  v_exp_f32 v79, v79
  v_cvt_pk_bf16_f32 v62, v76, v77
  s_setprio 2
  v_exp_f32 v80, v80
  v_exp_f32 v81, v81
  v_cvt_pk_bf16_f32 v63, v78, v79
  v_exp_f32 v82, v82
  v_mfma_f32_32x32x16_bf16 v[64:79], v[28:31], v[16:19], 0
  ds_read_b128 v[32:35], v128 offset:25344
  v_exp_f32 v83, v83
  v_cvt_pk_bf16_f32 v56, v80, v81
  v_exp_f32 v84, v84
  v_mfma_f32_32x32x16_bf16 v[96:111], v[52:55], v[60:63], v[96:111]
  v_exp_f32 v85, v85
  v_cvt_pk_bf16_f32 v57, v82, v83
  v_exp_f32 v86, v86
  v_exp_f32 v87, v87
  v_cvt_pk_bf16_f32 v58, v84, v85
  v_exp_f32 v88, v88
  v_mfma_f32_32x32x8bf16_1k v[64:79], v[36:37], v[24:25], v[64:79]
  ds_read_u16 v38, v129 offset:25344
  v_exp_f32 v89, v89
  v_cvt_pk_bf16_f32 v59, v86, v87
  v_exp_f32 v90, v90
  v_exp_f32 v91, v91
  v_cvt_pk_bf16_f32 v60, v88, v89
  v_exp_f32 v92, v92
  v_mfma_f32_32x32x16_bf16 v[112:127], v[48:51], v[56:59], v[112:127]
  s_waitcnt lgkmcnt(2)
  v_exp_f32 v93, v93
  v_cvt_pk_bf16_f32 v61, v90, v91
  v_exp_f32 v94, v94
  v_exp_f32 v95, v95
  v_cvt_pk_bf16_f32 v62, v92, v93
  v_exp_f32 v64, v64
  v_exp_f32 v65, v65
  v_cvt_pk_bf16_f32 v63, v94, v95
  v_exp_f32 v66, v66
  v_mfma_f32_32x32x16_bf16 v[80:95], v[28:31], v[20:23], 0
  v_exp_f32 v67, v67
  v_cvt_pk_bf16_f32 v56, v64, v65
  v_exp_f32 v68, v68
  v_mfma_f32_32x32x16_bf16 v[112:127], v[52:55], v[60:63], v[112:127]
  buffer_load_dwordx4 v[224:227], v4, s[24:27], s79 offen offset:0 sc1
  v_exp_f32 v69, v69
  v_cvt_pk_bf16_f32 v57, v66, v67
  v_exp_f32 v70, v70
  v_exp_f32 v71, v71
  v_cvt_pk_bf16_f32 v58, v68, v69
  v_exp_f32 v72, v72
  v_mfma_f32_32x32x8bf16_1k v[80:95], v[36:37], v[26:27], v[80:95]
  s_mov_b64 exec, s[84:85]
  ds_read_b128 v[48:51], v130 offset:25344
  ds_read_b128 v[52:55], v130 offset:25984
  s_mov_b64 exec, -1
  v_exp_f32 v73, v73
  v_cvt_pk_bf16_f32 v59, v70, v71
  v_exp_f32 v74, v74
  v_exp_f32 v75, v75
  v_cvt_pk_bf16_f32 v60, v72, v73
  v_exp_f32 v76, v76
  v_mfma_f32_32x32x16_bf16 v[96:111], v[40:43], v[56:59], v[96:111]
  s_waitcnt lgkmcnt(2)
  v_exp_f32 v77, v77
  v_cvt_pk_bf16_f32 v61, v74, v75
  v_exp_f32 v78, v78
  v_exp_f32 v79, v79
  v_cvt_pk_bf16_f32 v62, v76, v77
  v_exp_f32 v80, v80
  v_exp_f32 v81, v81
  v_cvt_pk_bf16_f32 v63, v78, v79
  v_exp_f32 v82, v82
  v_mfma_f32_32x32x16_bf16 v[64:79], v[32:35], v[16:19], 0
  ds_read_b128 v[28:31], v128 offset:27648
  v_exp_f32 v83, v83
  v_cvt_pk_bf16_f32 v56, v80, v81
  v_exp_f32 v84, v84
  v_mfma_f32_32x32x16_bf16 v[96:111], v[44:47], v[60:63], v[96:111]
  v_exp_f32 v85, v85
  v_cvt_pk_bf16_f32 v57, v82, v83
  v_exp_f32 v86, v86
  v_exp_f32 v87, v87
  v_cvt_pk_bf16_f32 v58, v84, v85
  v_exp_f32 v88, v88
  v_mfma_f32_32x32x8bf16_1k v[64:79], v[38:39], v[24:25], v[64:79]
  ds_read_u16 v36, v129 offset:27648
  v_exp_f32 v89, v89
  v_cvt_pk_bf16_f32 v59, v86, v87
  v_exp_f32 v90, v90
  v_exp_f32 v91, v91
  v_cvt_pk_bf16_f32 v60, v88, v89
  v_exp_f32 v92, v92
  v_mfma_f32_32x32x16_bf16 v[112:127], v[40:43], v[56:59], v[112:127]
  s_waitcnt lgkmcnt(2)
  v_exp_f32 v93, v93
  v_cvt_pk_bf16_f32 v61, v90, v91
  v_exp_f32 v94, v94
  v_exp_f32 v95, v95
  v_cvt_pk_bf16_f32 v62, v92, v93
  v_exp_f32 v64, v64
  v_exp_f32 v65, v65
  v_cvt_pk_bf16_f32 v63, v94, v95
  v_exp_f32 v66, v66
  v_mfma_f32_32x32x16_bf16 v[80:95], v[32:35], v[20:23], 0
  v_exp_f32 v67, v67
  v_cvt_pk_bf16_f32 v56, v64, v65
  v_exp_f32 v68, v68
  v_mfma_f32_32x32x16_bf16 v[112:127], v[44:47], v[60:63], v[112:127]
  buffer_load_dwordx4 v[228:231], v4, s[24:27], s79 offen offset:1024 sc1
  v_exp_f32 v69, v69
  v_cvt_pk_bf16_f32 v57, v66, v67
  v_exp_f32 v70, v70
  v_exp_f32 v71, v71
  v_cvt_pk_bf16_f32 v58, v68, v69
  v_exp_f32 v72, v72
  v_mfma_f32_32x32x8bf16_1k v[80:95], v[38:39], v[26:27], v[80:95]
  s_mov_b64 exec, s[84:85]
  ds_read_b128 v[40:43], v130 offset:27648
  ds_read_b128 v[44:47], v130 offset:28288
  s_mov_b64 exec, -1
  v_exp_f32 v73, v73
  v_cvt_pk_bf16_f32 v59, v70, v71
  v_exp_f32 v74, v74
  v_exp_f32 v75, v75
  v_cvt_pk_bf16_f32 v60, v72, v73
  v_exp_f32 v76, v76
  v_mfma_f32_32x32x16_bf16 v[96:111], v[48:51], v[56:59], v[96:111]
  s_waitcnt lgkmcnt(2)
  v_exp_f32 v77, v77
  v_cvt_pk_bf16_f32 v61, v74, v75
  v_exp_f32 v78, v78
  v_exp_f32 v79, v79
  v_cvt_pk_bf16_f32 v62, v76, v77
  v_exp_f32 v80, v80
  v_exp_f32 v81, v81
  v_cvt_pk_bf16_f32 v63, v78, v79
  v_exp_f32 v82, v82
  v_mfma_f32_32x32x16_bf16 v[64:79], v[28:31], v[16:19], 0
  ds_read_b128 v[32:35], v128 offset:29952
  v_exp_f32 v83, v83
  v_cvt_pk_bf16_f32 v56, v80, v81
  v_exp_f32 v84, v84
  v_mfma_f32_32x32x16_bf16 v[96:111], v[52:55], v[60:63], v[96:111]
  v_exp_f32 v85, v85
  v_cvt_pk_bf16_f32 v57, v82, v83
  v_exp_f32 v86, v86
  v_exp_f32 v87, v87
  v_cvt_pk_bf16_f32 v58, v84, v85
  v_exp_f32 v88, v88
  v_mfma_f32_32x32x8bf16_1k v[64:79], v[36:37], v[24:25], v[64:79]
  ds_read_u16 v38, v129 offset:29952
  v_exp_f32 v89, v89
  v_cvt_pk_bf16_f32 v59, v86, v87
  v_exp_f32 v90, v90
  v_exp_f32 v91, v91
  v_cvt_pk_bf16_f32 v60, v88, v89
  v_exp_f32 v92, v92
  v_mfma_f32_32x32x16_bf16 v[112:127], v[48:51], v[56:59], v[112:127]
  s_waitcnt lgkmcnt(2)
  v_exp_f32 v93, v93
  v_cvt_pk_bf16_f32 v61, v90, v91
  v_exp_f32 v94, v94
  v_exp_f32 v95, v95
  v_cvt_pk_bf16_f32 v62, v92, v93
  v_exp_f32 v64, v64
  v_exp_f32 v65, v65
  v_cvt_pk_bf16_f32 v63, v94, v95
  v_exp_f32 v66, v66
  v_mfma_f32_32x32x16_bf16 v[80:95], v[28:31], v[20:23], 0
  v_exp_f32 v67, v67
  v_cvt_pk_bf16_f32 v56, v64, v65
  v_exp_f32 v68, v68
  v_mfma_f32_32x32x16_bf16 v[112:127], v[52:55], v[60:63], v[112:127]
  buffer_load_dwordx4 v[232:235], v4, s[24:27], s80 offen offset:0 sc1
  v_exp_f32 v69, v69
  v_cvt_pk_bf16_f32 v57, v66, v67
  v_exp_f32 v70, v70
  v_exp_f32 v71, v71
  v_cvt_pk_bf16_f32 v58, v68, v69
  v_exp_f32 v72, v72
  v_mfma_f32_32x32x8bf16_1k v[80:95], v[36:37], v[26:27], v[80:95]
  s_mov_b64 exec, s[84:85]
  ds_read_b128 v[48:51], v130 offset:29952
  ds_read_b128 v[52:55], v130 offset:30592
  s_mov_b64 exec, -1
  v_exp_f32 v73, v73
  v_cvt_pk_bf16_f32 v59, v70, v71
  v_exp_f32 v74, v74
  v_exp_f32 v75, v75
  v_cvt_pk_bf16_f32 v60, v72, v73
  v_exp_f32 v76, v76
  v_mfma_f32_32x32x16_bf16 v[96:111], v[40:43], v[56:59], v[96:111]
  s_waitcnt lgkmcnt(2)
  v_exp_f32 v77, v77
  v_cvt_pk_bf16_f32 v61, v74, v75
  v_exp_f32 v78, v78
  v_exp_f32 v79, v79
  v_cvt_pk_bf16_f32 v62, v76, v77
  v_exp_f32 v80, v80
  v_exp_f32 v81, v81
  v_cvt_pk_bf16_f32 v63, v78, v79
  v_exp_f32 v82, v82
  v_mfma_f32_32x32x16_bf16 v[64:79], v[32:35], v[16:19], 0
  ds_read_b128 v[28:31], v128 offset:32256
  v_exp_f32 v83, v83
  v_cvt_pk_bf16_f32 v56, v80, v81
  v_exp_f32 v84, v84
  v_mfma_f32_32x32x16_bf16 v[96:111], v[44:47], v[60:63], v[96:111]
  v_exp_f32 v85, v85
  v_cvt_pk_bf16_f32 v57, v82, v83
  v_exp_f32 v86, v86
  v_exp_f32 v87, v87
  v_cvt_pk_bf16_f32 v58, v84, v85
  v_exp_f32 v88, v88
  v_mfma_f32_32x32x8bf16_1k v[64:79], v[38:39], v[24:25], v[64:79]
  ds_read_u16 v36, v129 offset:32256
  v_exp_f32 v89, v89
  v_cvt_pk_bf16_f32 v59, v86, v87
  v_exp_f32 v90, v90
  v_exp_f32 v91, v91
  v_cvt_pk_bf16_f32 v60, v88, v89
  v_exp_f32 v92, v92
  v_mfma_f32_32x32x16_bf16 v[112:127], v[40:43], v[56:59], v[112:127]
  s_waitcnt lgkmcnt(2)
  v_exp_f32 v93, v93
  v_cvt_pk_bf16_f32 v61, v90, v91
  v_exp_f32 v94, v94
  v_exp_f32 v95, v95
  v_cvt_pk_bf16_f32 v62, v92, v93
  v_exp_f32 v64, v64
  v_exp_f32 v65, v65
  v_cvt_pk_bf16_f32 v63, v94, v95
  v_exp_f32 v66, v66
  v_mfma_f32_32x32x16_bf16 v[80:95], v[32:35], v[20:23], 0
  v_exp_f32 v67, v67
  v_cvt_pk_bf16_f32 v56, v64, v65
  v_exp_f32 v68, v68
  v_mfma_f32_32x32x16_bf16 v[112:127], v[44:47], v[60:63], v[112:127]
  buffer_load_dwordx4 v[236:239], v4, s[24:27], s80 offen offset:1024 sc1
  v_exp_f32 v69, v69
  v_cvt_pk_bf16_f32 v57, v66, v67
  v_exp_f32 v70, v70
  v_exp_f32 v71, v71
  v_cvt_pk_bf16_f32 v58, v68, v69
  v_exp_f32 v72, v72
  v_mfma_f32_32x32x8bf16_1k v[80:95], v[38:39], v[26:27], v[80:95]
  s_mov_b64 exec, s[84:85]
  ds_read_b128 v[40:43], v130 offset:32256
  ds_read_b128 v[44:47], v130 offset:32896
  s_mov_b64 exec, -1
  v_exp_f32 v73, v73
  v_cvt_pk_bf16_f32 v59, v70, v71
  v_exp_f32 v74, v74
  v_exp_f32 v75, v75
  v_cvt_pk_bf16_f32 v60, v72, v73
  v_exp_f32 v76, v76
  v_mfma_f32_32x32x16_bf16 v[96:111], v[48:51], v[56:59], v[96:111]
  s_waitcnt lgkmcnt(2)
  v_exp_f32 v77, v77
  v_cvt_pk_bf16_f32 v61, v74, v75
  v_exp_f32 v78, v78
  v_exp_f32 v79, v79
  v_cvt_pk_bf16_f32 v62, v76, v77
  s_setprio 1
  v_exp_f32 v80, v80
  v_exp_f32 v81, v81
  v_cvt_pk_bf16_f32 v63, v78, v79
  v_exp_f32 v82, v82
  v_mfma_f32_32x32x16_bf16 v[64:79], v[28:31], v[16:19], 0
  ds_read_b128 v[32:35], v128 offset:34560
  v_exp_f32 v83, v83
  v_cvt_pk_bf16_f32 v56, v80, v81
  v_exp_f32 v84, v84
  v_mfma_f32_32x32x16_bf16 v[96:111], v[52:55], v[60:63], v[96:111]
  v_exp_f32 v85, v85
  v_cvt_pk_bf16_f32 v57, v82, v83
  v_exp_f32 v86, v86
  v_exp_f32 v87, v87
  v_cvt_pk_bf16_f32 v58, v84, v85
  v_exp_f32 v88, v88
  v_mfma_f32_32x32x8bf16_1k v[64:79], v[36:37], v[24:25], v[64:79]
  ds_read_u16 v38, v129 offset:34560
  v_exp_f32 v89, v89
  v_cvt_pk_bf16_f32 v59, v86, v87
  v_exp_f32 v90, v90
  v_exp_f32 v91, v91
  v_cvt_pk_bf16_f32 v60, v88, v89
  v_exp_f32 v92, v92
  v_mfma_f32_32x32x16_bf16 v[112:127], v[48:51], v[56:59], v[112:127]
  s_waitcnt lgkmcnt(2)
  v_exp_f32 v93, v93
  v_cvt_pk_bf16_f32 v61, v90, v91
  v_exp_f32 v94, v94
  v_exp_f32 v95, v95
  v_cvt_pk_bf16_f32 v62, v92, v93
  v_exp_f32 v64, v64
  v_exp_f32 v65, v65
  v_cvt_pk_bf16_f32 v63, v94, v95
  v_exp_f32 v66, v66
  v_mfma_f32_32x32x16_bf16 v[80:95], v[28:31], v[20:23], 0
  v_exp_f32 v67, v67
  v_cvt_pk_bf16_f32 v56, v64, v65
  v_exp_f32 v68, v68
  v_mfma_f32_32x32x16_bf16 v[112:127], v[52:55], v[60:63], v[112:127]
  buffer_load_dwordx4 v[240:243], v4, s[24:27], s81 offen sc1
  v_exp_f32 v69, v69
  v_cvt_pk_bf16_f32 v57, v66, v67
  v_exp_f32 v70, v70
  v_exp_f32 v71, v71
  v_cvt_pk_bf16_f32 v58, v68, v69
  v_exp_f32 v72, v72
  v_mfma_f32_32x32x8bf16_1k v[80:95], v[36:37], v[26:27], v[80:95]
  s_mov_b64 exec, s[84:85]
  ds_read_b128 v[48:51], v130 offset:34560
  ds_read_b128 v[52:55], v130 offset:35200
  s_mov_b64 exec, -1
  v_exp_f32 v73, v73
  v_cvt_pk_bf16_f32 v59, v70, v71
  v_exp_f32 v74, v74
  v_exp_f32 v75, v75
  v_cvt_pk_bf16_f32 v60, v72, v73
  v_exp_f32 v76, v76
  v_mfma_f32_32x32x16_bf16 v[96:111], v[40:43], v[56:59], v[96:111]
  s_waitcnt lgkmcnt(2)
  v_exp_f32 v77, v77
  v_cvt_pk_bf16_f32 v61, v74, v75
  v_exp_f32 v78, v78
  v_exp_f32 v79, v79
  v_cvt_pk_bf16_f32 v62, v76, v77
  v_exp_f32 v80, v80
  v_exp_f32 v81, v81
  v_cvt_pk_bf16_f32 v63, v78, v79
  v_exp_f32 v82, v82
  v_mfma_f32_32x32x16_bf16 v[64:79], v[32:35], v[16:19], 0
  v_exp_f32 v83, v83
  v_cvt_pk_bf16_f32 v56, v80, v81
  v_exp_f32 v84, v84
  v_mfma_f32_32x32x16_bf16 v[96:111], v[44:47], v[60:63], v[96:111]
  v_exp_f32 v85, v85
  v_cvt_pk_bf16_f32 v57, v82, v83
  v_exp_f32 v86, v86
  v_exp_f32 v87, v87
  v_cvt_pk_bf16_f32 v58, v84, v85
  v_exp_f32 v88, v88
  v_mfma_f32_32x32x8bf16_1k v[64:79], v[38:39], v[24:25], v[64:79]
  v_exp_f32 v89, v89
  v_cvt_pk_bf16_f32 v59, v86, v87
  v_exp_f32 v90, v90
  v_exp_f32 v91, v91
  v_cvt_pk_bf16_f32 v60, v88, v89
  v_exp_f32 v92, v92
  v_mfma_f32_32x32x16_bf16 v[112:127], v[40:43], v[56:59], v[112:127]
  v_exp_f32 v93, v93
  v_cvt_pk_bf16_f32 v61, v90, v91
  v_exp_f32 v94, v94
  v_exp_f32 v95, v95
  v_cvt_pk_bf16_f32 v62, v92, v93
  s_setprio 0
  v_exp_f32 v64, v64
  v_exp_f32 v65, v65
  v_cvt_pk_bf16_f32 v63, v94, v95
  v_exp_f32 v66, v66
  v_mfma_f32_32x32x16_bf16 v[80:95], v[32:35], v[20:23], 0
  v_exp_f32 v67, v67
  v_cvt_pk_bf16_f32 v56, v64, v65
  v_exp_f32 v68, v68
  v_mfma_f32_32x32x16_bf16 v[112:127], v[44:47], v[60:63], v[112:127]
  v_exp_f32 v69, v69
  v_cvt_pk_bf16_f32 v57, v66, v67
  v_exp_f32 v70, v70
  v_exp_f32 v71, v71
  v_cvt_pk_bf16_f32 v58, v68, v69
  v_exp_f32 v72, v72
  v_mfma_f32_32x32x8bf16_1k v[80:95], v[38:39], v[26:27], v[80:95]
  v_exp_f32 v73, v73
  v_cvt_pk_bf16_f32 v59, v70, v71
  v_exp_f32 v74, v74
  v_exp_f32 v75, v75
  v_cvt_pk_bf16_f32 v60, v72, v73
  v_exp_f32 v76, v76
  s_waitcnt lgkmcnt(1)
  v_mfma_f32_32x32x16_bf16 v[96:111], v[48:51], v[56:59], v[96:111]
  v_exp_f32 v77, v77
  v_cvt_pk_bf16_f32 v61, v74, v75
  v_exp_f32 v78, v78
  v_exp_f32 v79, v79
  v_cvt_pk_bf16_f32 v62, v76, v77
  v_exp_f32 v80, v80
  v_exp_f32 v81, v81
  v_cvt_pk_bf16_f32 v63, v78, v79
  v_exp_f32 v82, v82
  v_exp_f32 v83, v83
  v_cvt_pk_bf16_f32 v56, v80, v81
  v_exp_f32 v84, v84
  s_waitcnt lgkmcnt(0)
  v_mfma_f32_32x32x16_bf16 v[96:111], v[52:55], v[60:63], v[96:111]
  v_exp_f32 v85, v85
  v_cvt_pk_bf16_f32 v57, v82, v83
  v_exp_f32 v86, v86
  v_exp_f32 v87, v87
  v_cvt_pk_bf16_f32 v58, v84, v85
  v_exp_f32 v88, v88
  v_exp_f32 v89, v89
  v_cvt_pk_bf16_f32 v59, v86, v87
  v_exp_f32 v90, v90
  v_exp_f32 v91, v91
  v_cvt_pk_bf16_f32 v60, v88, v89
  v_exp_f32 v92, v92
  v_mfma_f32_32x32x16_bf16 v[112:127], v[48:51], v[56:59], v[112:127]
  v_exp_f32 v93, v93
  v_cvt_pk_bf16_f32 v61, v90, v91
  v_exp_f32 v94, v94
  v_exp_f32 v95, v95
  v_cvt_pk_bf16_f32 v62, v92, v93
f_kernel_lend65:
  v_cvt_pk_bf16_f32 v63, v94, v95
  s_nop 1
  v_mfma_f32_32x32x16_bf16 v[112:127], v[52:55], v[60:63], v[112:127]
  s_mov_b32 s62, 0x53800000
  s_nop 10
  v_add_f32 v57, v106, v122
  v_cmp_nlt_f32 vcc, v57, s62
  s_nop 4
  s_cbranch_vccz f_kernel_ok66
  s_cmp_lg_u32 s76, 0
  s_cbranch_scc1 f_kernel_ok66
  s_mov_b32 s75, 71424
  s_mov_b32 s76, 99
  v_mov_b32 v96, 0
  v_mov_b32 v97, 0
  v_mov_b32 v98, 0
  v_mov_b32 v99, 0
  v_mov_b32 v100, 0
  v_mov_b32 v101, 0
  v_mov_b32 v102, 0
  v_mov_b32 v103, 0
  v_mov_b32 v104, 0
  v_mov_b32 v105, 0
  v_mov_b32 v106, 0
  v_mov_b32 v107, 0
  v_mov_b32 v108, 0
  v_mov_b32 v109, 0
  v_mov_b32 v110, 0
  v_mov_b32 v111, 0
  v_mov_b32 v112, 0
  v_mov_b32 v113, 0
  v_mov_b32 v114, 0
  v_mov_b32 v115, 0
  v_mov_b32 v116, 0
  v_mov_b32 v117, 0
  v_mov_b32 v118, 0
  v_mov_b32 v119, 0
  v_mov_b32 v120, 0
  v_mov_b32 v121, 0
  v_mov_b32 v122, 0
  v_mov_b32 v123, 0
  v_mov_b32 v124, 0
  v_mov_b32 v125, 0
  v_mov_b32 v126, 0
  v_mov_b32 v127, 0
  v_mov_b32 v60, 0
  v_mov_b32 v52, v140
  v_mov_b32 v61, 0
  v_mov_b32 v53, v140
  v_mov_b32 v62, 0
  v_mov_b32 v54, v140
  v_mov_b32 v63, 0
  v_mov_b32 v55, v140
  v_mov_b32 v25, 0
  v_mov_b32 v134, 0xff800000
  v_mov_b32 v27, 0
  v_mov_b32 v135, 0xff800000
f_kernel_mp67:
  v_add_u32 v56, s75, v131
  v_add_u32 v57, s75, v132
  ds_read_b128 v[28:31], v56 offset:0
  ds_read_u16 v36, v57 offset:0
  s_waitcnt lgkmcnt(1)
  v_mfma_f32_32x32x16_bf16 v[64:79], v[28:31], v[16:19], 0
  v_mfma_f32_32x32x16_bf16 v[80:95], v[28:31], v[20:23], 0
  s_waitcnt lgkmcnt(0)
  v_mfma_f32_32x32x8bf16_1k v[64:79], v[36:37], v[24:25], v[64:79]
  v_mfma_f32_32x32x8bf16_1k v[80:95], v[36:37], v[26:27], v[80:95]
  s_nop 10
  v_max3_f32 v134, v64, v65, v134
  v_max3_f32 v134, v66, v67, v134
  v_max3_f32 v134, v68, v69, v134
  v_max3_f32 v134, v70, v71, v134
  v_max3_f32 v134, v72, v73, v134
  v_max3_f32 v134, v74, v75, v134
  v_max3_f32 v134, v76, v77, v134
  v_max3_f32 v134, v78, v79, v134
  v_max3_f32 v135, v80, v81, v135
  v_max3_f32 v135, v82, v83, v135
  v_max3_f32 v135, v84, v85, v135
  v_max3_f32 v135, v86, v87, v135
  v_max3_f32 v135, v88, v89, v135
  v_max3_f32 v135, v90, v91, v135
  v_max3_f32 v135, v92, v93, v135
  v_max3_f32 v135, v94, v95, v135
  s_sub_u32 s75, s75, 2304
  s_cbranch_scc0 f_kernel_mp67
  s_mov_b64 exec, s[84:85]
  ds_read_b128 v[40:43], v133 offset:0
  ds_read_b128 v[44:47], v133 offset:640
  s_mov_b64 exec, -1
  ds_read_b128 v[32:35], v131 offset:2304
  ds_read_u16 v38, v132 offset:2304
  v_permlane32_swap_b32 v134, v135
  v_max_f32 v134, v134, v135
  v_xor_b32 v56, 0x80000000, v134
  v_and_b32 v57, s60, v56
  v_sub_f32 v56, v56, v57
  v_and_b32 v58, s60, v56
  v_sub_f32 v56, v56, v58
  v_lshrrev_b32 v57, 16, v57
  v_or_b32 v25, v57, v58
  v_lshrrev_b32 v27, 16, v56
  v_mov_b32 v135, v134
  s_nop 0
  v_permlane32_swap_b32 v25, v27
  v_permlane32_swap_b32 v134, v135
  v_mfma_f32_32x32x16_bf16 v[64:79], v[28:31], v[16:19], 0
  v_mfma_f32_32x32x8bf16_1k v[64:79], v[36:37], v[24:25], v[64:79]
  v_mov_b32 v94, 0
  v_mov_b32 v95, 0
  s_waitcnt lgkmcnt(0)
  v_mov_b32 v128, v131
  v_mov_b32 v129, v132
  v_mov_b32 v130, v133
  s_mov_b32 s78, 0
f_kernel_loop68:
  s_nop 4
  v_exp_f32 v64, v64
  v_exp_f32 v65, v65
  v_cvt_pk_bf16_f32 v63, v94, v95
  v_exp_f32 v66, v66
  v_mfma_f32_32x32x16_bf16 v[80:95], v[28:31], v[20:23], 0
  v_exp_f32 v67, v67
  v_cvt_pk_bf16_f32 v56, v64, v65
  v_exp_f32 v68, v68
  v_mfma_f32_32x32x16_bf16 v[112:127], v[52:55], v[60:63], v[112:127]
  v_exp_f32 v69, v69
  v_cvt_pk_bf16_f32 v57, v66, v67
  v_exp_f32 v70, v70
  v_exp_f32 v71, v71
  v_cvt_pk_bf16_f32 v58, v68, v69
  v_exp_f32 v72, v72
  v_mfma_f32_32x32x8bf16_1k v[80:95], v[36:37], v[26:27], v[80:95]
  s_mov_b64 exec, s[84:85]
  ds_read_b128 v[48:51], v130 offset:2304
  ds_read_b128 v[52:55], v130 offset:2944
  s_mov_b64 exec, -1
  v_exp_f32 v73, v73
  v_cvt_pk_bf16_f32 v59, v70, v71
  v_exp_f32 v74, v74
  v_exp_f32 v75, v75
  v_cvt_pk_bf16_f32 v60, v72, v73
  v_exp_f32 v76, v76
  v_mfma_f32_32x32x16_bf16 v[96:111], v[40:43], v[56:59], v[96:111]
  s_waitcnt lgkmcnt(2)
  v_exp_f32 v77, v77
  v_cvt_pk_bf16_f32 v61, v74, v75
  v_exp_f32 v78, v78
  v_exp_f32 v79, v79
  v_cvt_pk_bf16_f32 v62, v76, v77
  v_exp_f32 v80, v80
  v_exp_f32 v81, v81
  v_cvt_pk_bf16_f32 v63, v78, v79
  v_exp_f32 v82, v82
  v_mfma_f32_32x32x16_bf16 v[64:79], v[32:35], v[16:19], 0
  ds_read_b128 v[28:31], v128 offset:4608
  v_exp_f32 v83, v83
  v_cvt_pk_bf16_f32 v56, v80, v81
  v_exp_f32 v84, v84
  v_mfma_f32_32x32x16_bf16 v[96:111], v[44:47], v[60:63], v[96:111]
  v_exp_f32 v85, v85
  v_cvt_pk_bf16_f32 v57, v82, v83
  v_exp_f32 v86, v86
  v_exp_f32 v87, v87
  v_cvt_pk_bf16_f32 v58, v84, v85
  v_exp_f32 v88, v88
  v_mfma_f32_32x32x8bf16_1k v[64:79], v[38:39], v[24:25], v[64:79]
  ds_read_u16 v36, v129 offset:4608
  v_exp_f32 v89, v89
  v_cvt_pk_bf16_f32 v59, v86, v87
  v_exp_f32 v90, v90
  v_exp_f32 v91, v91
  v_cvt_pk_bf16_f32 v60, v88, v89
  v_exp_f32 v92, v92
  v_mfma_f32_32x32x16_bf16 v[112:127], v[40:43], v[56:59], v[112:127]
  s_waitcnt lgkmcnt(2)
  v_exp_f32 v93, v93
  v_cvt_pk_bf16_f32 v61, v90, v91
  v_exp_f32 v94, v94
  v_exp_f32 v95, v95
  v_cvt_pk_bf16_f32 v62, v92, v93
  v_exp_f32 v64, v64
  v_exp_f32 v65, v65
  v_cvt_pk_bf16_f32 v63, v94, v95
  v_exp_f32 v66, v66
  v_mfma_f32_32x32x16_bf16 v[80:95], v[32:35], v[20:23], 0
  v_exp_f32 v67, v67
  v_cvt_pk_bf16_f32 v56, v64, v65
  v_exp_f32 v68, v68
  v_mfma_f32_32x32x16_bf16 v[112:127], v[44:47], v[60:63], v[112:127]
  v_exp_f32 v69, v69
  v_cvt_pk_bf16_f32 v57, v66, v67
  v_exp_f32 v70, v70
  v_exp_f32 v71, v71
  v_cvt_pk_bf16_f32 v58, v68, v69
  v_exp_f32 v72, v72
  v_mfma_f32_32x32x8bf16_1k v[80:95], v[38:39], v[26:27], v[80:95]
  s_mov_b64 exec, s[84:85]
  ds_read_b128 v[40:43], v130 offset:4608
  ds_read_b128 v[44:47], v130 offset:5248
  s_mov_b64 exec, -1
  v_exp_f32 v73, v73
  v_cvt_pk_bf16_f32 v59, v70, v71
  v_exp_f32 v74, v74
  v_exp_f32 v75, v75
  v_cvt_pk_bf16_f32 v60, v72, v73
  v_exp_f32 v76, v76
  v_mfma_f32_32x32x16_bf16 v[96:111], v[48:51], v[56:59], v[96:111]
  s_waitcnt lgkmcnt(2)
  v_exp_f32 v77, v77
  v_cvt_pk_bf16_f32 v61, v74, v75
  v_add_u32 v130, 4608, v130
  v_exp_f32 v78, v78
  v_exp_f32 v79, v79
  v_cvt_pk_bf16_f32 v62, v76, v77
  v_exp_f32 v80, v80
  v_exp_f32 v81, v81
  v_cvt_pk_bf16_f32 v63, v78, v79
  v_exp_f32 v82, v82
  v_mfma_f32_32x32x16_bf16 v[64:79], v[28:31], v[16:19], 0
  ds_read_b128 v[32:35], v128 offset:6912
  v_exp_f32 v83, v83
  v_cvt_pk_bf16_f32 v56, v80, v81
  v_exp_f32 v84, v84
  v_mfma_f32_32x32x16_bf16 v[96:111], v[52:55], v[60:63], v[96:111]
  v_exp_f32 v85, v85
  v_cvt_pk_bf16_f32 v57, v82, v83
  v_exp_f32 v86, v86
  v_exp_f32 v87, v87
  v_cvt_pk_bf16_f32 v58, v84, v85
  v_exp_f32 v88, v88
  v_mfma_f32_32x32x8bf16_1k v[64:79], v[36:37], v[24:25], v[64:79]
  ds_read_u16 v38, v129 offset:6912
  v_exp_f32 v89, v89
  v_cvt_pk_bf16_f32 v59, v86, v87
  v_exp_f32 v90, v90
  v_exp_f32 v91, v91
  v_cvt_pk_bf16_f32 v60, v88, v89
  v_exp_f32 v92, v92
  v_mfma_f32_32x32x16_bf16 v[112:127], v[48:51], v[56:59], v[112:127]
  s_waitcnt lgkmcnt(2)
  v_exp_f32 v93, v93
  v_cvt_pk_bf16_f32 v61, v90, v91
  v_add_u32 v128, 4608, v128
  v_add_u32 v129, 4608, v129
  v_exp_f32 v94, v94
  v_exp_f32 v95, v95
  v_cvt_pk_bf16_f32 v62, v92, v93
  s_add_u32 s78, s78, 1
  s_cmp_lt_u32 s78, 16
  s_cbranch_scc1 f_kernel_loop68
  s_branch f_kernel_lend65
f_kernel_ok66:
  v_mov_b32 v123, v135
  s_waitcnt lgkmcnt(0)
  s_barrier
  ds_write_b128 v138, v[112:115] offset:0
  ds_write_b128 v138, v[116:119] offset:1024
  ds_write_b128 v138, v[120:123] offset:2048
  s_waitcnt lgkmcnt(0)
  s_barrier
  ds_read_b128 v[72:75], v139 offset:2048
  ds_read_b128 v[64:67], v139 offset:0
  ds_read_b128 v[68:71], v139 offset:1024
  s_waitcnt lgkmcnt(2)
  v_max_f32 v56, v134, v75
  v_sub_f32 v57, v134, v56
  v_sub_f32 v58, v75, v56
  v_exp_f32 v57, v57
  v_exp_f32 v58, v58
  v_mul_f32 v56, v57, v106
  v_fmac_f32 v56, v58, v74
  v_rcp_f32 v56, v56
  s_nop 0
  v_mul_f32 v57, v57, v56
  v_mul_f32 v58, v58, v56
  v_mul_f32 v104, v57, v104
  v_fmac_f32 v104, v58, v72
  v_mul_f32 v105, v57, v105
  v_fmac_f32 v105, v58, v73
  v_cvt_pk_bf16_f32 v40, v104, v105
  v_mul_f32 v96, v57, v96
  s_waitcnt lgkmcnt(1)
  v_fmac_f32 v96, v58, v64
  v_mul_f32 v97, v57, v97
  v_fmac_f32 v97, v58, v65
  v_mov_b32_dpp v41, v40 quad_perm:[1,1,1,1] row_mask:0xf bank_mask:0xf
  v_mul_f32 v98, v57, v98
  v_fmac_f32 v98, v58, v66
  v_mov_b32_dpp v42, v40 quad_perm:[2,2,2,2] row_mask:0xf bank_mask:0xf
  v_mul_f32 v99, v57, v99
  v_fmac_f32 v99, v58, v67
  v_mov_b32_dpp v43, v40 quad_perm:[3,3,3,3] row_mask:0xf bank_mask:0xf
  buffer_store_dwordx4 v[40:43], v137, s[24:27], s74 offen sc1
  v_mul_f32 v100, v57, v100
  s_waitcnt lgkmcnt(0)
  v_fmac_f32 v100, v58, v68
  v_mul_f32 v101, v57, v101
  v_fmac_f32 v101, v58, v69
  v_mul_f32 v102, v57, v102
  v_fmac_f32 v102, v58, v70
  v_mul_f32 v103, v57, v103
  v_fmac_f32 v103, v58, v71
  v_cvt_pk_bf16_f32 v60, v96, v97
  v_cvt_pk_bf16_f32 v61, v98, v99
  v_cvt_pk_bf16_f32 v62, v100, v101
  v_cvt_pk_bf16_f32 v63, v102, v103
  buffer_store_dwordx4 v[60:63], v4, s[24:27], s73 offen sc1
  s_waitcnt vmcnt(0)
  s_barrier
  s_cmp_lg_u32 s3, 7
  s_cbranch_scc1 f_kernel_sig69
  s_add_u32 s62, s50, s54
  v_lshlrev_b32 v12, 12, v1
  v_mov_b32 v13, s42
  s_add_u32 s62, s62, 262144
  s_mov_b64 exec, 1
  buffer_store_dword v13, v12, s[24:27], s62 offen sc1
  s_mov_b64 exec, -1
f_kernel_sig69:
  v_lshlrev_b32 v16, 4, v2
  v_lshl_add_u32 v16, v3, 9, v16
  v_and_b32 v17, 3, v1
  v_lshlrev_b32 v17, 13, v17
  v_and_b32 v18, 60, v1
  v_add_u32 v17, v17, v18
  s_lshr_b32 s62, s44, 1
  s_and_b32 s63, s44, 1
  s_lshl_b32 s68, s62, 16
  s_lshl_b32 s69, s63, 8
  s_add_u32 s68, s68, s69
  s_lshl_b32 s70, s3, 12
  s_add_u32 s68, s68, s70
  s_add_u32 s68, s68, s49
  s_add_u32 s68, s68, 27262976
  s_lshl_b32 s69, s62, 8
  s_lshl_b32 s63, s63, 6
  s_add_u32 s69, s69, s63
  s_lshl_b32 s62, s3, 15
  s_add_u32 s69, s69, s62
  s_add_u32 s69, s69, s49
  s_add_u32 s69, s69, 29360128
  s_lshr_b32 s62, s3, 2
  s_lshl_b32 s62, s62, 11
  s_and_b32 s63, s3, 3
  s_lshl_b32 s63, s63, 8
  s_add_u32 s71, s62, s63
  s_add_u32 s43, s43, 1
  s_add_u32 s48, s48, 4718592
  s_add_u32 s51, s51, 0x8000
  s_add_u32 s49, s49, 16777216
  s_mov_b32 s55, 1073741824
  v_mov_b32 v252, v4
  s_lshl_b32 s62, s3, 12
  v_add_u32 v5, s62, v252
  s_and_b32 s62, s3, 1
  s_lshl_b32 s62, s62, 11
  s_add_u32 s62, s62, 32768
  v_add_u32 v6, s62, v252
  s_mul_i32 s62, s3, 4112
  s_add_u32 s62, s62, 36864
  v_add_u32 v7, s62, v4
  s_cmp_eq_u32 s43, 2
  s_cbranch_scc1 f_kernel_eo56
  v_lshlrev_b32 v8, 4, v2
  v_lshl_add_u32 v8, v3, 14, v8
  v_lshl_add_u32 v9, v2, 2, v3
  s_lshl_b32 s62, s3, 3
  s_add_u32 s62, s62, 69760
  v_lshl_add_u32 v9, v9, 6, s62
  s_mul_i32 s64, s45, 589824
  s_lshl_b32 s65, s44, 8
  s_add_u32 s64, s64, s65
  s_add_u32 s64, s64, s48
  s_lshl_b32 s65, s3, 5
  s_add_u32 s65, s65, s64
  s_add_u32 s65, s65, 524288
  s_lshl_b32 s62, s3, 16
  s_add_u32 s64, s64, s62
  s_lshl_b32 s66, s45, 13
  s_lshl_b32 s62, s44, 7
  s_add_u32 s66, s66, s62
  s_lshl_b32 s62, s3, 4
  s_add_u32 s66, s66, s62
  s_add_u32 s66, s66, s51
  s_branch f_kernel_eoj57
f_kernel_eo56:
  s_mov_b32 s28, s16
  s_mov_b32 s29, s17
  s_mov_b32 s30, 2359296
  s_mov_b32 s31, 0x00020000
  v_mul_u32_u24 v8, 0x9000, v2
  v_and_b32 v9, 1, v3
  v_mul_u32_u24 v9, 0x480, v9
  v_lshrrev_b32 v10, 1, v3
  v_lshlrev_b32 v10, 4, v10
  v_add3_u32 v8, v8, v9, v10
  s_mul_i32 s64, s45, 288
  s_add_u32 s64, s64, s67
  s_mul_i32 s65, s3, 73728
  s_add_u32 s65, s65, s64
  s_add_u32 s65, s65, 256
  s_lshl_b32 s62, s3, 5
  s_add_u32 s64, s64, s62
f_kernel_eoj57:
  s_cmp_lg_u32 s3, 7
  s_cbranch_scc1 f_kernel_wsk70
  s_add_u32 s62, s50, s57
  s_add_u32 s62, s62, 262144
  v_lshlrev_b32 v11, 6, v1
  s_mov_b64 exec, 0xff
  s_mov_b32 s63, 0
f_kernel_wlp71:
  s_add_u32 s63, s63, 1
  buffer_load_dwordx4 v[12:15], v11, s[24:27], s62 offen sc1
  s_waitcnt vmcnt(0)
  v_xor_b32 v12, s42, v12
  v_xor_b32 v13, s42, v13
  v_xor_b32 v14, s42, v14
  v_xor_b32 v15, s42, v15
  v_or3_b32 v12, v12, v13, v14
  v_or_b32 v12, v12, v15
  v_cmp_ne_u32 vcc, 0, v12
  s_nop 4
  s_cbranch_vccz f_kernel_wdn72
  s_cmp_lt_u32 s63, 20000
  s_cbranch_scc1 f_kernel_wlp71
f_kernel_wdn72:
  s_mov_b64 exec, -1
f_kernel_wsk70:
  s_barrier
  s_add_u32 m0, s70, 0
  s_nop 0
  buffer_load_dwordx4 v16, s[24:27], s68 offen offset:0 sc1 lds
  buffer_load_dwordx4 v16, s[24:27], s68 offen offset:2048 sc1 lds
  s_add_u32 m0, s71, 32768
  s_nop 0
  buffer_load_dword v17, s[24:27], s69 offen offset:0 sc1 lds
  s_add_u32 s68, s68, 32768
  s_add_u32 m0, s70, 1024
  s_nop 0
  buffer_load_dwordx4 v16, s[24:27], s68 offen offset:0 sc1 lds
  buffer_load_dwordx4 v16, s[24:27], s68 offen offset:2048 sc1 lds
  s_add_u32 m0, s71, 33664
  s_nop 0
  buffer_load_dword v17, s[24:27], s69 offen offset:128 sc1 lds
  s_add_u32 s50, s50, 327680
  s_add_u32 s61, s61, 21
  s_waitcnt vmcnt(0)
  s_branch f_kernel_core6
f_kernel_fin7:
  s_nop 3
  v_cvt_pk_bf16_f32 v16, v144, v145
  v_cvt_pk_bf16_f32 v17, v146, v147
  v_cvt_pk_bf16_f32 v18, v148, v149
  v_cvt_pk_bf16_f32 v19, v150, v151
  s_nop 0
  v_permlane16_swap_b32 v16, v18
  v_permlane16_swap_b32 v17, v19
  buffer_store_dwordx4 v[16:19], v8, s[28:31], s64 offen
  v_and_b32 v5, 7, v1
  v_mul_u32_u24 v10, 4112, v5
  v_bfe_u32 v6, v1, 3, 2
  v_lshl_add_u32 v10, v6, 9, v10
  v_lshrrev_b32 v7, 5, v1
  v_lshl_add_u32 v10, v7, 4, v10
  s_lshl_b32 s62, s3, 5
  s_add_u32 s62, s62, 36864
  v_add_u32 v10, s62, v10
  v_mul_u32_u24 v7, 0x9000, v7
  v_and_b32 v6, 1, v6
  v_lshl_add_u32 v7, v6, 4, v7
  v_add_u32 v7, v7, v9
  v_mov_b32 v6, 1073741824
  v_cmp_eq_u32 vcc, 0, v5
  s_nop 1
  v_cndmask_b32 v7, v6, v7, vcc
  s_waitcnt lgkmcnt(0)
  s_barrier
  ds_read_b128 v[24:27], v10 offset:0
  ds_read_b128 v[28:31], v10 offset:256
  s_waitcnt lgkmcnt(1)
  v_add_f32_dpp v24, v24, v24 quad_perm:[1,0,3,2] row_mask:0xf bank_mask:0xf
  v_add_f32_dpp v25, v25, v25 quad_perm:[1,0,3,2] row_mask:0xf bank_mask:0xf
  v_add_f32_dpp v26, v26, v26 quad_perm:[1,0,3,2] row_mask:0xf bank_mask:0xf
  v_add_f32_dpp v27, v27, v27 quad_perm:[1,0,3,2] row_mask:0xf bank_mask:0xf
  s_waitcnt lgkmcnt(0)
  v_add_f32_dpp v28, v28, v28 quad_perm:[1,0,3,2] row_mask:0xf bank_mask:0xf
  v_add_f32_dpp v29, v29, v29 quad_perm:[1,0,3,2] row_mask:0xf bank_mask:0xf
  v_add_f32_dpp v30, v30, v30 quad_perm:[1,0,3,2] row_mask:0xf bank_mask:0xf
  v_add_f32_dpp v31, v31, v31 quad_perm:[1,0,3,2] row_mask:0xf bank_mask:0xf
  v_add_f32_dpp v24, v24, v24 quad_perm:[2,3,0,1] row_mask:0xf bank_mask:0xf
  v_add_f32_dpp v25, v25, v25 quad_perm:[2,3,0,1] row_mask:0xf bank_mask:0xf
  v_add_f32_dpp v26, v26, v26 quad_perm:[2,3,0,1] row_mask:0xf bank_mask:0xf
  v_add_f32_dpp v27, v27, v27 quad_perm:[2,3,0,1] row_mask:0xf bank_mask:0xf
  v_add_f32_dpp v28, v28, v28 quad_perm:[2,3,0,1] row_mask:0xf bank_mask:0xf
  v_add_f32_dpp v29, v29, v29 quad_perm:[2,3,0,1] row_mask:0xf bank_mask:0xf
  v_add_f32_dpp v30, v30, v30 quad_perm:[2,3,0,1] row_mask:0xf bank_mask:0xf
  v_add_f32_dpp v31, v31, v31 quad_perm:[2,3,0,1] row_mask:0xf bank_mask:0xf
  v_add_f32_dpp v24, v24, v24 row_half_mirror row_mask:0xf bank_mask:0xf
  v_add_f32_dpp v25, v25, v25 row_half_mirror row_mask:0xf bank_mask:0xf
  v_add_f32_dpp v26, v26, v26 row_half_mirror row_mask:0xf bank_mask:0xf
  v_add_f32_dpp v27, v27, v27 row_half_mirror row_mask:0xf bank_mask:0xf
  v_add_f32_dpp v28, v28, v28 row_half_mirror row_mask:0xf bank_mask:0xf
  v_add_f32_dpp v29, v29, v29 row_half_mirror row_mask:0xf bank_mask:0xf
  v_add_f32_dpp v30, v30, v30 row_half_mirror row_mask:0xf bank_mask:0xf
  v_add_f32_dpp v31, v31, v31 row_half_mirror row_mask:0xf bank_mask:0xf
  v_cvt_pk_bf16_f32 v20, v24, v25
  v_cvt_pk_bf16_f32 v21, v26, v27
  v_cvt_pk_bf16_f32 v22, v28, v29
  v_cvt_pk_bf16_f32 v23, v30, v31
  buffer_store_dwordx4 v[20:23], v7, s[28:31], s65 offen
  s_or_b32 s62, s2, s3
  s_cmp_lg_u32 s62, 0
  s_cbranch_scc1 f_kernel_end73
  v_mov_b32 v5, s42
  v_mov_b32 v6, 0
  s_mov_b64 exec, 1
  buffer_store_dword v5, v6, s[24:27], 0 offen offset:256
f_kernel_end73:
f_end:
  s_endpgm
.section .rodata,"a"
.p2align 6
.amdhsa_kernel f_kernel
  .amdhsa_next_free_vgpr 256
  .amdhsa_next_free_sgpr 92
  .amdhsa_accum_offset 256
  .amdhsa_group_segment_fixed_size 0
  .amdhsa_kernarg_size 72
  .amdhsa_user_sgpr_count 2
  .amdhsa_user_sgpr_kernarg_segment_ptr 1
  .amdhsa_system_sgpr_workgroup_id_x 1
.end_amdhsa_kernel
```
